```python
import torch

def _softmax(x, axis=-1):
    return torch.softmax(x, dim=axis)
def _gelu(x):
    return torch.nn.functional.gelu(x, approximate="tanh")
def _silu(x):
    return torch.nn.functional.silu(x)
def _sigmoid(x):
    return torch.sigmoid(x)
def _layernorm(x, axis=-1, eps=1e-5):
    m = x.mean(dim=axis, keepdim=True)
    v = x.var(dim=axis, keepdim=True, unbiased=False)
    return (x - m) / torch.sqrt(v + eps)
def _scatter_add(tgt, idx, src, axis=0):
    return tgt.clone().index_add_(axis, idx, src)
def _segment_sum(src, seg, n):
    out = torch.zeros((n,) + src.shape[1:], dtype=src.dtype)
    return out.index_add_(0, seg, src)
def _pad(x, pw):
    flat = tuple(v for pair in reversed(pw) for v in pair)
    return torch.nn.functional.pad(x, flat)

kernel_name = 'gated_mix__grouped_kv_mqa__dense_activation_relu__prompt'

def setup_inputs():

    _w = (lambda a: (lambda t: t.to(torch.bfloat16) if t.is_floating_point() else t)(torch.as_tensor(a)))
    def _A_setup():
        B, S, D, H = 1, 2048, 512, 32
        Dh = D // H
        return {
            "x": _w((lambda *s: torch.randn(*s, dtype=torch.bfloat16) * 0.05)(B, S, D)),
            "wq": _w((lambda *s: torch.randn(*s, dtype=torch.bfloat16) * 0.8)(D, H * Dh)),
            "wk": _w((lambda *s: torch.randn(*s, dtype=torch.bfloat16) * 0.8)(D, Dh)),
            "wv": _w((lambda *s: torch.randn(*s, dtype=torch.bfloat16) * 0.2)(D, Dh)),
            "wo": _w((lambda *s: torch.randn(*s, dtype=torch.bfloat16) * 0.2)(H * Dh, D)),
        }
    _A_in = _A_setup()

    def _B_setup():
        B, S, D, Dff = 1, 2048, 512, 1792
        return {
            "x": _w((lambda *s: torch.randn(*s, dtype=torch.bfloat16) * 0.05)(B, S, D)),
            "w1": _w((lambda *s: torch.randn(*s, dtype=torch.bfloat16) * 0.05)(D, Dff)),
            "w2": _w((lambda *s: torch.randn(*s, dtype=torch.bfloat16) * 0.05)(Dff, D)),
        }
    _B_in = _B_setup()

    return {
        "A_x": _A_in["x"],
        "A_wq": _A_in["wq"],
        "A_wk": _A_in["wk"],
        "A_wv": _A_in["wv"],
        "A_wo": _A_in["wo"],
        "B_x": _B_in["x"],
        "B_w1": _B_in["w1"],
        "B_w2": _B_in["w2"],
        "gate_w": _w((lambda *s: torch.randn(*s, dtype=torch.bfloat16) * 0.05)(512) * 16.0),
    }

def reference(A_x, A_wq, A_wk, A_wv, A_wo, B_x, B_w1, B_w2, gate_w):
    def _A_ref(x, wq, wk, wv, wo):
        B, S, D = x.shape
        H = 32
        Dh = D // H
        q = (lambda x, *d: x.permute(*d))((x @ wq).reshape(B, S, H, Dh), 0, 2, 1, 3)
        k = x @ wk
        v = x @ wv
        scores = torch.einsum("bhqd,bkd->bhqk", q, k) * (Dh ** -0.5)
        p = _softmax(scores, axis=-1)
        o = torch.einsum("bhqk,bkd->bhqd", p, v)
        return (lambda x, *d: x.permute(*d))(o, 0, 2, 1, 3).reshape(B, S, H * Dh) @ wo

    def _B_ref(x, w1, w2):
        h = torch.einsum("bsd,df->bsf", x, w1)
        zero = torch.zeros_like(h)
        h = torch.maximum(h, zero)
        return torch.einsum("bsf,fd->bsd", h, w2)

    x = A_x
    g = _sigmoid((x * gate_w).sum(-1, keepdims=True))
    a = _A_ref(x, A_wq, A_wk, A_wv, A_wo)
    b = _B_ref(x, B_w1, B_w2)
    return g * a + (1 - g) * b
```

```asm
; @launch grid=(256,1,1) block=(512,1,1) lds=163840
.amdgcn_target "amdgcn-amd-amdhsa--gfx950"
.text
.globl gated_mix__grouped_kv_mqa__dense_activation_relu__prompt_kernel
.p2align 8
.type gated_mix__grouped_kv_mqa__dense_activation_relu__prompt_kernel,@function
gated_mix__grouped_kv_mqa__dense_activation_relu__prompt_kernel:
  s_cmp_ge_u32 s2, 256
  s_cbranch_scc1 M_END
  s_load_dwordx16 s[16:31], s[0:1], 0
  s_load_dwordx4 s[32:35], s[0:1], 64
  s_load_dwordx4 s[52:55], s[0:1], 80
  s_and_b32 s65, s2, 1
  s_lshl_b32 s65, s65, 2
  s_bfe_u32 s67, s2, 0x20003
  s_or_b32 s65, s65, s67
  s_bfe_u32 s64, s2, 0x20001
  s_lshl_b32 s64, s64, 3
  s_lshr_b32 s67, s2, 5
  s_or_b32 s64, s64, s67
  v_lshrrev_b32 v8, 6, v0
  v_and_b32 v1, 63, v0
  v_readfirstlane_b32 s66, v8
  v_lshlrev_b32 v5, 4, v1
  s_and_b32 s75, s65, 1
  s_lshr_b32 s76, s65, 1
  s_and_b32 s81, s64, 3
  v_lshrrev_b32 v11, 4, v1
  v_and_b32 v10, 15, v1
  v_xor_b32 v10, v10, v11
  v_lshlrev_b32 v10, 4, v10
  v_lshl_add_u32 v16, v11, 10, v10
  v_xor_b32 v17, 64, v16
  v_xor_b32 v18, 128, v16
  v_xor_b32 v19, 192, v16
  s_and_b32 s92, s66, 3
  s_lshl_b32 s67, s64, 16
  s_lshl_b32 s68, s92, 14
  s_add_u32 s72, s67, s68
  s_lshl_b32 s83, s92, 12
  s_cmp_ge_u32 s66, 4
  s_cbranch_scc1 A_LOADER
  v_lshrrev_b32 v11, 1, v1
  v_and_b32 v12, 0x13, v11
  v_bfe_u32 v13, v11, 2, 1
  v_bfe_u32 v14, v11, 3, 1
  v_lshl_add_u32 v12, v13, 3, v12
  v_lshl_add_u32 v12, v14, 2, v12
  v_lshlrev_b32 v12, 5, v12
  v_and_b32 v13, 1, v1
  v_lshl_add_u32 v12, v13, 4, v12
  s_waitcnt lgkmcnt(0)
  s_mov_b32 s36, s16
  s_mov_b32 s37, s17
  s_mov_b32 s38, 2097152
  s_mov_b32 s39, 0x00020000
  s_mov_b32 s8, s54
  s_mov_b32 s9, s55
  s_mov_b32 s10, 16777216
  s_mov_b32 s11, 0x00020000
  s_mov_b32 s12, s52
  s_mov_b32 s13, s53
  s_mov_b32 s14, 256
  s_mov_b32 s15, 0x00020000
  s_mov_b64 s[4:5], s[24:25]
  s_mov_b64 s[6:7], s[34:35]
  s_lshl_b32 s67, s2, 3
  s_add_u32 s93, s67, s66
  s_cmp_eq_u32 s93, 1
  s_cbranch_scc0 A_NORST
  v_mov_b32 v32, 0
  v_mov_b32 v33, 0
  v_mov_b32 v34, 0
  v_mov_b32 v35, 0
  s_mov_b32 s67, 2260992
  buffer_store_dwordx4 v[32:35], v5, s[8:11], s67 offen offset:0 sc1
  buffer_store_dwordx4 v[32:35], v5, s[8:11], s67 offen offset:1024 sc1
  buffer_store_dwordx4 v[32:35], v5, s[8:11], s67 offen offset:2048 sc1
  buffer_store_dwordx4 v[32:35], v5, s[8:11], s67 offen offset:3072 sc1
A_NORST:
  s_add_u32 s67, s81, 0
  s_and_b32 s67, s67, 3
  s_add_u32 m0, s83, 0
  s_lshl_b32 s67, s67, 8
  s_add_u32 s67, s67, s72
  buffer_load_dwordx4 v16, s[36:39], s67 offen lds
  s_add_u32 m0, m0, 1024
  s_add_u32 s67, s67, 4096
  buffer_load_dwordx4 v17, s[36:39], s67 offen lds
  s_add_u32 m0, m0, 1024
  s_add_u32 s67, s67, 4096
  buffer_load_dwordx4 v18, s[36:39], s67 offen lds
  s_add_u32 m0, m0, 1024
  s_add_u32 s67, s67, 4096
  buffer_load_dwordx4 v19, s[36:39], s67 offen lds
  s_cmp_eq_u32 s75, 0
  s_cselect_b32 s48, s20, s22
  s_cselect_b32 s49, s21, s23
  s_mov_b32 s50, 16384
  s_mov_b32 s51, 0x00020000
  s_lshl_b32 s67, s66, 12
  s_add_u32 m0, s67, 139264
  s_nop 0
  buffer_load_dwordx4 v12, s[48:51], s67 offen offset:0 lds
  buffer_load_dwordx4 v12, s[48:51], s67 offen offset:1024 lds
  buffer_load_dwordx4 v12, s[48:51], s67 offen offset:2048 lds
  buffer_load_dwordx4 v12, s[48:51], s67 offen offset:3072 lds
  s_mov_b32 s60, s32
  s_mov_b32 s61, s33
  s_mov_b32 s62, 1024
  s_mov_b32 s63, 0x00020000
  s_mov_b32 m0, 155648
  s_nop 0
  buffer_load_dwordx4 v5, s[60:63], 0 offen lds
  s_add_u32 s67, s81, 2
  s_and_b32 s67, s67, 3
  s_add_u32 m0, s83, 32768
  s_lshl_b32 s67, s67, 8
  s_add_u32 s67, s67, s72
  buffer_load_dwordx4 v16, s[36:39], s67 offen lds
  s_add_u32 m0, m0, 1024
  s_add_u32 s67, s67, 4096
  buffer_load_dwordx4 v17, s[36:39], s67 offen lds
  s_add_u32 m0, m0, 1024
  s_add_u32 s67, s67, 4096
  buffer_load_dwordx4 v18, s[36:39], s67 offen lds
  s_add_u32 m0, m0, 1024
  s_add_u32 s67, s67, 4096
  buffer_load_dwordx4 v19, s[36:39], s67 offen lds
  s_add_u32 s67, s81, 3
  s_and_b32 s67, s67, 3
  s_add_u32 m0, s83, 49152
  s_lshl_b32 s67, s67, 8
  s_add_u32 s67, s67, s72
  buffer_load_dwordx4 v16, s[36:39], s67 offen lds
  s_add_u32 m0, m0, 1024
  s_add_u32 s67, s67, 4096
  buffer_load_dwordx4 v17, s[36:39], s67 offen lds
  s_add_u32 m0, m0, 1024
  s_add_u32 s67, s67, 4096
  buffer_load_dwordx4 v18, s[36:39], s67 offen lds
  s_add_u32 m0, m0, 1024
  s_add_u32 s67, s67, 4096
  buffer_load_dwordx4 v19, s[36:39], s67 offen lds
  s_cmp_eq_u32 s93, 1
  s_cbranch_scc0 A_NORST2
  s_waitcnt vmcnt(17)
  v_mov_b32 v36, 1
  buffer_store_dword v36, off, s[12:15], 0 sc1
A_NORST2:
  v_lshrrev_b32 v8, 5, v1
  v_and_b32 v9, 31, v1
  v_and_b32 v10, 15, v9
  v_xor_b32 v10, v10, v8
  v_lshlrev_b32 v10, 4, v10
  v_lshl_add_u32 v236, v9, 8, v10
  v_xor_b32 v237, 32, v236
  v_xor_b32 v238, 64, v236
  v_xor_b32 v239, 96, v236
  v_xor_b32 v240, 128, v236
  v_xor_b32 v241, 160, v236
  v_xor_b32 v242, 192, v236
  v_xor_b32 v243, 224, v236
  v_bfe_u32 v10, v1, 2, 2
  v_lshl_add_u32 v11, v8, 3, v10
  v_bfe_u32 v12, v1, 4, 1
  v_lshlrev_b32 v12, 5, v12
  v_and_b32 v13, 3, v1
  v_lshl_add_u32 v12, v13, 3, v12
  s_cmp_eq_u32 s66, 0
  s_cbranch_scc0 A_HROLE
  v_lshl_add_u32 v228, v11, 7, v12
  v_bfe_u32 v13, v1, 3, 1
  v_lshl_add_u32 v228, v13, 6, v228
  v_add_u32 v228, 65536, v228
  v_xor_b32 v232, 64, v228
  v_add_u32 v229, 18432, v228
  v_add_u32 v233, 18432, v232
  v_add_u32 v230, 36864, v228
  v_add_u32 v234, 36864, v232
  v_add_u32 v231, 55296, v228
  v_add_u32 v235, 55296, v232
  v_mov_b32 v64, 0
  v_mov_b32 v65, 0
  v_mov_b32 v66, 0
  v_mov_b32 v67, 0
  v_mov_b32 v68, 0
  v_mov_b32 v69, 0
  v_mov_b32 v70, 0
  v_mov_b32 v71, 0
  v_mov_b32 v72, 0
  v_mov_b32 v73, 0
  v_mov_b32 v74, 0
  v_mov_b32 v75, 0
  v_mov_b32 v76, 0
  v_mov_b32 v77, 0
  v_mov_b32 v78, 0
  v_mov_b32 v79, 0
  v_mov_b32 v80, 0
  v_mov_b32 v81, 0
  v_mov_b32 v82, 0
  v_mov_b32 v83, 0
  v_mov_b32 v84, 0
  v_mov_b32 v85, 0
  v_mov_b32 v86, 0
  v_mov_b32 v87, 0
  v_mov_b32 v88, 0
  v_mov_b32 v89, 0
  v_mov_b32 v90, 0
  v_mov_b32 v91, 0
  v_mov_b32 v92, 0
  v_mov_b32 v93, 0
  v_mov_b32 v94, 0
  v_mov_b32 v95, 0
  v_mov_b32 v96, 0
  v_mov_b32 v97, 0
  v_mov_b32 v98, 0
  v_mov_b32 v99, 0
  v_mov_b32 v100, 0
  v_mov_b32 v101, 0
  v_mov_b32 v102, 0
  v_mov_b32 v103, 0
  v_mov_b32 v104, 0
  v_mov_b32 v105, 0
  v_mov_b32 v106, 0
  v_mov_b32 v107, 0
  v_mov_b32 v108, 0
  v_mov_b32 v109, 0
  v_mov_b32 v110, 0
  v_mov_b32 v111, 0
  v_mov_b32 v112, 0
  v_mov_b32 v113, 0
  v_mov_b32 v114, 0
  v_mov_b32 v115, 0
  v_mov_b32 v116, 0
  v_mov_b32 v117, 0
  v_mov_b32 v118, 0
  v_mov_b32 v119, 0
  v_mov_b32 v120, 0
  v_mov_b32 v121, 0
  v_mov_b32 v122, 0
  v_mov_b32 v123, 0
  v_mov_b32 v124, 0
  v_mov_b32 v125, 0
  v_mov_b32 v126, 0
  v_mov_b32 v127, 0
  s_waitcnt vmcnt(13)
  s_barrier
  ds_read_b64_tr_b16 v[32:33], v228 offset:0
  ds_read_b64_tr_b16 v[34:35], v228 offset:512
  ds_read_b128 v[48:51], v236 offset:0
  ds_read_b128 v[52:55], v236 offset:8192
  ds_read_b64_tr_b16 v[36:37], v232 offset:0
  ds_read_b64_tr_b16 v[38:39], v232 offset:512
  s_waitcnt lgkmcnt(3)
  v_mfma_f32_32x32x16_bf16 v[64:79], v[32:35], v[48:51], v[64:79]
  ds_read_b64_tr_b16 v[40:41], v228 offset:2048
  ds_read_b64_tr_b16 v[42:43], v228 offset:2560
  ds_read_b128 v[56:59], v237 offset:0
  s_waitcnt lgkmcnt(5)
  v_mfma_f32_32x32x16_bf16 v[80:95], v[32:35], v[52:55], v[80:95]
  ds_read_b128 v[60:63], v237 offset:8192
  s_waitcnt lgkmcnt(4)
  v_mfma_f32_32x32x16_bf16 v[112:127], v[36:39], v[52:55], v[112:127]
  ds_read_b64_tr_b16 v[44:45], v232 offset:2048
  ds_read_b64_tr_b16 v[46:47], v232 offset:2560
  v_mfma_f32_32x32x16_bf16 v[96:111], v[36:39], v[48:51], v[96:111]
  s_waitcnt lgkmcnt(3)
  v_mfma_f32_32x32x16_bf16 v[64:79], v[40:43], v[56:59], v[64:79]
  s_waitcnt vmcnt(8)
  s_waitcnt lgkmcnt(0)
  s_barrier
  ds_read_b64_tr_b16 v[32:33], v229 offset:0
  ds_read_b64_tr_b16 v[34:35], v229 offset:512
  ds_read_b128 v[48:51], v238 offset:0
  v_mfma_f32_32x32x16_bf16 v[80:95], v[40:43], v[60:63], v[80:95]
  ds_read_b128 v[52:55], v238 offset:8192
  ds_read_b64_tr_b16 v[36:37], v233 offset:0
  ds_read_b64_tr_b16 v[38:39], v233 offset:512
  v_mfma_f32_32x32x16_bf16 v[112:127], v[44:47], v[60:63], v[112:127]
  v_mfma_f32_32x32x16_bf16 v[96:111], v[44:47], v[56:59], v[96:111]
  s_waitcnt lgkmcnt(3)
  v_mfma_f32_32x32x16_bf16 v[64:79], v[32:35], v[48:51], v[64:79]
  ds_read_b64_tr_b16 v[40:41], v229 offset:2048
  ds_read_b64_tr_b16 v[42:43], v229 offset:2560
  ds_read_b128 v[56:59], v239 offset:0
  s_waitcnt lgkmcnt(5)
  v_mfma_f32_32x32x16_bf16 v[80:95], v[32:35], v[52:55], v[80:95]
  ds_read_b128 v[60:63], v239 offset:8192
  s_waitcnt lgkmcnt(4)
  v_mfma_f32_32x32x16_bf16 v[112:127], v[36:39], v[52:55], v[112:127]
  ds_read_b64_tr_b16 v[44:45], v233 offset:2048
  ds_read_b64_tr_b16 v[46:47], v233 offset:2560
  v_mfma_f32_32x32x16_bf16 v[96:111], v[36:39], v[48:51], v[96:111]
  s_waitcnt lgkmcnt(3)
  v_mfma_f32_32x32x16_bf16 v[64:79], v[40:43], v[56:59], v[64:79]
  s_waitcnt vmcnt(4)
  s_waitcnt vmcnt(0)
  s_waitcnt lgkmcnt(0)
  s_barrier
  ds_read_b64_tr_b16 v[32:33], v230 offset:0
  ds_read_b64_tr_b16 v[34:35], v230 offset:512
  ds_read_b128 v[48:51], v240 offset:0
  v_mfma_f32_32x32x16_bf16 v[80:95], v[40:43], v[60:63], v[80:95]
  ds_read_b128 v[52:55], v240 offset:8192
  ds_read_b64_tr_b16 v[36:37], v234 offset:0
  ds_read_b64_tr_b16 v[38:39], v234 offset:512
  v_mfma_f32_32x32x16_bf16 v[112:127], v[44:47], v[60:63], v[112:127]
  v_mfma_f32_32x32x16_bf16 v[96:111], v[44:47], v[56:59], v[96:111]
  s_waitcnt lgkmcnt(3)
  v_mfma_f32_32x32x16_bf16 v[64:79], v[32:35], v[48:51], v[64:79]
  ds_read_b64_tr_b16 v[40:41], v230 offset:2048
  ds_read_b64_tr_b16 v[42:43], v230 offset:2560
  ds_read_b128 v[56:59], v241 offset:0
  s_waitcnt lgkmcnt(5)
  v_mfma_f32_32x32x16_bf16 v[80:95], v[32:35], v[52:55], v[80:95]
  ds_read_b128 v[60:63], v241 offset:8192
  s_waitcnt lgkmcnt(4)
  v_mfma_f32_32x32x16_bf16 v[112:127], v[36:39], v[52:55], v[112:127]
  ds_read_b64_tr_b16 v[44:45], v234 offset:2048
  ds_read_b64_tr_b16 v[46:47], v234 offset:2560
  v_mfma_f32_32x32x16_bf16 v[96:111], v[36:39], v[48:51], v[96:111]
  s_waitcnt lgkmcnt(3)
  v_mfma_f32_32x32x16_bf16 v[64:79], v[40:43], v[56:59], v[64:79]
  s_waitcnt lgkmcnt(0)
  s_barrier
  ds_read_b64_tr_b16 v[32:33], v231 offset:0
  ds_read_b64_tr_b16 v[34:35], v231 offset:512
  ds_read_b128 v[48:51], v242 offset:0
  v_mfma_f32_32x32x16_bf16 v[80:95], v[40:43], v[60:63], v[80:95]
  ds_read_b128 v[52:55], v242 offset:8192
  ds_read_b64_tr_b16 v[36:37], v235 offset:0
  ds_read_b64_tr_b16 v[38:39], v235 offset:512
  v_mfma_f32_32x32x16_bf16 v[112:127], v[44:47], v[60:63], v[112:127]
  v_mfma_f32_32x32x16_bf16 v[96:111], v[44:47], v[56:59], v[96:111]
  s_waitcnt lgkmcnt(3)
  v_mfma_f32_32x32x16_bf16 v[64:79], v[32:35], v[48:51], v[64:79]
  ds_read_b64_tr_b16 v[40:41], v231 offset:2048
  ds_read_b64_tr_b16 v[42:43], v231 offset:2560
  ds_read_b128 v[56:59], v243 offset:0
  s_waitcnt lgkmcnt(5)
  v_mfma_f32_32x32x16_bf16 v[80:95], v[32:35], v[52:55], v[80:95]
  ds_read_b128 v[60:63], v243 offset:8192
  s_waitcnt lgkmcnt(4)
  v_mfma_f32_32x32x16_bf16 v[112:127], v[36:39], v[52:55], v[112:127]
  ds_read_b64_tr_b16 v[44:45], v235 offset:2048
  ds_read_b64_tr_b16 v[46:47], v235 offset:2560
  v_mfma_f32_32x32x16_bf16 v[96:111], v[36:39], v[48:51], v[96:111]
  s_waitcnt lgkmcnt(3)
  v_mfma_f32_32x32x16_bf16 v[64:79], v[40:43], v[56:59], v[64:79]
  s_waitcnt lgkmcnt(0)
  s_barrier
  ds_read_b64_tr_b16 v[32:33], v228 offset:0
  ds_read_b64_tr_b16 v[34:35], v228 offset:512
  ds_read_b128 v[48:51], v236 offset:16384
  v_mfma_f32_32x32x16_bf16 v[80:95], v[40:43], v[60:63], v[80:95]
  ds_read_b128 v[52:55], v236 offset:24576
  ds_read_b64_tr_b16 v[36:37], v232 offset:0
  ds_read_b64_tr_b16 v[38:39], v232 offset:512
  v_mfma_f32_32x32x16_bf16 v[112:127], v[44:47], v[60:63], v[112:127]
  v_mfma_f32_32x32x16_bf16 v[96:111], v[44:47], v[56:59], v[96:111]
  s_waitcnt lgkmcnt(3)
  v_mfma_f32_32x32x16_bf16 v[64:79], v[32:35], v[48:51], v[64:79]
  ds_read_b64_tr_b16 v[40:41], v228 offset:2048
  ds_read_b64_tr_b16 v[42:43], v228 offset:2560
  ds_read_b128 v[56:59], v237 offset:16384
  s_waitcnt lgkmcnt(5)
  v_mfma_f32_32x32x16_bf16 v[80:95], v[32:35], v[52:55], v[80:95]
  ds_read_b128 v[60:63], v237 offset:24576
  s_waitcnt lgkmcnt(4)
  v_mfma_f32_32x32x16_bf16 v[112:127], v[36:39], v[52:55], v[112:127]
  ds_read_b64_tr_b16 v[44:45], v232 offset:2048
  ds_read_b64_tr_b16 v[46:47], v232 offset:2560
  v_mfma_f32_32x32x16_bf16 v[96:111], v[36:39], v[48:51], v[96:111]
  s_waitcnt lgkmcnt(3)
  v_mfma_f32_32x32x16_bf16 v[64:79], v[40:43], v[56:59], v[64:79]
  s_waitcnt lgkmcnt(0)
  s_barrier
  ds_read_b64_tr_b16 v[32:33], v229 offset:0
  ds_read_b64_tr_b16 v[34:35], v229 offset:512
  ds_read_b128 v[48:51], v238 offset:16384
  v_mfma_f32_32x32x16_bf16 v[80:95], v[40:43], v[60:63], v[80:95]
  ds_read_b128 v[52:55], v238 offset:24576
  ds_read_b64_tr_b16 v[36:37], v233 offset:0
  ds_read_b64_tr_b16 v[38:39], v233 offset:512
  v_mfma_f32_32x32x16_bf16 v[112:127], v[44:47], v[60:63], v[112:127]
  v_mfma_f32_32x32x16_bf16 v[96:111], v[44:47], v[56:59], v[96:111]
  s_waitcnt lgkmcnt(3)
  v_mfma_f32_32x32x16_bf16 v[64:79], v[32:35], v[48:51], v[64:79]
  ds_read_b64_tr_b16 v[40:41], v229 offset:2048
  ds_read_b64_tr_b16 v[42:43], v229 offset:2560
  ds_read_b128 v[56:59], v239 offset:16384
  s_waitcnt lgkmcnt(5)
  v_mfma_f32_32x32x16_bf16 v[80:95], v[32:35], v[52:55], v[80:95]
  ds_read_b128 v[60:63], v239 offset:24576
  s_waitcnt lgkmcnt(4)
  v_mfma_f32_32x32x16_bf16 v[112:127], v[36:39], v[52:55], v[112:127]
  ds_read_b64_tr_b16 v[44:45], v233 offset:2048
  ds_read_b64_tr_b16 v[46:47], v233 offset:2560
  v_mfma_f32_32x32x16_bf16 v[96:111], v[36:39], v[48:51], v[96:111]
  s_waitcnt lgkmcnt(3)
  v_mfma_f32_32x32x16_bf16 v[64:79], v[40:43], v[56:59], v[64:79]
  s_waitcnt lgkmcnt(0)
  s_barrier
  ds_read_b64_tr_b16 v[32:33], v230 offset:0
  ds_read_b64_tr_b16 v[34:35], v230 offset:512
  ds_read_b128 v[48:51], v240 offset:16384
  v_mfma_f32_32x32x16_bf16 v[80:95], v[40:43], v[60:63], v[80:95]
  ds_read_b128 v[52:55], v240 offset:24576
  ds_read_b64_tr_b16 v[36:37], v234 offset:0
  ds_read_b64_tr_b16 v[38:39], v234 offset:512
  v_mfma_f32_32x32x16_bf16 v[112:127], v[44:47], v[60:63], v[112:127]
  v_mfma_f32_32x32x16_bf16 v[96:111], v[44:47], v[56:59], v[96:111]
  s_waitcnt lgkmcnt(3)
  v_mfma_f32_32x32x16_bf16 v[64:79], v[32:35], v[48:51], v[64:79]
  ds_read_b64_tr_b16 v[40:41], v230 offset:2048
  ds_read_b64_tr_b16 v[42:43], v230 offset:2560
  ds_read_b128 v[56:59], v241 offset:16384
  s_waitcnt lgkmcnt(5)
  v_mfma_f32_32x32x16_bf16 v[80:95], v[32:35], v[52:55], v[80:95]
  ds_read_b128 v[60:63], v241 offset:24576
  s_waitcnt lgkmcnt(4)
  v_mfma_f32_32x32x16_bf16 v[112:127], v[36:39], v[52:55], v[112:127]
  ds_read_b64_tr_b16 v[44:45], v234 offset:2048
  ds_read_b64_tr_b16 v[46:47], v234 offset:2560
  v_mfma_f32_32x32x16_bf16 v[96:111], v[36:39], v[48:51], v[96:111]
  s_waitcnt lgkmcnt(3)
  v_mfma_f32_32x32x16_bf16 v[64:79], v[40:43], v[56:59], v[64:79]
  s_waitcnt lgkmcnt(0)
  s_barrier
  ds_read_b64_tr_b16 v[32:33], v231 offset:0
  ds_read_b64_tr_b16 v[34:35], v231 offset:512
  ds_read_b128 v[48:51], v242 offset:16384
  v_mfma_f32_32x32x16_bf16 v[80:95], v[40:43], v[60:63], v[80:95]
  ds_read_b128 v[52:55], v242 offset:24576
  ds_read_b64_tr_b16 v[36:37], v235 offset:0
  ds_read_b64_tr_b16 v[38:39], v235 offset:512
  v_mfma_f32_32x32x16_bf16 v[112:127], v[44:47], v[60:63], v[112:127]
  v_mfma_f32_32x32x16_bf16 v[96:111], v[44:47], v[56:59], v[96:111]
  s_waitcnt lgkmcnt(3)
  v_mfma_f32_32x32x16_bf16 v[64:79], v[32:35], v[48:51], v[64:79]
  ds_read_b64_tr_b16 v[40:41], v231 offset:2048
  ds_read_b64_tr_b16 v[42:43], v231 offset:2560
  ds_read_b128 v[56:59], v243 offset:16384
  s_waitcnt lgkmcnt(5)
  v_mfma_f32_32x32x16_bf16 v[80:95], v[32:35], v[52:55], v[80:95]
  ds_read_b128 v[60:63], v243 offset:24576
  s_waitcnt lgkmcnt(4)
  v_mfma_f32_32x32x16_bf16 v[112:127], v[36:39], v[52:55], v[112:127]
  ds_read_b64_tr_b16 v[44:45], v235 offset:2048
  ds_read_b64_tr_b16 v[46:47], v235 offset:2560
  v_mfma_f32_32x32x16_bf16 v[96:111], v[36:39], v[48:51], v[96:111]
  s_waitcnt lgkmcnt(3)
  v_mfma_f32_32x32x16_bf16 v[64:79], v[40:43], v[56:59], v[64:79]
  s_waitcnt lgkmcnt(0)
  s_barrier
  ds_read_b64_tr_b16 v[32:33], v228 offset:0
  ds_read_b64_tr_b16 v[34:35], v228 offset:512
  ds_read_b128 v[48:51], v236 offset:32768
  v_mfma_f32_32x32x16_bf16 v[80:95], v[40:43], v[60:63], v[80:95]
  ds_read_b128 v[52:55], v236 offset:40960
  ds_read_b64_tr_b16 v[36:37], v232 offset:0
  ds_read_b64_tr_b16 v[38:39], v232 offset:512
  v_mfma_f32_32x32x16_bf16 v[112:127], v[44:47], v[60:63], v[112:127]
  v_mfma_f32_32x32x16_bf16 v[96:111], v[44:47], v[56:59], v[96:111]
  s_mov_b32 s16, s66
  s_mov_b32 s17, s64
  s_mov_b32 s18, s65
  s_lshl_b32 s32, s16, 10
  s_lshr_b32 s22, s16, 2
  s_and_b32 s28, s16, 3
  s_and_b32 s30, s16, 1
  s_bfe_u32 s29, s16, 0x10001
  s_lshr_b32 s35, s16, 1
  s_lshl_b32 s23, s18, 2
  s_add_u32 s23, s23, s28
  s_lshl_b32 s33, s17, 1
  s_add_u32 s33, s33, s22
  s_lshl_b32 s33, s33, 5
  s_add_u32 s33, s33, s23
  s_lshl_b32 s33, s33, 10
  s_add_u32 s37, s33, 13631488
  s_mul_i32 s19, s16, 14
  s_lshl_b32 s20, s18, 1
  s_add_u32 s20, s20, s29
  s_mul_i32 s24, s20, 112
  s_xor_b32 s20, s20, 1
  s_mul_i32 s25, s20, 112
  s_lshl_b32 s20, s17, 1
  s_add_u32 s20, s20, s30
  s_mul_i32 s26, s20, 112
  s_xor_b32 s20, s20, 1
  s_mul_i32 s27, s20, 112
  s_add_u32 s24, s24, s19
  s_lshl_b32 s24, s24, 10
  s_add_u32 s24, s24, 10485760
  s_add_u32 s25, s25, s19
  s_lshl_b32 s25, s25, 10
  s_add_u32 s25, s25, 10485760
  s_add_u32 s26, s26, s19
  s_lshl_b32 s26, s26, 10
  s_add_u32 s26, s26, 3145728
  s_add_u32 s27, s27, s19
  s_lshl_b32 s27, s27, 10
  s_add_u32 s27, s27, 3145728
  s_lshl_b32 s19, s17, 8
  s_add_u32 s19, s19, 2240512
  s_lshl_b32 s20, s18, 5
  s_add_u32 s50, s19, s20
  s_lshl_b32 s20, s16, 2
  s_add_u32 s50, s50, s20
  s_lshl_b32 s20, s16, 5
  s_add_u32 s51, s19, s20
  v_and_b32 v249, 7, v1
  v_lshlrev_b32 v249, 2, v249
  v_and_b32 v8, 31, v1
  v_lshrrev_b32 v9, 5, v1
  v_and_b32 v10, 11, v1
  v_cmp_eq_u32 vcc, 0, v10
  v_mov_b32 v10, 0x3c003c00
  s_nop 0
  v_cndmask_b32 v132, 0, v10, vcc
  v_mov_b32 v133, v132
  v_mov_b32 v134, v132
  v_mov_b32 v135, v132
  s_lshl_b32 s19, s16, 10
  s_add_u32 s19, s19, 155648
  v_add_u32 v10, s19, v5
  ds_write_b128 v10, v[132:135]
  s_nop 1
  v_lshlrev_b32 v10, 8, v9
  v_lshl_add_u32 v10, v8, 4, v10
  v_add_u32 v10, 65536, v10
  v_subrev_u32 v11, 20, v8
  v_cmp_gt_u32 vcc, 8, v11
  v_mov_b32 v11, 155648
  v_mov_b32 v12, 155712
  v_cndmask_b32 v11, v11, v12, vcc
  v_and_b32 v12, 11, v8
  v_cmp_ne_u32 vcc, 0, v12
  v_add_u32 v12, 16, v11
  s_nop 0
  v_cndmask_b32 v11, v11, v12, vcc
  v_cmp_gt_u32 vcc, 16, v8
  s_nop 1
  v_cndmask_b32 v3, v11, v10, vcc
  v_mov_b32 v11, 8192
  v_cndmask_b32 v4, 0, v11, vcc
  v_lshlrev_b32 v6, 2, v8
  v_mov_b32 v136, 0
  v_mov_b32 v137, 0
  v_mov_b32 v138, 0
  v_mov_b32 v139, 0
  v_mov_b32 v140, 0
  v_mov_b32 v141, 0
  v_mov_b32 v142, 0
  v_mov_b32 v143, 0
  v_mov_b32 v144, 0
  v_mov_b32 v145, 0
  v_mov_b32 v146, 0
  v_mov_b32 v147, 0
  v_mov_b32 v148, 0
  v_mov_b32 v149, 0
  v_mov_b32 v150, 0
  v_mov_b32 v151, 0
  v_mov_b32 v152, 0
  v_mov_b32 v153, 0
  v_mov_b32 v154, 0
  v_mov_b32 v155, 0
  v_mov_b32 v156, 0
  v_mov_b32 v157, 0
  v_mov_b32 v158, 0
  v_mov_b32 v159, 0
  v_mov_b32 v160, 0
  v_mov_b32 v161, 0
  v_mov_b32 v162, 0
  v_mov_b32 v163, 0
  v_mov_b32 v164, 0
  v_mov_b32 v165, 0
  v_mov_b32 v166, 0
  v_mov_b32 v167, 0
  v_mov_b32 v168, 0
  v_mov_b32 v169, 0
  v_mov_b32 v170, 0
  v_mov_b32 v171, 0
  v_mov_b32 v172, 0
  v_mov_b32 v173, 0
  v_mov_b32 v174, 0
  v_mov_b32 v175, 0
  v_mov_b32 v176, 0
  v_mov_b32 v177, 0
  v_mov_b32 v178, 0
  v_mov_b32 v179, 0
  v_mov_b32 v180, 0
  v_mov_b32 v181, 0
  v_mov_b32 v182, 0
  v_mov_b32 v183, 0
  v_mov_b32 v184, 0
  v_mov_b32 v185, 0
  v_mov_b32 v186, 0
  v_mov_b32 v187, 0
  v_mov_b32 v188, 0
  v_mov_b32 v189, 0
  v_mov_b32 v190, 0
  v_mov_b32 v191, 0
  v_mov_b32 v192, 0
  v_mov_b32 v193, 0
  v_mov_b32 v194, 0
  v_mov_b32 v195, 0
  v_mov_b32 v132, 0
  v_mov_b32 v133, 0
  v_mov_b32 v134, 0
  v_mov_b32 v135, 0
  s_lshl_b32 s19, s16, 13
  s_add_u32 s19, s19, 32768
  s_cmp_ge_u32 s16, 3
  s_cselect_b32 s20, 40960, 0
  s_add_u32 s19, s19, s20
  s_cmp_ge_u32 s16, 6
  s_cselect_b32 s20, 16384, 0
  s_add_u32 s19, s19, s20
  v_add_u32 v2, s19, v5
  s_xor_b32 s3, s16, 1
  s_lshl_b32 s19, s3, 13
  s_add_u32 s19, s19, 32768
  s_cmp_ge_u32 s3, 3
  s_cselect_b32 s20, 40960, 0
  s_add_u32 s19, s19, s20
  s_cmp_ge_u32 s3, 6
  s_cselect_b32 s20, 16384, 0
  s_add_u32 s19, s19, s20
  v_add_u32 v21, s19, v5
  s_lshl_b32 s20, s17, 1
  s_add_u32 s20, s20, s30
  s_lshl_b32 s20, s20, 5
  s_lshl_b32 s19, s35, 3
  s_add_u32 s20, s20, s19
  s_lshl_b32 s20, s20, 10
  s_add_u32 s36, s20, 13631488
  s_lshl_b32 s19, s16, 16
  s_lshl_b32 s20, s18, 7
  s_add_u32 s38, s19, s20
  v_lshrrev_b32 v14, 3, v1
  v_and_b32 v20, 7, v1
  v_bfe_u32 v13, v14, 1, 1
  v_lshlrev_b32 v13, 2, v13
  v_xor_b32 v20, v20, v13
  v_lshlrev_b32 v20, 4, v20
  v_lshl_add_u32 v20, v14, 10, v20
  s_waitcnt lgkmcnt(0)
  s_waitcnt lgkmcnt(3)
  v_mfma_f32_32x32x16_bf16 v[64:79], v[32:35], v[48:51], v[64:79]
  ds_read_b64_tr_b16 v[40:41], v228 offset:2048
  ds_read_b64_tr_b16 v[42:43], v228 offset:2560
  ds_read_b128 v[56:59], v237 offset:32768
  s_waitcnt lgkmcnt(5)
  v_mfma_f32_32x32x16_bf16 v[80:95], v[32:35], v[52:55], v[80:95]
  ds_read_b128 v[60:63], v237 offset:40960
  s_waitcnt lgkmcnt(4)
  v_mfma_f32_32x32x16_bf16 v[112:127], v[36:39], v[52:55], v[112:127]
  ds_read_b64_tr_b16 v[44:45], v232 offset:2048
  ds_read_b64_tr_b16 v[46:47], v232 offset:2560
  v_mfma_f32_32x32x16_bf16 v[96:111], v[36:39], v[48:51], v[96:111]
  s_waitcnt lgkmcnt(3)
  v_mfma_f32_32x32x16_bf16 v[64:79], v[40:43], v[56:59], v[64:79]
  s_waitcnt lgkmcnt(0)
  s_barrier
  ds_read_b64_tr_b16 v[32:33], v229 offset:0
  ds_read_b64_tr_b16 v[34:35], v229 offset:512
  ds_read_b128 v[48:51], v238 offset:32768
  v_mfma_f32_32x32x16_bf16 v[80:95], v[40:43], v[60:63], v[80:95]
  ds_read_b128 v[52:55], v238 offset:40960
  ds_read_b64_tr_b16 v[36:37], v233 offset:0
  ds_read_b64_tr_b16 v[38:39], v233 offset:512
  v_mfma_f32_32x32x16_bf16 v[112:127], v[44:47], v[60:63], v[112:127]
  v_mfma_f32_32x32x16_bf16 v[96:111], v[44:47], v[56:59], v[96:111]
  s_waitcnt lgkmcnt(3)
  v_mfma_f32_32x32x16_bf16 v[64:79], v[32:35], v[48:51], v[64:79]
  ds_read_b64_tr_b16 v[40:41], v229 offset:2048
  ds_read_b64_tr_b16 v[42:43], v229 offset:2560
  ds_read_b128 v[56:59], v239 offset:32768
  s_waitcnt lgkmcnt(5)
  v_mfma_f32_32x32x16_bf16 v[80:95], v[32:35], v[52:55], v[80:95]
  ds_read_b128 v[60:63], v239 offset:40960
  s_waitcnt lgkmcnt(4)
  v_mfma_f32_32x32x16_bf16 v[112:127], v[36:39], v[52:55], v[112:127]
  ds_read_b64_tr_b16 v[44:45], v233 offset:2048
  ds_read_b64_tr_b16 v[46:47], v233 offset:2560
  v_mfma_f32_32x32x16_bf16 v[96:111], v[36:39], v[48:51], v[96:111]
  s_waitcnt lgkmcnt(3)
  v_mfma_f32_32x32x16_bf16 v[64:79], v[40:43], v[56:59], v[64:79]
  s_waitcnt lgkmcnt(0)
  s_barrier
  ds_read_b64_tr_b16 v[32:33], v230 offset:0
  ds_read_b64_tr_b16 v[34:35], v230 offset:512
  ds_read_b128 v[48:51], v240 offset:32768
  v_mfma_f32_32x32x16_bf16 v[80:95], v[40:43], v[60:63], v[80:95]
  ds_read_b128 v[52:55], v240 offset:40960
  ds_read_b64_tr_b16 v[36:37], v234 offset:0
  ds_read_b64_tr_b16 v[38:39], v234 offset:512
  v_mfma_f32_32x32x16_bf16 v[112:127], v[44:47], v[60:63], v[112:127]
  v_mfma_f32_32x32x16_bf16 v[96:111], v[44:47], v[56:59], v[96:111]
  s_waitcnt lgkmcnt(3)
  v_mfma_f32_32x32x16_bf16 v[64:79], v[32:35], v[48:51], v[64:79]
  ds_read_b64_tr_b16 v[40:41], v230 offset:2048
  ds_read_b64_tr_b16 v[42:43], v230 offset:2560
  ds_read_b128 v[56:59], v241 offset:32768
  s_waitcnt lgkmcnt(5)
  v_mfma_f32_32x32x16_bf16 v[80:95], v[32:35], v[52:55], v[80:95]
  ds_read_b128 v[60:63], v241 offset:40960
  s_waitcnt lgkmcnt(4)
  v_mfma_f32_32x32x16_bf16 v[112:127], v[36:39], v[52:55], v[112:127]
  ds_read_b64_tr_b16 v[44:45], v234 offset:2048
  ds_read_b64_tr_b16 v[46:47], v234 offset:2560
  v_mfma_f32_32x32x16_bf16 v[96:111], v[36:39], v[48:51], v[96:111]
  s_waitcnt lgkmcnt(3)
  v_mfma_f32_32x32x16_bf16 v[64:79], v[40:43], v[56:59], v[64:79]
  s_waitcnt lgkmcnt(0)
  s_barrier
  ds_read_b64_tr_b16 v[32:33], v231 offset:0
  ds_read_b64_tr_b16 v[34:35], v231 offset:512
  ds_read_b128 v[48:51], v242 offset:32768
  v_mfma_f32_32x32x16_bf16 v[80:95], v[40:43], v[60:63], v[80:95]
  ds_read_b128 v[52:55], v242 offset:40960
  ds_read_b64_tr_b16 v[36:37], v235 offset:0
  ds_read_b64_tr_b16 v[38:39], v235 offset:512
  v_mfma_f32_32x32x16_bf16 v[112:127], v[44:47], v[60:63], v[112:127]
  v_mfma_f32_32x32x16_bf16 v[96:111], v[44:47], v[56:59], v[96:111]
  s_waitcnt lgkmcnt(3)
  v_mfma_f32_32x32x16_bf16 v[64:79], v[32:35], v[48:51], v[64:79]
  ds_read_b64_tr_b16 v[40:41], v231 offset:2048
  ds_read_b64_tr_b16 v[42:43], v231 offset:2560
  ds_read_b128 v[56:59], v243 offset:32768
  s_waitcnt lgkmcnt(5)
  v_mfma_f32_32x32x16_bf16 v[80:95], v[32:35], v[52:55], v[80:95]
  ds_read_b128 v[60:63], v243 offset:40960
  s_waitcnt lgkmcnt(4)
  v_mfma_f32_32x32x16_bf16 v[112:127], v[36:39], v[52:55], v[112:127]
  ds_read_b64_tr_b16 v[44:45], v235 offset:2048
  ds_read_b64_tr_b16 v[46:47], v235 offset:2560
  v_mfma_f32_32x32x16_bf16 v[96:111], v[36:39], v[48:51], v[96:111]
  s_waitcnt lgkmcnt(3)
  v_mfma_f32_32x32x16_bf16 v[64:79], v[40:43], v[56:59], v[64:79]
  s_waitcnt lgkmcnt(0)
  s_barrier
  ds_read_b64_tr_b16 v[32:33], v228 offset:0
  ds_read_b64_tr_b16 v[34:35], v228 offset:512
  ds_read_b128 v[48:51], v236 offset:49152
  v_mfma_f32_32x32x16_bf16 v[80:95], v[40:43], v[60:63], v[80:95]
  ds_read_b128 v[52:55], v236 offset:57344
  ds_read_b64_tr_b16 v[36:37], v232 offset:0
  ds_read_b64_tr_b16 v[38:39], v232 offset:512
  v_mfma_f32_32x32x16_bf16 v[112:127], v[44:47], v[60:63], v[112:127]
  v_mfma_f32_32x32x16_bf16 v[96:111], v[44:47], v[56:59], v[96:111]
  s_waitcnt lgkmcnt(3)
  v_mfma_f32_32x32x16_bf16 v[64:79], v[32:35], v[48:51], v[64:79]
  ds_read_b64_tr_b16 v[40:41], v228 offset:2048
  ds_read_b64_tr_b16 v[42:43], v228 offset:2560
  ds_read_b128 v[56:59], v237 offset:49152
  s_waitcnt lgkmcnt(5)
  v_mfma_f32_32x32x16_bf16 v[80:95], v[32:35], v[52:55], v[80:95]
  ds_read_b128 v[60:63], v237 offset:57344
  s_waitcnt lgkmcnt(4)
  v_mfma_f32_32x32x16_bf16 v[112:127], v[36:39], v[52:55], v[112:127]
  ds_read_b64_tr_b16 v[44:45], v232 offset:2048
  ds_read_b64_tr_b16 v[46:47], v232 offset:2560
  v_mfma_f32_32x32x16_bf16 v[96:111], v[36:39], v[48:51], v[96:111]
  s_waitcnt lgkmcnt(3)
  v_mfma_f32_32x32x16_bf16 v[64:79], v[40:43], v[56:59], v[64:79]
  s_waitcnt lgkmcnt(0)
  s_barrier
  ds_read_b64_tr_b16 v[32:33], v229 offset:0
  ds_read_b64_tr_b16 v[34:35], v229 offset:512
  ds_read_b128 v[48:51], v238 offset:49152
  v_mfma_f32_32x32x16_bf16 v[80:95], v[40:43], v[60:63], v[80:95]
  ds_read_b128 v[52:55], v238 offset:57344
  ds_read_b64_tr_b16 v[36:37], v233 offset:0
  ds_read_b64_tr_b16 v[38:39], v233 offset:512
  v_mfma_f32_32x32x16_bf16 v[112:127], v[44:47], v[60:63], v[112:127]
  v_mfma_f32_32x32x16_bf16 v[96:111], v[44:47], v[56:59], v[96:111]
  s_waitcnt lgkmcnt(3)
  v_mfma_f32_32x32x16_bf16 v[64:79], v[32:35], v[48:51], v[64:79]
  ds_read_b64_tr_b16 v[40:41], v229 offset:2048
  ds_read_b64_tr_b16 v[42:43], v229 offset:2560
  ds_read_b128 v[56:59], v239 offset:49152
  s_waitcnt lgkmcnt(5)
  v_mfma_f32_32x32x16_bf16 v[80:95], v[32:35], v[52:55], v[80:95]
  ds_read_b128 v[60:63], v239 offset:57344
  s_waitcnt lgkmcnt(4)
  v_mfma_f32_32x32x16_bf16 v[112:127], v[36:39], v[52:55], v[112:127]
  ds_read_b64_tr_b16 v[44:45], v233 offset:2048
  ds_read_b64_tr_b16 v[46:47], v233 offset:2560
  v_mfma_f32_32x32x16_bf16 v[96:111], v[36:39], v[48:51], v[96:111]
  s_waitcnt lgkmcnt(3)
  v_mfma_f32_32x32x16_bf16 v[64:79], v[40:43], v[56:59], v[64:79]
  s_waitcnt lgkmcnt(0)
  s_barrier
  ds_read_b64_tr_b16 v[32:33], v230 offset:0
  ds_read_b64_tr_b16 v[34:35], v230 offset:512
  ds_read_b128 v[48:51], v240 offset:49152
  v_mfma_f32_32x32x16_bf16 v[80:95], v[40:43], v[60:63], v[80:95]
  ds_read_b128 v[52:55], v240 offset:57344
  ds_read_b64_tr_b16 v[36:37], v234 offset:0
  ds_read_b64_tr_b16 v[38:39], v234 offset:512
  v_mfma_f32_32x32x16_bf16 v[112:127], v[44:47], v[60:63], v[112:127]
  v_mfma_f32_32x32x16_bf16 v[96:111], v[44:47], v[56:59], v[96:111]
  s_mov_b32 m0, s32
  s_add_u32 s32, s32, 2097152
  buffer_load_dwordx4 v5, s[8:11], s32 offen sc1 lds
  s_add_u32 m0, m0, 65536
  s_add_u32 s32, s32, 65536
  buffer_load_dwordx4 v5, s[8:11], s32 offen sc1 lds
  s_sub_u32 m0, m0, 57344
  s_sub_u32 s32, s32, 57344
  buffer_load_dwordx4 v5, s[8:11], s32 offen sc1 lds
  s_add_u32 m0, m0, 65536
  s_add_u32 s32, s32, 65536
  buffer_load_dwordx4 v5, s[8:11], s32 offen sc1 lds
  s_sub_u32 m0, m0, 57344
  s_sub_u32 s32, s32, 57344
  s_mov_b32 s31, 2236416
  buffer_load_dwordx4 v[244:247], v5, s[8:11], s31 offen sc1
  buffer_load_dwordx4 v[196:199], v5, s[8:11], s24 offen offset:0 sc1
  buffer_load_dwordx4 v[200:203], v5, s[8:11], s25 offen offset:0 sc1
  buffer_load_dwordx4 v[212:215], v5, s[8:11], s24 offen offset:1024 sc1
  buffer_load_dwordx4 v[216:219], v5, s[8:11], s25 offen offset:1024 sc1
  s_waitcnt lgkmcnt(3)
  v_mfma_f32_32x32x16_bf16 v[64:79], v[32:35], v[48:51], v[64:79]
  ds_read_b64_tr_b16 v[40:41], v230 offset:2048
  ds_read_b64_tr_b16 v[42:43], v230 offset:2560
  ds_read_b128 v[56:59], v241 offset:49152
  s_waitcnt lgkmcnt(5)
  v_mfma_f32_32x32x16_bf16 v[80:95], v[32:35], v[52:55], v[80:95]
  ds_read_b128 v[60:63], v241 offset:57344
  s_waitcnt lgkmcnt(4)
  v_mfma_f32_32x32x16_bf16 v[112:127], v[36:39], v[52:55], v[112:127]
  ds_read_b64_tr_b16 v[44:45], v234 offset:2048
  ds_read_b64_tr_b16 v[46:47], v234 offset:2560
  v_mfma_f32_32x32x16_bf16 v[96:111], v[36:39], v[48:51], v[96:111]
  s_waitcnt lgkmcnt(3)
  v_mfma_f32_32x32x16_bf16 v[64:79], v[40:43], v[56:59], v[64:79]
  s_waitcnt lgkmcnt(0)
  s_barrier
  ds_read_b64_tr_b16 v[32:33], v231 offset:0
  ds_read_b64_tr_b16 v[34:35], v231 offset:512
  ds_read_b128 v[48:51], v242 offset:49152
  v_mfma_f32_32x32x16_bf16 v[80:95], v[40:43], v[60:63], v[80:95]
  ds_read_b128 v[52:55], v242 offset:57344
  ds_read_b64_tr_b16 v[36:37], v235 offset:0
  ds_read_b64_tr_b16 v[38:39], v235 offset:512
  v_mfma_f32_32x32x16_bf16 v[112:127], v[44:47], v[60:63], v[112:127]
  v_mfma_f32_32x32x16_bf16 v[96:111], v[44:47], v[56:59], v[96:111]
  s_waitcnt lgkmcnt(3)
  v_mfma_f32_32x32x16_bf16 v[64:79], v[32:35], v[48:51], v[64:79]
  ds_read_b64_tr_b16 v[40:41], v231 offset:2048
  ds_read_b64_tr_b16 v[42:43], v231 offset:2560
  ds_read_b128 v[56:59], v243 offset:49152
  s_waitcnt lgkmcnt(5)
  v_mfma_f32_32x32x16_bf16 v[80:95], v[32:35], v[52:55], v[80:95]
  ds_read_b128 v[60:63], v243 offset:57344
  s_waitcnt lgkmcnt(4)
  v_mfma_f32_32x32x16_bf16 v[112:127], v[36:39], v[52:55], v[112:127]
  ds_read_b64_tr_b16 v[44:45], v235 offset:2048
  ds_read_b64_tr_b16 v[46:47], v235 offset:2560
  v_mfma_f32_32x32x16_bf16 v[96:111], v[36:39], v[48:51], v[96:111]
  s_waitcnt lgkmcnt(3)
  v_mfma_f32_32x32x16_bf16 v[64:79], v[40:43], v[56:59], v[64:79]
  s_waitcnt lgkmcnt(0)
  v_mfma_f32_32x32x16_bf16 v[80:95], v[40:43], v[60:63], v[80:95]
  v_mfma_f32_32x32x16_bf16 v[112:127], v[44:47], v[60:63], v[112:127]
  v_mfma_f32_32x32x16_bf16 v[96:111], v[44:47], v[56:59], v[96:111]
  v_add_u32 v8, 139264, v5
  s_nop 6
  v_mul_f32 v64, 0x3bb8aaf4, v64
  v_mul_f32 v65, 0x3bb8aaf4, v65
  v_cvt_pk_bf16_f32 v32, v64, v65
  v_mul_f32 v66, 0x3bb8aaf4, v66
  v_mul_f32 v67, 0x3bb8aaf4, v67
  v_cvt_pk_bf16_f32 v33, v66, v67
  v_mul_f32 v68, 0x3bb8aaf4, v68
  v_mul_f32 v69, 0x3bb8aaf4, v69
  v_cvt_pk_bf16_f32 v34, v68, v69
  v_mul_f32 v70, 0x3bb8aaf4, v70
  v_mul_f32 v71, 0x3bb8aaf4, v71
  v_cvt_pk_bf16_f32 v35, v70, v71
  ds_write_b128 v8, v[32:35] offset:0
  v_mul_f32 v72, 0x3bb8aaf4, v72
  v_mul_f32 v73, 0x3bb8aaf4, v73
  v_cvt_pk_bf16_f32 v36, v72, v73
  v_mul_f32 v74, 0x3bb8aaf4, v74
  v_mul_f32 v75, 0x3bb8aaf4, v75
  v_cvt_pk_bf16_f32 v37, v74, v75
  v_mul_f32 v76, 0x3bb8aaf4, v76
  v_mul_f32 v77, 0x3bb8aaf4, v77
  v_cvt_pk_bf16_f32 v38, v76, v77
  v_mul_f32 v78, 0x3bb8aaf4, v78
  v_mul_f32 v79, 0x3bb8aaf4, v79
  v_cvt_pk_bf16_f32 v39, v78, v79
  ds_write_b128 v8, v[36:39] offset:1024
  v_mul_f32 v96, 0x3bb8aaf4, v96
  v_mul_f32 v97, 0x3bb8aaf4, v97
  v_cvt_pk_bf16_f32 v40, v96, v97
  v_mul_f32 v98, 0x3bb8aaf4, v98
  v_mul_f32 v99, 0x3bb8aaf4, v99
  v_cvt_pk_bf16_f32 v41, v98, v99
  v_mul_f32 v100, 0x3bb8aaf4, v100
  v_mul_f32 v101, 0x3bb8aaf4, v101
  v_cvt_pk_bf16_f32 v42, v100, v101
  v_mul_f32 v102, 0x3bb8aaf4, v102
  v_mul_f32 v103, 0x3bb8aaf4, v103
  v_cvt_pk_bf16_f32 v43, v102, v103
  ds_write_b128 v8, v[40:43] offset:2048
  v_mul_f32 v104, 0x3bb8aaf4, v104
  v_mul_f32 v105, 0x3bb8aaf4, v105
  v_cvt_pk_bf16_f32 v44, v104, v105
  v_mul_f32 v106, 0x3bb8aaf4, v106
  v_mul_f32 v107, 0x3bb8aaf4, v107
  v_cvt_pk_bf16_f32 v45, v106, v107
  v_mul_f32 v108, 0x3bb8aaf4, v108
  v_mul_f32 v109, 0x3bb8aaf4, v109
  v_cvt_pk_bf16_f32 v46, v108, v109
  v_mul_f32 v110, 0x3bb8aaf4, v110
  v_mul_f32 v111, 0x3bb8aaf4, v111
  v_cvt_pk_bf16_f32 v47, v110, v111
  ds_write_b128 v8, v[44:47] offset:3072
  v_mul_f32 v80, 0x3bb8aaf4, v80
  v_mul_f32 v81, 0x3bb8aaf4, v81
  v_cvt_pk_bf16_f32 v48, v80, v81
  v_mul_f32 v82, 0x3bb8aaf4, v82
  v_mul_f32 v83, 0x3bb8aaf4, v83
  v_cvt_pk_bf16_f32 v49, v82, v83
  v_mul_f32 v84, 0x3bb8aaf4, v84
  v_mul_f32 v85, 0x3bb8aaf4, v85
  v_cvt_pk_bf16_f32 v50, v84, v85
  v_mul_f32 v86, 0x3bb8aaf4, v86
  v_mul_f32 v87, 0x3bb8aaf4, v87
  v_cvt_pk_bf16_f32 v51, v86, v87
  ds_write_b128 v8, v[48:51] offset:4096
  v_mul_f32 v88, 0x3bb8aaf4, v88
  v_mul_f32 v89, 0x3bb8aaf4, v89
  v_cvt_pk_bf16_f32 v52, v88, v89
  v_mul_f32 v90, 0x3bb8aaf4, v90
  v_mul_f32 v91, 0x3bb8aaf4, v91
  v_cvt_pk_bf16_f32 v53, v90, v91
  v_mul_f32 v92, 0x3bb8aaf4, v92
  v_mul_f32 v93, 0x3bb8aaf4, v93
  v_cvt_pk_bf16_f32 v54, v92, v93
  v_mul_f32 v94, 0x3bb8aaf4, v94
  v_mul_f32 v95, 0x3bb8aaf4, v95
  v_cvt_pk_bf16_f32 v55, v94, v95
  ds_write_b128 v8, v[52:55] offset:5120
  v_mul_f32 v112, 0x3bb8aaf4, v112
  v_mul_f32 v113, 0x3bb8aaf4, v113
  v_cvt_pk_bf16_f32 v56, v112, v113
  v_mul_f32 v114, 0x3bb8aaf4, v114
  v_mul_f32 v115, 0x3bb8aaf4, v115
  v_cvt_pk_bf16_f32 v57, v114, v115
  v_mul_f32 v116, 0x3bb8aaf4, v116
  v_mul_f32 v117, 0x3bb8aaf4, v117
  v_cvt_pk_bf16_f32 v58, v116, v117
  v_mul_f32 v118, 0x3bb8aaf4, v118
  v_mul_f32 v119, 0x3bb8aaf4, v119
  v_cvt_pk_bf16_f32 v59, v118, v119
  ds_write_b128 v8, v[56:59] offset:6144
  v_mul_f32 v120, 0x3bb8aaf4, v120
  v_mul_f32 v121, 0x3bb8aaf4, v121
  v_cvt_pk_bf16_f32 v60, v120, v121
  v_mul_f32 v122, 0x3bb8aaf4, v122
  v_mul_f32 v123, 0x3bb8aaf4, v123
  v_cvt_pk_bf16_f32 v61, v122, v123
  v_mul_f32 v124, 0x3bb8aaf4, v124
  v_mul_f32 v125, 0x3bb8aaf4, v125
  v_cvt_pk_bf16_f32 v62, v124, v125
  v_mul_f32 v126, 0x3bb8aaf4, v126
  v_mul_f32 v127, 0x3bb8aaf4, v127
  v_cvt_pk_bf16_f32 v63, v126, v127
  ds_write_b128 v8, v[60:63] offset:7168
  v_mov_b32 v100, 0
  v_mov_b32 v101, 0
  v_mov_b32 v102, 0
  v_mov_b32 v103, 0
  v_mov_b32 v104, 0
  v_mov_b32 v105, 0
  v_mov_b32 v106, 0
  v_mov_b32 v107, 0
  v_mov_b32 v108, 0
  v_mov_b32 v109, 0
  v_mov_b32 v110, 0
  v_mov_b32 v111, 0
  v_mov_b32 v112, 0
  v_mov_b32 v113, 0
  v_mov_b32 v114, 0
  v_mov_b32 v115, 0
  s_waitcnt vmcnt(4)
  v_mov_b32 v48, 0x02000200
  v_mov_b32 v49, 0x39a839a8
  s_branch B_ENTRY
A_HROLE:
  v_mul_u32_u24 v228, 448, v11
  v_add_u32 v228, v228, v12
  s_lshl_b32 s67, s66, 7
  s_add_u32 s67, s67, 69504
  v_add_u32 v228, s67, v228
  v_add_u32 v229, 18432, v228
  v_add_u32 v230, 36864, v228
  v_add_u32 v231, 55296, v228
  v_mov_b32 v64, 0
  v_mov_b32 v65, 0
  v_mov_b32 v66, 0
  v_mov_b32 v67, 0
  v_mov_b32 v68, 0
  v_mov_b32 v69, 0
  v_mov_b32 v70, 0
  v_mov_b32 v71, 0
  v_mov_b32 v72, 0
  v_mov_b32 v73, 0
  v_mov_b32 v74, 0
  v_mov_b32 v75, 0
  v_mov_b32 v76, 0
  v_mov_b32 v77, 0
  v_mov_b32 v78, 0
  v_mov_b32 v79, 0
  v_mov_b32 v80, 0
  v_mov_b32 v81, 0
  v_mov_b32 v82, 0
  v_mov_b32 v83, 0
  v_mov_b32 v84, 0
  v_mov_b32 v85, 0
  v_mov_b32 v86, 0
  v_mov_b32 v87, 0
  v_mov_b32 v88, 0
  v_mov_b32 v89, 0
  v_mov_b32 v90, 0
  v_mov_b32 v91, 0
  v_mov_b32 v92, 0
  v_mov_b32 v93, 0
  v_mov_b32 v94, 0
  v_mov_b32 v95, 0
  v_mov_b32 v96, 0
  v_mov_b32 v97, 0
  v_mov_b32 v98, 0
  v_mov_b32 v99, 0
  v_mov_b32 v100, 0
  v_mov_b32 v101, 0
  v_mov_b32 v102, 0
  v_mov_b32 v103, 0
  v_mov_b32 v104, 0
  v_mov_b32 v105, 0
  v_mov_b32 v106, 0
  v_mov_b32 v107, 0
  v_mov_b32 v108, 0
  v_mov_b32 v109, 0
  v_mov_b32 v110, 0
  v_mov_b32 v111, 0
  v_mov_b32 v112, 0
  v_mov_b32 v113, 0
  v_mov_b32 v114, 0
  v_mov_b32 v115, 0
  v_mov_b32 v116, 0
  v_mov_b32 v117, 0
  v_mov_b32 v118, 0
  v_mov_b32 v119, 0
  v_mov_b32 v120, 0
  v_mov_b32 v121, 0
  v_mov_b32 v122, 0
  v_mov_b32 v123, 0
  v_mov_b32 v124, 0
  v_mov_b32 v125, 0
  v_mov_b32 v126, 0
  v_mov_b32 v127, 0
  s_waitcnt vmcnt(13)
  s_barrier
  ds_read_b64_tr_b16 v[32:33], v228 offset:0
  ds_read_b64_tr_b16 v[34:35], v228 offset:1792
  ds_read_b128 v[48:51], v236 offset:0
  ds_read_b128 v[52:55], v236 offset:8192
  ds_read_b64_tr_b16 v[36:37], v228 offset:64
  ds_read_b64_tr_b16 v[38:39], v228 offset:1856
  s_waitcnt lgkmcnt(3)
  v_mfma_f32_32x32x16_bf16 v[64:79], v[32:35], v[48:51], v[64:79]
  ds_read_b64_tr_b16 v[40:41], v228 offset:7168
  ds_read_b64_tr_b16 v[42:43], v228 offset:8960
  ds_read_b128 v[56:59], v237 offset:0
  s_waitcnt lgkmcnt(5)
  v_mfma_f32_32x32x16_bf16 v[80:95], v[32:35], v[52:55], v[80:95]
  ds_read_b128 v[60:63], v237 offset:8192
  s_waitcnt lgkmcnt(4)
  v_mfma_f32_32x32x16_bf16 v[112:127], v[36:39], v[52:55], v[112:127]
  ds_read_b64_tr_b16 v[44:45], v228 offset:7232
  ds_read_b64_tr_b16 v[46:47], v228 offset:9024
  v_mfma_f32_32x32x16_bf16 v[96:111], v[36:39], v[48:51], v[96:111]
  s_waitcnt lgkmcnt(3)
  v_mfma_f32_32x32x16_bf16 v[64:79], v[40:43], v[56:59], v[64:79]
  s_waitcnt vmcnt(8)
  s_waitcnt lgkmcnt(0)
  s_barrier
  ds_read_b64_tr_b16 v[32:33], v229 offset:0
  ds_read_b64_tr_b16 v[34:35], v229 offset:1792
  ds_read_b128 v[48:51], v238 offset:0
  v_mfma_f32_32x32x16_bf16 v[80:95], v[40:43], v[60:63], v[80:95]
  ds_read_b128 v[52:55], v238 offset:8192
  ds_read_b64_tr_b16 v[36:37], v229 offset:64
  ds_read_b64_tr_b16 v[38:39], v229 offset:1856
  v_mfma_f32_32x32x16_bf16 v[112:127], v[44:47], v[60:63], v[112:127]
  v_mfma_f32_32x32x16_bf16 v[96:111], v[44:47], v[56:59], v[96:111]
  s_waitcnt lgkmcnt(3)
  v_mfma_f32_32x32x16_bf16 v[64:79], v[32:35], v[48:51], v[64:79]
  ds_read_b64_tr_b16 v[40:41], v229 offset:7168
  ds_read_b64_tr_b16 v[42:43], v229 offset:8960
  ds_read_b128 v[56:59], v239 offset:0
  s_waitcnt lgkmcnt(5)
  v_mfma_f32_32x32x16_bf16 v[80:95], v[32:35], v[52:55], v[80:95]
  ds_read_b128 v[60:63], v239 offset:8192
  s_waitcnt lgkmcnt(4)
  v_mfma_f32_32x32x16_bf16 v[112:127], v[36:39], v[52:55], v[112:127]
  ds_read_b64_tr_b16 v[44:45], v229 offset:7232
  ds_read_b64_tr_b16 v[46:47], v229 offset:9024
  v_mfma_f32_32x32x16_bf16 v[96:111], v[36:39], v[48:51], v[96:111]
  s_waitcnt lgkmcnt(3)
  v_mfma_f32_32x32x16_bf16 v[64:79], v[40:43], v[56:59], v[64:79]
  s_waitcnt vmcnt(4)
  s_waitcnt vmcnt(0)
  s_waitcnt lgkmcnt(0)
  s_barrier
  ds_read_b64_tr_b16 v[32:33], v230 offset:0
  ds_read_b64_tr_b16 v[34:35], v230 offset:1792
  ds_read_b128 v[48:51], v240 offset:0
  v_mfma_f32_32x32x16_bf16 v[80:95], v[40:43], v[60:63], v[80:95]
  ds_read_b128 v[52:55], v240 offset:8192
  ds_read_b64_tr_b16 v[36:37], v230 offset:64
  ds_read_b64_tr_b16 v[38:39], v230 offset:1856
  v_mfma_f32_32x32x16_bf16 v[112:127], v[44:47], v[60:63], v[112:127]
  v_mfma_f32_32x32x16_bf16 v[96:111], v[44:47], v[56:59], v[96:111]
  s_waitcnt lgkmcnt(3)
  v_mfma_f32_32x32x16_bf16 v[64:79], v[32:35], v[48:51], v[64:79]
  ds_read_b64_tr_b16 v[40:41], v230 offset:7168
  ds_read_b64_tr_b16 v[42:43], v230 offset:8960
  ds_read_b128 v[56:59], v241 offset:0
  s_waitcnt lgkmcnt(5)
  v_mfma_f32_32x32x16_bf16 v[80:95], v[32:35], v[52:55], v[80:95]
  ds_read_b128 v[60:63], v241 offset:8192
  s_waitcnt lgkmcnt(4)
  v_mfma_f32_32x32x16_bf16 v[112:127], v[36:39], v[52:55], v[112:127]
  ds_read_b64_tr_b16 v[44:45], v230 offset:7232
  ds_read_b64_tr_b16 v[46:47], v230 offset:9024
  v_mfma_f32_32x32x16_bf16 v[96:111], v[36:39], v[48:51], v[96:111]
  s_waitcnt lgkmcnt(3)
  v_mfma_f32_32x32x16_bf16 v[64:79], v[40:43], v[56:59], v[64:79]
  s_waitcnt lgkmcnt(0)
  s_barrier
  ds_read_b64_tr_b16 v[32:33], v231 offset:0
  ds_read_b64_tr_b16 v[34:35], v231 offset:1792
  ds_read_b128 v[48:51], v242 offset:0
  v_mfma_f32_32x32x16_bf16 v[80:95], v[40:43], v[60:63], v[80:95]
  ds_read_b128 v[52:55], v242 offset:8192
  ds_read_b64_tr_b16 v[36:37], v231 offset:64
  ds_read_b64_tr_b16 v[38:39], v231 offset:1856
  v_mfma_f32_32x32x16_bf16 v[112:127], v[44:47], v[60:63], v[112:127]
  v_mfma_f32_32x32x16_bf16 v[96:111], v[44:47], v[56:59], v[96:111]
  s_waitcnt lgkmcnt(3)
  v_mfma_f32_32x32x16_bf16 v[64:79], v[32:35], v[48:51], v[64:79]
  ds_read_b64_tr_b16 v[40:41], v231 offset:7168
  ds_read_b64_tr_b16 v[42:43], v231 offset:8960
  ds_read_b128 v[56:59], v243 offset:0
  s_waitcnt lgkmcnt(5)
  v_mfma_f32_32x32x16_bf16 v[80:95], v[32:35], v[52:55], v[80:95]
  ds_read_b128 v[60:63], v243 offset:8192
  s_waitcnt lgkmcnt(4)
  v_mfma_f32_32x32x16_bf16 v[112:127], v[36:39], v[52:55], v[112:127]
  ds_read_b64_tr_b16 v[44:45], v231 offset:7232
  ds_read_b64_tr_b16 v[46:47], v231 offset:9024
  v_mfma_f32_32x32x16_bf16 v[96:111], v[36:39], v[48:51], v[96:111]
  s_waitcnt lgkmcnt(3)
  v_mfma_f32_32x32x16_bf16 v[64:79], v[40:43], v[56:59], v[64:79]
  s_waitcnt lgkmcnt(0)
  s_barrier
  ds_read_b64_tr_b16 v[32:33], v228 offset:0
  ds_read_b64_tr_b16 v[34:35], v228 offset:1792
  ds_read_b128 v[48:51], v236 offset:16384
  v_mfma_f32_32x32x16_bf16 v[80:95], v[40:43], v[60:63], v[80:95]
  ds_read_b128 v[52:55], v236 offset:24576
  ds_read_b64_tr_b16 v[36:37], v228 offset:64
  ds_read_b64_tr_b16 v[38:39], v228 offset:1856
  v_mfma_f32_32x32x16_bf16 v[112:127], v[44:47], v[60:63], v[112:127]
  v_mfma_f32_32x32x16_bf16 v[96:111], v[44:47], v[56:59], v[96:111]
  s_waitcnt lgkmcnt(3)
  v_mfma_f32_32x32x16_bf16 v[64:79], v[32:35], v[48:51], v[64:79]
  ds_read_b64_tr_b16 v[40:41], v228 offset:7168
  ds_read_b64_tr_b16 v[42:43], v228 offset:8960
  ds_read_b128 v[56:59], v237 offset:16384
  s_waitcnt lgkmcnt(5)
  v_mfma_f32_32x32x16_bf16 v[80:95], v[32:35], v[52:55], v[80:95]
  ds_read_b128 v[60:63], v237 offset:24576
  s_waitcnt lgkmcnt(4)
  v_mfma_f32_32x32x16_bf16 v[112:127], v[36:39], v[52:55], v[112:127]
  ds_read_b64_tr_b16 v[44:45], v228 offset:7232
  ds_read_b64_tr_b16 v[46:47], v228 offset:9024
  v_mfma_f32_32x32x16_bf16 v[96:111], v[36:39], v[48:51], v[96:111]
  s_waitcnt lgkmcnt(3)
  v_mfma_f32_32x32x16_bf16 v[64:79], v[40:43], v[56:59], v[64:79]
  s_waitcnt lgkmcnt(0)
  s_barrier
  ds_read_b64_tr_b16 v[32:33], v229 offset:0
  ds_read_b64_tr_b16 v[34:35], v229 offset:1792
  ds_read_b128 v[48:51], v238 offset:16384
  v_mfma_f32_32x32x16_bf16 v[80:95], v[40:43], v[60:63], v[80:95]
  ds_read_b128 v[52:55], v238 offset:24576
  ds_read_b64_tr_b16 v[36:37], v229 offset:64
  ds_read_b64_tr_b16 v[38:39], v229 offset:1856
  v_mfma_f32_32x32x16_bf16 v[112:127], v[44:47], v[60:63], v[112:127]
  v_mfma_f32_32x32x16_bf16 v[96:111], v[44:47], v[56:59], v[96:111]
  s_waitcnt lgkmcnt(3)
  v_mfma_f32_32x32x16_bf16 v[64:79], v[32:35], v[48:51], v[64:79]
  ds_read_b64_tr_b16 v[40:41], v229 offset:7168
  ds_read_b64_tr_b16 v[42:43], v229 offset:8960
  ds_read_b128 v[56:59], v239 offset:16384
  s_waitcnt lgkmcnt(5)
  v_mfma_f32_32x32x16_bf16 v[80:95], v[32:35], v[52:55], v[80:95]
  ds_read_b128 v[60:63], v239 offset:24576
  s_waitcnt lgkmcnt(4)
  v_mfma_f32_32x32x16_bf16 v[112:127], v[36:39], v[52:55], v[112:127]
  ds_read_b64_tr_b16 v[44:45], v229 offset:7232
  ds_read_b64_tr_b16 v[46:47], v229 offset:9024
  v_mfma_f32_32x32x16_bf16 v[96:111], v[36:39], v[48:51], v[96:111]
  s_waitcnt lgkmcnt(3)
  v_mfma_f32_32x32x16_bf16 v[64:79], v[40:43], v[56:59], v[64:79]
  s_waitcnt lgkmcnt(0)
  s_barrier
  ds_read_b64_tr_b16 v[32:33], v230 offset:0
  ds_read_b64_tr_b16 v[34:35], v230 offset:1792
  ds_read_b128 v[48:51], v240 offset:16384
  v_mfma_f32_32x32x16_bf16 v[80:95], v[40:43], v[60:63], v[80:95]
  ds_read_b128 v[52:55], v240 offset:24576
  ds_read_b64_tr_b16 v[36:37], v230 offset:64
  ds_read_b64_tr_b16 v[38:39], v230 offset:1856
  v_mfma_f32_32x32x16_bf16 v[112:127], v[44:47], v[60:63], v[112:127]
  v_mfma_f32_32x32x16_bf16 v[96:111], v[44:47], v[56:59], v[96:111]
  s_waitcnt lgkmcnt(3)
  v_mfma_f32_32x32x16_bf16 v[64:79], v[32:35], v[48:51], v[64:79]
  ds_read_b64_tr_b16 v[40:41], v230 offset:7168
  ds_read_b64_tr_b16 v[42:43], v230 offset:8960
  ds_read_b128 v[56:59], v241 offset:16384
  s_waitcnt lgkmcnt(5)
  v_mfma_f32_32x32x16_bf16 v[80:95], v[32:35], v[52:55], v[80:95]
  ds_read_b128 v[60:63], v241 offset:24576
  s_waitcnt lgkmcnt(4)
  v_mfma_f32_32x32x16_bf16 v[112:127], v[36:39], v[52:55], v[112:127]
  ds_read_b64_tr_b16 v[44:45], v230 offset:7232
  ds_read_b64_tr_b16 v[46:47], v230 offset:9024
  v_mfma_f32_32x32x16_bf16 v[96:111], v[36:39], v[48:51], v[96:111]
  s_waitcnt lgkmcnt(3)
  v_mfma_f32_32x32x16_bf16 v[64:79], v[40:43], v[56:59], v[64:79]
  s_waitcnt lgkmcnt(0)
  s_barrier
  ds_read_b64_tr_b16 v[32:33], v231 offset:0
  ds_read_b64_tr_b16 v[34:35], v231 offset:1792
  ds_read_b128 v[48:51], v242 offset:16384
  v_mfma_f32_32x32x16_bf16 v[80:95], v[40:43], v[60:63], v[80:95]
  ds_read_b128 v[52:55], v242 offset:24576
  ds_read_b64_tr_b16 v[36:37], v231 offset:64
  ds_read_b64_tr_b16 v[38:39], v231 offset:1856
  v_mfma_f32_32x32x16_bf16 v[112:127], v[44:47], v[60:63], v[112:127]
  v_mfma_f32_32x32x16_bf16 v[96:111], v[44:47], v[56:59], v[96:111]
  s_waitcnt lgkmcnt(3)
  v_mfma_f32_32x32x16_bf16 v[64:79], v[32:35], v[48:51], v[64:79]
  ds_read_b64_tr_b16 v[40:41], v231 offset:7168
  ds_read_b64_tr_b16 v[42:43], v231 offset:8960
  ds_read_b128 v[56:59], v243 offset:16384
  s_waitcnt lgkmcnt(5)
  v_mfma_f32_32x32x16_bf16 v[80:95], v[32:35], v[52:55], v[80:95]
  ds_read_b128 v[60:63], v243 offset:24576
  s_waitcnt lgkmcnt(4)
  v_mfma_f32_32x32x16_bf16 v[112:127], v[36:39], v[52:55], v[112:127]
  ds_read_b64_tr_b16 v[44:45], v231 offset:7232
  ds_read_b64_tr_b16 v[46:47], v231 offset:9024
  v_mfma_f32_32x32x16_bf16 v[96:111], v[36:39], v[48:51], v[96:111]
  s_waitcnt lgkmcnt(3)
  v_mfma_f32_32x32x16_bf16 v[64:79], v[40:43], v[56:59], v[64:79]
  s_waitcnt lgkmcnt(0)
  s_barrier
  ds_read_b64_tr_b16 v[32:33], v228 offset:0
  ds_read_b64_tr_b16 v[34:35], v228 offset:1792
  ds_read_b128 v[48:51], v236 offset:32768
  v_mfma_f32_32x32x16_bf16 v[80:95], v[40:43], v[60:63], v[80:95]
  ds_read_b128 v[52:55], v236 offset:40960
  ds_read_b64_tr_b16 v[36:37], v228 offset:64
  ds_read_b64_tr_b16 v[38:39], v228 offset:1856
  v_mfma_f32_32x32x16_bf16 v[112:127], v[44:47], v[60:63], v[112:127]
  v_mfma_f32_32x32x16_bf16 v[96:111], v[44:47], v[56:59], v[96:111]
  s_mov_b32 s16, s66
  s_mov_b32 s17, s64
  s_mov_b32 s18, s65
  s_lshl_b32 s32, s16, 10
  s_lshr_b32 s22, s16, 2
  s_and_b32 s28, s16, 3
  s_and_b32 s30, s16, 1
  s_bfe_u32 s29, s16, 0x10001
  s_lshr_b32 s35, s16, 1
  s_lshl_b32 s23, s18, 2
  s_add_u32 s23, s23, s28
  s_lshl_b32 s33, s17, 1
  s_add_u32 s33, s33, s22
  s_lshl_b32 s33, s33, 5
  s_add_u32 s33, s33, s23
  s_lshl_b32 s33, s33, 10
  s_add_u32 s37, s33, 13631488
  s_mul_i32 s19, s16, 14
  s_lshl_b32 s20, s18, 1
  s_add_u32 s20, s20, s29
  s_mul_i32 s24, s20, 112
  s_xor_b32 s20, s20, 1
  s_mul_i32 s25, s20, 112
  s_lshl_b32 s20, s17, 1
  s_add_u32 s20, s20, s30
  s_mul_i32 s26, s20, 112
  s_xor_b32 s20, s20, 1
  s_mul_i32 s27, s20, 112
  s_add_u32 s24, s24, s19
  s_lshl_b32 s24, s24, 10
  s_add_u32 s24, s24, 10485760
  s_add_u32 s25, s25, s19
  s_lshl_b32 s25, s25, 10
  s_add_u32 s25, s25, 10485760
  s_add_u32 s26, s26, s19
  s_lshl_b32 s26, s26, 10
  s_add_u32 s26, s26, 3145728
  s_add_u32 s27, s27, s19
  s_lshl_b32 s27, s27, 10
  s_add_u32 s27, s27, 3145728
  s_lshl_b32 s19, s17, 8
  s_add_u32 s19, s19, 2240512
  s_lshl_b32 s20, s18, 5
  s_add_u32 s50, s19, s20
  s_lshl_b32 s20, s16, 2
  s_add_u32 s50, s50, s20
  s_lshl_b32 s20, s16, 5
  s_add_u32 s51, s19, s20
  v_and_b32 v249, 7, v1
  v_lshlrev_b32 v249, 2, v249
  v_and_b32 v8, 31, v1
  v_lshrrev_b32 v9, 5, v1
  v_and_b32 v10, 11, v1
  v_cmp_eq_u32 vcc, 0, v10
  v_mov_b32 v10, 0x3c003c00
  s_nop 0
  v_cndmask_b32 v132, 0, v10, vcc
  v_mov_b32 v133, v132
  v_mov_b32 v134, v132
  v_mov_b32 v135, v132
  s_lshl_b32 s19, s16, 10
  s_add_u32 s19, s19, 155648
  v_add_u32 v10, s19, v5
  ds_write_b128 v10, v[132:135]
  s_nop 1
  v_lshlrev_b32 v10, 8, v9
  v_lshl_add_u32 v10, v8, 4, v10
  v_add_u32 v10, 65536, v10
  v_subrev_u32 v11, 20, v8
  v_cmp_gt_u32 vcc, 8, v11
  v_mov_b32 v11, 155648
  v_mov_b32 v12, 155712
  v_cndmask_b32 v11, v11, v12, vcc
  v_and_b32 v12, 11, v8
  v_cmp_ne_u32 vcc, 0, v12
  v_add_u32 v12, 16, v11
  s_nop 0
  v_cndmask_b32 v11, v11, v12, vcc
  v_cmp_gt_u32 vcc, 16, v8
  s_nop 1
  v_cndmask_b32 v3, v11, v10, vcc
  v_mov_b32 v11, 8192
  v_cndmask_b32 v4, 0, v11, vcc
  v_lshlrev_b32 v6, 2, v8
  v_mov_b32 v136, 0
  v_mov_b32 v137, 0
  v_mov_b32 v138, 0
  v_mov_b32 v139, 0
  v_mov_b32 v140, 0
  v_mov_b32 v141, 0
  v_mov_b32 v142, 0
  v_mov_b32 v143, 0
  v_mov_b32 v144, 0
  v_mov_b32 v145, 0
  v_mov_b32 v146, 0
  v_mov_b32 v147, 0
  v_mov_b32 v148, 0
  v_mov_b32 v149, 0
  v_mov_b32 v150, 0
  v_mov_b32 v151, 0
  v_mov_b32 v152, 0
  v_mov_b32 v153, 0
  v_mov_b32 v154, 0
  v_mov_b32 v155, 0
  v_mov_b32 v156, 0
  v_mov_b32 v157, 0
  v_mov_b32 v158, 0
  v_mov_b32 v159, 0
  v_mov_b32 v160, 0
  v_mov_b32 v161, 0
  v_mov_b32 v162, 0
  v_mov_b32 v163, 0
  v_mov_b32 v164, 0
  v_mov_b32 v165, 0
  v_mov_b32 v166, 0
  v_mov_b32 v167, 0
  v_mov_b32 v168, 0
  v_mov_b32 v169, 0
  v_mov_b32 v170, 0
  v_mov_b32 v171, 0
  v_mov_b32 v172, 0
  v_mov_b32 v173, 0
  v_mov_b32 v174, 0
  v_mov_b32 v175, 0
  v_mov_b32 v176, 0
  v_mov_b32 v177, 0
  v_mov_b32 v178, 0
  v_mov_b32 v179, 0
  v_mov_b32 v180, 0
  v_mov_b32 v181, 0
  v_mov_b32 v182, 0
  v_mov_b32 v183, 0
  v_mov_b32 v184, 0
  v_mov_b32 v185, 0
  v_mov_b32 v186, 0
  v_mov_b32 v187, 0
  v_mov_b32 v188, 0
  v_mov_b32 v189, 0
  v_mov_b32 v190, 0
  v_mov_b32 v191, 0
  v_mov_b32 v192, 0
  v_mov_b32 v193, 0
  v_mov_b32 v194, 0
  v_mov_b32 v195, 0
  v_mov_b32 v132, 0
  v_mov_b32 v133, 0
  v_mov_b32 v134, 0
  v_mov_b32 v135, 0
  s_lshl_b32 s19, s16, 13
  s_add_u32 s19, s19, 32768
  s_cmp_ge_u32 s16, 3
  s_cselect_b32 s20, 40960, 0
  s_add_u32 s19, s19, s20
  s_cmp_ge_u32 s16, 6
  s_cselect_b32 s20, 16384, 0
  s_add_u32 s19, s19, s20
  v_add_u32 v2, s19, v5
  s_xor_b32 s3, s16, 1
  s_lshl_b32 s19, s3, 13
  s_add_u32 s19, s19, 32768
  s_cmp_ge_u32 s3, 3
  s_cselect_b32 s20, 40960, 0
  s_add_u32 s19, s19, s20
  s_cmp_ge_u32 s3, 6
  s_cselect_b32 s20, 16384, 0
  s_add_u32 s19, s19, s20
  v_add_u32 v21, s19, v5
  s_lshl_b32 s20, s17, 1
  s_add_u32 s20, s20, s30
  s_lshl_b32 s20, s20, 5
  s_lshl_b32 s19, s35, 3
  s_add_u32 s20, s20, s19
  s_lshl_b32 s20, s20, 10
  s_add_u32 s36, s20, 13631488
  s_lshl_b32 s19, s16, 16
  s_lshl_b32 s20, s18, 7
  s_add_u32 s38, s19, s20
  v_lshrrev_b32 v14, 3, v1
  v_and_b32 v20, 7, v1
  v_bfe_u32 v13, v14, 1, 1
  v_lshlrev_b32 v13, 2, v13
  v_xor_b32 v20, v20, v13
  v_lshlrev_b32 v20, 4, v20
  v_lshl_add_u32 v20, v14, 10, v20
  s_waitcnt lgkmcnt(0)
  s_waitcnt lgkmcnt(3)
  v_mfma_f32_32x32x16_bf16 v[64:79], v[32:35], v[48:51], v[64:79]
  ds_read_b64_tr_b16 v[40:41], v228 offset:7168
  ds_read_b64_tr_b16 v[42:43], v228 offset:8960
  ds_read_b128 v[56:59], v237 offset:32768
  s_waitcnt lgkmcnt(5)
  v_mfma_f32_32x32x16_bf16 v[80:95], v[32:35], v[52:55], v[80:95]
  ds_read_b128 v[60:63], v237 offset:40960
  s_waitcnt lgkmcnt(4)
  v_mfma_f32_32x32x16_bf16 v[112:127], v[36:39], v[52:55], v[112:127]
  ds_read_b64_tr_b16 v[44:45], v228 offset:7232
  ds_read_b64_tr_b16 v[46:47], v228 offset:9024
  v_mfma_f32_32x32x16_bf16 v[96:111], v[36:39], v[48:51], v[96:111]
  s_waitcnt lgkmcnt(3)
  v_mfma_f32_32x32x16_bf16 v[64:79], v[40:43], v[56:59], v[64:79]
  s_waitcnt lgkmcnt(0)
  s_barrier
  ds_read_b64_tr_b16 v[32:33], v229 offset:0
  ds_read_b64_tr_b16 v[34:35], v229 offset:1792
  ds_read_b128 v[48:51], v238 offset:32768
  v_mfma_f32_32x32x16_bf16 v[80:95], v[40:43], v[60:63], v[80:95]
  ds_read_b128 v[52:55], v238 offset:40960
  ds_read_b64_tr_b16 v[36:37], v229 offset:64
  ds_read_b64_tr_b16 v[38:39], v229 offset:1856
  v_mfma_f32_32x32x16_bf16 v[112:127], v[44:47], v[60:63], v[112:127]
  v_mfma_f32_32x32x16_bf16 v[96:111], v[44:47], v[56:59], v[96:111]
  s_waitcnt lgkmcnt(3)
  v_mfma_f32_32x32x16_bf16 v[64:79], v[32:35], v[48:51], v[64:79]
  ds_read_b64_tr_b16 v[40:41], v229 offset:7168
  ds_read_b64_tr_b16 v[42:43], v229 offset:8960
  ds_read_b128 v[56:59], v239 offset:32768
  s_waitcnt lgkmcnt(5)
  v_mfma_f32_32x32x16_bf16 v[80:95], v[32:35], v[52:55], v[80:95]
  ds_read_b128 v[60:63], v239 offset:40960
  s_waitcnt lgkmcnt(4)
  v_mfma_f32_32x32x16_bf16 v[112:127], v[36:39], v[52:55], v[112:127]
  ds_read_b64_tr_b16 v[44:45], v229 offset:7232
  ds_read_b64_tr_b16 v[46:47], v229 offset:9024
  v_mfma_f32_32x32x16_bf16 v[96:111], v[36:39], v[48:51], v[96:111]
  s_waitcnt lgkmcnt(3)
  v_mfma_f32_32x32x16_bf16 v[64:79], v[40:43], v[56:59], v[64:79]
  s_waitcnt lgkmcnt(0)
  s_barrier
  ds_read_b64_tr_b16 v[32:33], v230 offset:0
  ds_read_b64_tr_b16 v[34:35], v230 offset:1792
  ds_read_b128 v[48:51], v240 offset:32768
  v_mfma_f32_32x32x16_bf16 v[80:95], v[40:43], v[60:63], v[80:95]
  ds_read_b128 v[52:55], v240 offset:40960
  ds_read_b64_tr_b16 v[36:37], v230 offset:64
  ds_read_b64_tr_b16 v[38:39], v230 offset:1856
  v_mfma_f32_32x32x16_bf16 v[112:127], v[44:47], v[60:63], v[112:127]
  v_mfma_f32_32x32x16_bf16 v[96:111], v[44:47], v[56:59], v[96:111]
  s_waitcnt lgkmcnt(3)
  v_mfma_f32_32x32x16_bf16 v[64:79], v[32:35], v[48:51], v[64:79]
  ds_read_b64_tr_b16 v[40:41], v230 offset:7168
  ds_read_b64_tr_b16 v[42:43], v230 offset:8960
  ds_read_b128 v[56:59], v241 offset:32768
  s_waitcnt lgkmcnt(5)
  v_mfma_f32_32x32x16_bf16 v[80:95], v[32:35], v[52:55], v[80:95]
  ds_read_b128 v[60:63], v241 offset:40960
  s_waitcnt lgkmcnt(4)
  v_mfma_f32_32x32x16_bf16 v[112:127], v[36:39], v[52:55], v[112:127]
  ds_read_b64_tr_b16 v[44:45], v230 offset:7232
  ds_read_b64_tr_b16 v[46:47], v230 offset:9024
  v_mfma_f32_32x32x16_bf16 v[96:111], v[36:39], v[48:51], v[96:111]
  s_waitcnt lgkmcnt(3)
  v_mfma_f32_32x32x16_bf16 v[64:79], v[40:43], v[56:59], v[64:79]
  s_waitcnt lgkmcnt(0)
  s_barrier
  ds_read_b64_tr_b16 v[32:33], v231 offset:0
  ds_read_b64_tr_b16 v[34:35], v231 offset:1792
  ds_read_b128 v[48:51], v242 offset:32768
  v_mfma_f32_32x32x16_bf16 v[80:95], v[40:43], v[60:63], v[80:95]
  ds_read_b128 v[52:55], v242 offset:40960
  ds_read_b64_tr_b16 v[36:37], v231 offset:64
  ds_read_b64_tr_b16 v[38:39], v231 offset:1856
  v_mfma_f32_32x32x16_bf16 v[112:127], v[44:47], v[60:63], v[112:127]
  v_mfma_f32_32x32x16_bf16 v[96:111], v[44:47], v[56:59], v[96:111]
  s_waitcnt lgkmcnt(3)
  v_mfma_f32_32x32x16_bf16 v[64:79], v[32:35], v[48:51], v[64:79]
  ds_read_b64_tr_b16 v[40:41], v231 offset:7168
  ds_read_b64_tr_b16 v[42:43], v231 offset:8960
  ds_read_b128 v[56:59], v243 offset:32768
  s_waitcnt lgkmcnt(5)
  v_mfma_f32_32x32x16_bf16 v[80:95], v[32:35], v[52:55], v[80:95]
  ds_read_b128 v[60:63], v243 offset:40960
  s_waitcnt lgkmcnt(4)
  v_mfma_f32_32x32x16_bf16 v[112:127], v[36:39], v[52:55], v[112:127]
  ds_read_b64_tr_b16 v[44:45], v231 offset:7232
  ds_read_b64_tr_b16 v[46:47], v231 offset:9024
  v_mfma_f32_32x32x16_bf16 v[96:111], v[36:39], v[48:51], v[96:111]
  s_waitcnt lgkmcnt(3)
  v_mfma_f32_32x32x16_bf16 v[64:79], v[40:43], v[56:59], v[64:79]
  s_waitcnt lgkmcnt(0)
  s_barrier
  ds_read_b64_tr_b16 v[32:33], v228 offset:0
  ds_read_b64_tr_b16 v[34:35], v228 offset:1792
  ds_read_b128 v[48:51], v236 offset:49152
  v_mfma_f32_32x32x16_bf16 v[80:95], v[40:43], v[60:63], v[80:95]
  ds_read_b128 v[52:55], v236 offset:57344
  ds_read_b64_tr_b16 v[36:37], v228 offset:64
  ds_read_b64_tr_b16 v[38:39], v228 offset:1856
  v_mfma_f32_32x32x16_bf16 v[112:127], v[44:47], v[60:63], v[112:127]
  v_mfma_f32_32x32x16_bf16 v[96:111], v[44:47], v[56:59], v[96:111]
  s_waitcnt lgkmcnt(3)
  v_mfma_f32_32x32x16_bf16 v[64:79], v[32:35], v[48:51], v[64:79]
  ds_read_b64_tr_b16 v[40:41], v228 offset:7168
  ds_read_b64_tr_b16 v[42:43], v228 offset:8960
  ds_read_b128 v[56:59], v237 offset:49152
  s_waitcnt lgkmcnt(5)
  v_mfma_f32_32x32x16_bf16 v[80:95], v[32:35], v[52:55], v[80:95]
  ds_read_b128 v[60:63], v237 offset:57344
  s_waitcnt lgkmcnt(4)
  v_mfma_f32_32x32x16_bf16 v[112:127], v[36:39], v[52:55], v[112:127]
  ds_read_b64_tr_b16 v[44:45], v228 offset:7232
  ds_read_b64_tr_b16 v[46:47], v228 offset:9024
  v_mfma_f32_32x32x16_bf16 v[96:111], v[36:39], v[48:51], v[96:111]
  s_waitcnt lgkmcnt(3)
  v_mfma_f32_32x32x16_bf16 v[64:79], v[40:43], v[56:59], v[64:79]
  s_waitcnt lgkmcnt(0)
  s_barrier
  ds_read_b64_tr_b16 v[32:33], v229 offset:0
  ds_read_b64_tr_b16 v[34:35], v229 offset:1792
  ds_read_b128 v[48:51], v238 offset:49152
  v_mfma_f32_32x32x16_bf16 v[80:95], v[40:43], v[60:63], v[80:95]
  ds_read_b128 v[52:55], v238 offset:57344
  ds_read_b64_tr_b16 v[36:37], v229 offset:64
  ds_read_b64_tr_b16 v[38:39], v229 offset:1856
  v_mfma_f32_32x32x16_bf16 v[112:127], v[44:47], v[60:63], v[112:127]
  v_mfma_f32_32x32x16_bf16 v[96:111], v[44:47], v[56:59], v[96:111]
  s_waitcnt lgkmcnt(3)
  v_mfma_f32_32x32x16_bf16 v[64:79], v[32:35], v[48:51], v[64:79]
  ds_read_b64_tr_b16 v[40:41], v229 offset:7168
  ds_read_b64_tr_b16 v[42:43], v229 offset:8960
  ds_read_b128 v[56:59], v239 offset:49152
  s_waitcnt lgkmcnt(5)
  v_mfma_f32_32x32x16_bf16 v[80:95], v[32:35], v[52:55], v[80:95]
  ds_read_b128 v[60:63], v239 offset:57344
  s_waitcnt lgkmcnt(4)
  v_mfma_f32_32x32x16_bf16 v[112:127], v[36:39], v[52:55], v[112:127]
  ds_read_b64_tr_b16 v[44:45], v229 offset:7232
  ds_read_b64_tr_b16 v[46:47], v229 offset:9024
  v_mfma_f32_32x32x16_bf16 v[96:111], v[36:39], v[48:51], v[96:111]
  s_waitcnt lgkmcnt(3)
  v_mfma_f32_32x32x16_bf16 v[64:79], v[40:43], v[56:59], v[64:79]
  s_waitcnt lgkmcnt(0)
  s_barrier
  ds_read_b64_tr_b16 v[32:33], v230 offset:0
  ds_read_b64_tr_b16 v[34:35], v230 offset:1792
  ds_read_b128 v[48:51], v240 offset:49152
  v_mfma_f32_32x32x16_bf16 v[80:95], v[40:43], v[60:63], v[80:95]
  ds_read_b128 v[52:55], v240 offset:57344
  ds_read_b64_tr_b16 v[36:37], v230 offset:64
  ds_read_b64_tr_b16 v[38:39], v230 offset:1856
  v_mfma_f32_32x32x16_bf16 v[112:127], v[44:47], v[60:63], v[112:127]
  v_mfma_f32_32x32x16_bf16 v[96:111], v[44:47], v[56:59], v[96:111]
  s_mov_b32 m0, s32
  s_add_u32 s32, s32, 2097152
  buffer_load_dwordx4 v5, s[8:11], s32 offen sc1 lds
  s_add_u32 m0, m0, 65536
  s_add_u32 s32, s32, 65536
  buffer_load_dwordx4 v5, s[8:11], s32 offen sc1 lds
  s_sub_u32 m0, m0, 57344
  s_sub_u32 s32, s32, 57344
  buffer_load_dwordx4 v5, s[8:11], s32 offen sc1 lds
  s_add_u32 m0, m0, 65536
  s_add_u32 s32, s32, 65536
  buffer_load_dwordx4 v5, s[8:11], s32 offen sc1 lds
  s_sub_u32 m0, m0, 57344
  s_sub_u32 s32, s32, 57344
  s_mov_b32 s31, 2236416
  buffer_load_dwordx4 v[244:247], v5, s[8:11], s31 offen sc1
  buffer_load_dwordx4 v[196:199], v5, s[8:11], s24 offen offset:0 sc1
  buffer_load_dwordx4 v[200:203], v5, s[8:11], s25 offen offset:0 sc1
  buffer_load_dwordx4 v[212:215], v5, s[8:11], s24 offen offset:1024 sc1
  buffer_load_dwordx4 v[216:219], v5, s[8:11], s25 offen offset:1024 sc1
  s_waitcnt lgkmcnt(3)
  v_mfma_f32_32x32x16_bf16 v[64:79], v[32:35], v[48:51], v[64:79]
  ds_read_b64_tr_b16 v[40:41], v230 offset:7168
  ds_read_b64_tr_b16 v[42:43], v230 offset:8960
  ds_read_b128 v[56:59], v241 offset:49152
  s_waitcnt lgkmcnt(5)
  v_mfma_f32_32x32x16_bf16 v[80:95], v[32:35], v[52:55], v[80:95]
  ds_read_b128 v[60:63], v241 offset:57344
  s_waitcnt lgkmcnt(4)
  v_mfma_f32_32x32x16_bf16 v[112:127], v[36:39], v[52:55], v[112:127]
  ds_read_b64_tr_b16 v[44:45], v230 offset:7232
  ds_read_b64_tr_b16 v[46:47], v230 offset:9024
  v_mfma_f32_32x32x16_bf16 v[96:111], v[36:39], v[48:51], v[96:111]
  s_waitcnt lgkmcnt(3)
  v_mfma_f32_32x32x16_bf16 v[64:79], v[40:43], v[56:59], v[64:79]
  s_waitcnt lgkmcnt(0)
  s_barrier
  ds_read_b64_tr_b16 v[32:33], v231 offset:0
  ds_read_b64_tr_b16 v[34:35], v231 offset:1792
  ds_read_b128 v[48:51], v242 offset:49152
  v_mfma_f32_32x32x16_bf16 v[80:95], v[40:43], v[60:63], v[80:95]
  ds_read_b128 v[52:55], v242 offset:57344
  ds_read_b64_tr_b16 v[36:37], v231 offset:64
  ds_read_b64_tr_b16 v[38:39], v231 offset:1856
  v_mfma_f32_32x32x16_bf16 v[112:127], v[44:47], v[60:63], v[112:127]
  v_mfma_f32_32x32x16_bf16 v[96:111], v[44:47], v[56:59], v[96:111]
  s_waitcnt lgkmcnt(3)
  v_mfma_f32_32x32x16_bf16 v[64:79], v[32:35], v[48:51], v[64:79]
  ds_read_b64_tr_b16 v[40:41], v231 offset:7168
  ds_read_b64_tr_b16 v[42:43], v231 offset:8960
  ds_read_b128 v[56:59], v243 offset:49152
  s_waitcnt lgkmcnt(5)
  v_mfma_f32_32x32x16_bf16 v[80:95], v[32:35], v[52:55], v[80:95]
  ds_read_b128 v[60:63], v243 offset:57344
  s_waitcnt lgkmcnt(4)
  v_mfma_f32_32x32x16_bf16 v[112:127], v[36:39], v[52:55], v[112:127]
  ds_read_b64_tr_b16 v[44:45], v231 offset:7232
  ds_read_b64_tr_b16 v[46:47], v231 offset:9024
  v_mfma_f32_32x32x16_bf16 v[96:111], v[36:39], v[48:51], v[96:111]
  s_waitcnt lgkmcnt(3)
  v_mfma_f32_32x32x16_bf16 v[64:79], v[40:43], v[56:59], v[64:79]
  s_waitcnt lgkmcnt(0)
  v_mfma_f32_32x32x16_bf16 v[80:95], v[40:43], v[60:63], v[80:95]
  v_mfma_f32_32x32x16_bf16 v[112:127], v[44:47], v[60:63], v[112:127]
  v_mfma_f32_32x32x16_bf16 v[96:111], v[44:47], v[56:59], v[96:111]
  s_mul_i32 s67, s64, 224
  s_mul_i32 s68, s65, 14
  s_add_u32 s67, s67, s68
  s_lshl_b32 s68, s66, 2
  s_add_u32 s67, s67, s68
  s_lshl_b32 s67, s67, 10
  s_add_u32 s67, s67, 3141632
  s_add_u32 s68, s67, 114688
  v_cvt_pk_bf16_f32 v32, v64, v65
  v_pk_max_i16 v32, v32, 0
  v_cvt_pk_bf16_f32 v33, v66, v67
  v_pk_max_i16 v33, v33, 0
  v_cvt_pk_bf16_f32 v34, v68, v69
  v_pk_max_i16 v34, v34, 0
  v_cvt_pk_bf16_f32 v35, v70, v71
  v_pk_max_i16 v35, v35, 0
  buffer_store_dwordx4 v[32:35], v5, s[8:11], s67 offen offset:0 sc1
  v_cvt_pk_bf16_f32 v36, v72, v73
  v_pk_max_i16 v36, v36, 0
  v_cvt_pk_bf16_f32 v37, v74, v75
  v_pk_max_i16 v37, v37, 0
  v_cvt_pk_bf16_f32 v38, v76, v77
  v_pk_max_i16 v38, v38, 0
  v_cvt_pk_bf16_f32 v39, v78, v79
  v_pk_max_i16 v39, v39, 0
  buffer_store_dwordx4 v[36:39], v5, s[8:11], s67 offen offset:1024 sc1
  v_cvt_pk_bf16_f32 v40, v96, v97
  v_pk_max_i16 v40, v40, 0
  v_cvt_pk_bf16_f32 v41, v98, v99
  v_pk_max_i16 v41, v41, 0
  v_cvt_pk_bf16_f32 v42, v100, v101
  v_pk_max_i16 v42, v42, 0
  v_cvt_pk_bf16_f32 v43, v102, v103
  v_pk_max_i16 v43, v43, 0
  buffer_store_dwordx4 v[40:43], v5, s[8:11], s67 offen offset:2048 sc1
  v_cvt_pk_bf16_f32 v44, v104, v105
  v_pk_max_i16 v44, v44, 0
  v_cvt_pk_bf16_f32 v45, v106, v107
  v_pk_max_i16 v45, v45, 0
  v_cvt_pk_bf16_f32 v46, v108, v109
  v_pk_max_i16 v46, v46, 0
  v_cvt_pk_bf16_f32 v47, v110, v111
  v_pk_max_i16 v47, v47, 0
  buffer_store_dwordx4 v[44:47], v5, s[8:11], s67 offen offset:3072 sc1
  v_cvt_pk_bf16_f32 v48, v80, v81
  v_pk_max_i16 v48, v48, 0
  v_cvt_pk_bf16_f32 v49, v82, v83
  v_pk_max_i16 v49, v49, 0
  v_cvt_pk_bf16_f32 v50, v84, v85
  v_pk_max_i16 v50, v50, 0
  v_cvt_pk_bf16_f32 v51, v86, v87
  v_pk_max_i16 v51, v51, 0
  buffer_store_dwordx4 v[48:51], v5, s[8:11], s68 offen offset:0 sc1
  v_cvt_pk_bf16_f32 v52, v88, v89
  v_pk_max_i16 v52, v52, 0
  v_cvt_pk_bf16_f32 v53, v90, v91
  v_pk_max_i16 v53, v53, 0
  v_cvt_pk_bf16_f32 v54, v92, v93
  v_pk_max_i16 v54, v54, 0
  v_cvt_pk_bf16_f32 v55, v94, v95
  v_pk_max_i16 v55, v55, 0
  buffer_store_dwordx4 v[52:55], v5, s[8:11], s68 offen offset:1024 sc1
  v_cvt_pk_bf16_f32 v56, v112, v113
  v_pk_max_i16 v56, v56, 0
  v_cvt_pk_bf16_f32 v57, v114, v115
  v_pk_max_i16 v57, v57, 0
  v_cvt_pk_bf16_f32 v58, v116, v117
  v_pk_max_i16 v58, v58, 0
  v_cvt_pk_bf16_f32 v59, v118, v119
  v_pk_max_i16 v59, v59, 0
  buffer_store_dwordx4 v[56:59], v5, s[8:11], s68 offen offset:2048 sc1
  v_cvt_pk_bf16_f32 v60, v120, v121
  v_pk_max_i16 v60, v60, 0
  v_cvt_pk_bf16_f32 v61, v122, v123
  v_pk_max_i16 v61, v61, 0
  v_cvt_pk_bf16_f32 v62, v124, v125
  v_pk_max_i16 v62, v62, 0
  v_cvt_pk_bf16_f32 v63, v126, v127
  v_pk_max_i16 v63, v63, 0
  buffer_store_dwordx4 v[60:63], v5, s[8:11], s68 offen offset:3072 sc1
  v_mov_b32 v100, 0
  v_mov_b32 v101, 0
  v_mov_b32 v102, 0
  v_mov_b32 v103, 0
  v_mov_b32 v104, 0
  v_mov_b32 v105, 0
  v_mov_b32 v106, 0
  v_mov_b32 v107, 0
  v_mov_b32 v108, 0
  v_mov_b32 v109, 0
  v_mov_b32 v110, 0
  v_mov_b32 v111, 0
  v_mov_b32 v112, 0
  v_mov_b32 v113, 0
  v_mov_b32 v114, 0
  v_mov_b32 v115, 0
  s_waitcnt vmcnt(12)
  v_mov_b32 v48, 0x02000200
  v_mov_b32 v49, 0x39a839a8
  s_branch B_ENTRY
A_LOADER:
  v_lshrrev_b32 v8, 3, v1
  v_bfe_u32 v9, v8, 1, 1
  v_lshlrev_b32 v9, 2, v9
  v_and_b32 v10, 7, v1
  v_xor_b32 v10, v10, v9
  v_lshlrev_b32 v10, 4, v10
  v_lshl_add_u32 v250, v8, 10, v10
  s_lshl_b32 s67, s92, 13
  s_lshl_b32 s68, s65, 7
  s_add_u32 s78, s67, s68
  s_mul_i32 s93, s92, 3
  s_lshr_b32 s67, s92, 1
  s_and_b32 s67, s67, s92
  s_add_u32 s93, s93, s67
  s_lshl_b32 s67, s93, 6
  v_add_u32 v8, s67, v1
  v_mul_u32_u24 v9, 2341, v8
  v_lshrrev_b32 v9, 16, v9
  v_mul_u32_u24 v10, 28, v9
  v_sub_u32 v10, v8, v10
  v_mul_u32_u24 v9, 3584, v9
  v_lshl_add_u32 v251, v10, 4, v9
  v_add_u32 v8, s67, v1
  v_add_u32 v8, 64, v8
  v_mul_u32_u24 v9, 2341, v8
  v_lshrrev_b32 v9, 16, v9
  v_mul_u32_u24 v10, 28, v9
  v_sub_u32 v10, v8, v10
  v_mul_u32_u24 v9, 3584, v9
  v_lshl_add_u32 v252, v10, 4, v9
  v_add_u32 v8, s67, v1
  v_add_u32 v8, 128, v8
  v_mul_u32_u24 v9, 2341, v8
  v_lshrrev_b32 v9, 16, v9
  v_mul_u32_u24 v10, 28, v9
  v_sub_u32 v10, v8, v10
  v_mul_u32_u24 v9, 3584, v9
  v_lshl_add_u32 v253, v10, 4, v9
  v_add_u32 v8, s67, v1
  v_add_u32 v8, 192, v8
  v_mul_u32_u24 v9, 2341, v8
  v_lshrrev_b32 v9, 16, v9
  v_mul_u32_u24 v10, 28, v9
  v_sub_u32 v10, v8, v10
  v_mul_u32_u24 v9, 3584, v9
  v_lshl_add_u32 v254, v10, 4, v9
  s_mul_i32 s79, s65, 448
  s_lshl_b32 s93, s93, 10
  s_add_u32 s93, s93, 4096
  s_lshl_b32 s82, s81, 2
  v_lshrrev_b32 v13, 2, v1
  v_lshlrev_b32 v13, 10, v13
  v_and_b32 v14, 3, v1
  v_lshl_add_u32 v255, v14, 4, v13
  s_lshl_b32 s94, s64, 3
  s_add_u32 s94, s94, s65
  s_and_b32 s68, s94, 15
  s_lshl_b32 s68, s68, 6
  s_lshr_b32 s94, s94, 4
  s_mul_i32 s94, s94, 114688
  s_add_u32 s94, s94, s68
  s_waitcnt lgkmcnt(0)
  s_mov_b32 s44, s18
  s_mov_b32 s45, s19
  s_mov_b32 s46, 524288
  s_mov_b32 s47, 0x00020000
  s_mov_b32 s40, s28
  s_mov_b32 s41, s29
  s_mov_b32 s42, 1835008
  s_mov_b32 s43, 0x00020000
  s_mov_b32 s36, s16
  s_mov_b32 s37, s17
  s_mov_b32 s38, 2097152
  s_mov_b32 s39, 0x00020000
  s_cmp_ge_u32 s66, 6
  s_cbranch_scc1 A_L67
  s_lshl_b32 s67, s92, 10
  s_add_u32 m0, s67, 65536
  s_lshl_b32 s67, s82, 15
  s_add_u32 s67, s67, s78
  buffer_load_dwordx4 v250, s[44:47], s67 offen lds
  s_add_u32 m0, s93, 65536
  s_mul_i32 s67, s82, 114688
  s_add_u32 s67, s67, s79
  buffer_load_dwordx4 v251, s[40:43], s67 offen lds
  s_add_u32 m0, m0, 1024
  s_nop 0
  buffer_load_dwordx4 v252, s[40:43], s67 offen lds
  s_add_u32 m0, m0, 1024
  s_nop 0
  buffer_load_dwordx4 v253, s[40:43], s67 offen lds
  s_add_u32 s82, s82, 1
  s_and_b32 s82, s82, 15
  s_lshl_b32 s67, s92, 10
  s_add_u32 m0, s67, 83968
  s_lshl_b32 s67, s82, 15
  s_add_u32 s67, s67, s78
  buffer_load_dwordx4 v250, s[44:47], s67 offen lds
  s_add_u32 m0, s93, 83968
  s_mul_i32 s67, s82, 114688
  s_add_u32 s67, s67, s79
  buffer_load_dwordx4 v251, s[40:43], s67 offen lds
  s_add_u32 m0, m0, 1024
  s_nop 0
  buffer_load_dwordx4 v252, s[40:43], s67 offen lds
  s_add_u32 m0, m0, 1024
  s_nop 0
  buffer_load_dwordx4 v253, s[40:43], s67 offen lds
  s_add_u32 s82, s82, 1
  s_and_b32 s82, s82, 15
  s_add_u32 s67, s81, 1
  s_and_b32 s67, s67, 3
  s_add_u32 m0, s83, 16384
  s_lshl_b32 s67, s67, 8
  s_add_u32 s67, s67, s72
  buffer_load_dwordx4 v16, s[36:39], s67 offen lds
  s_add_u32 m0, m0, 1024
  s_add_u32 s67, s67, 4096
  buffer_load_dwordx4 v17, s[36:39], s67 offen lds
  s_add_u32 m0, m0, 1024
  s_add_u32 s67, s67, 4096
  buffer_load_dwordx4 v18, s[36:39], s67 offen lds
  s_add_u32 m0, m0, 1024
  s_add_u32 s67, s67, 4096
  buffer_load_dwordx4 v19, s[36:39], s67 offen lds
  s_lshl_b32 s67, s92, 10
  s_add_u32 m0, s67, 102400
  s_lshl_b32 s67, s82, 15
  s_add_u32 s67, s67, s78
  buffer_load_dwordx4 v250, s[44:47], s67 offen lds
  s_add_u32 m0, s93, 102400
  s_mul_i32 s67, s82, 114688
  s_add_u32 s67, s67, s79
  buffer_load_dwordx4 v251, s[40:43], s67 offen lds
  s_add_u32 m0, m0, 1024
  s_nop 0
  buffer_load_dwordx4 v252, s[40:43], s67 offen lds
  s_add_u32 m0, m0, 1024
  s_nop 0
  buffer_load_dwordx4 v253, s[40:43], s67 offen lds
  s_add_u32 s82, s82, 1
  s_and_b32 s82, s82, 15
  s_lshl_b32 s67, s92, 10
  s_add_u32 m0, s67, 120832
  s_lshl_b32 s67, s82, 15
  s_add_u32 s67, s67, s78
  buffer_load_dwordx4 v250, s[44:47], s67 offen lds
  s_add_u32 m0, s93, 120832
  s_mul_i32 s67, s82, 114688
  s_add_u32 s67, s67, s79
  buffer_load_dwordx4 v251, s[40:43], s67 offen lds
  s_add_u32 m0, m0, 1024
  s_nop 0
  buffer_load_dwordx4 v252, s[40:43], s67 offen lds
  s_add_u32 m0, m0, 1024
  s_nop 0
  buffer_load_dwordx4 v253, s[40:43], s67 offen lds
  s_add_u32 s82, s82, 1
  s_and_b32 s82, s82, 15
  s_mov_b32 s8, s54
  s_mov_b32 s9, s55
  s_mov_b32 s10, 16777216
  s_mov_b32 s11, 0x00020000
  s_mov_b32 s12, s52
  s_mov_b32 s13, s53
  s_mov_b32 s14, 256
  s_mov_b32 s15, 0x00020000
  s_mov_b64 s[4:5], s[24:25]
  s_mov_b64 s[6:7], s[34:35]
  v_lshrrev_b32 v8, 5, v1
  v_and_b32 v9, 31, v1
  v_and_b32 v10, 15, v9
  v_xor_b32 v10, v10, v8
  v_lshlrev_b32 v10, 4, v10
  v_lshl_add_u32 v236, v9, 8, v10
  s_lshl_b32 s67, s92, 13
  v_add_u32 v236, s67, v236
  v_xor_b32 v237, 32, v236
  v_xor_b32 v238, 64, v236
  v_xor_b32 v239, 96, v236
  v_xor_b32 v240, 128, v236
  v_xor_b32 v241, 160, v236
  v_xor_b32 v242, 192, v236
  v_xor_b32 v243, 224, v236
  v_bfe_u32 v10, v1, 2, 2
  v_lshl_add_u32 v11, v8, 3, v10
  v_bfe_u32 v12, v1, 4, 1
  v_lshlrev_b32 v12, 5, v12
  v_and_b32 v13, 3, v1
  v_lshl_add_u32 v12, v13, 3, v12
  v_mul_u32_u24 v26, 448, v11
  v_add_u32 v26, v26, v12
  v_add_u32 v26, 70016, v26
  v_add_u32 v27, 18432, v26
  v_add_u32 v28, 36864, v26
  v_add_u32 v29, 55296, v26
  v_mov_b32 v64, 0
  v_mov_b32 v65, 0
  v_mov_b32 v66, 0
  v_mov_b32 v67, 0
  v_mov_b32 v68, 0
  v_mov_b32 v69, 0
  v_mov_b32 v70, 0
  v_mov_b32 v71, 0
  v_mov_b32 v72, 0
  v_mov_b32 v73, 0
  v_mov_b32 v74, 0
  v_mov_b32 v75, 0
  v_mov_b32 v76, 0
  v_mov_b32 v77, 0
  v_mov_b32 v78, 0
  v_mov_b32 v79, 0
  s_waitcnt vmcnt(16)
  s_barrier
  ds_read_b64_tr_b16 v[32:33], v26 offset:0
  ds_read_b64_tr_b16 v[34:35], v26 offset:1792
  ds_read_b128 v[40:43], v236 offset:0
  ds_read_b64_tr_b16 v[36:37], v26 offset:7168
  ds_read_b64_tr_b16 v[38:39], v26 offset:8960
  ds_read_b128 v[44:47], v237 offset:0
  s_waitcnt lgkmcnt(3)
  v_mfma_f32_32x32x16_bf16 v[64:79], v[32:35], v[40:43], v[64:79]
  s_waitcnt lgkmcnt(0)
  v_mfma_f32_32x32x16_bf16 v[64:79], v[36:39], v[44:47], v[64:79]
  s_waitcnt vmcnt(12)
  s_waitcnt lgkmcnt(0)
  s_barrier
  ds_read_b64_tr_b16 v[32:33], v27 offset:0
  ds_read_b64_tr_b16 v[34:35], v27 offset:1792
  ds_read_b128 v[40:43], v238 offset:0
  ds_read_b64_tr_b16 v[36:37], v27 offset:7168
  ds_read_b64_tr_b16 v[38:39], v27 offset:8960
  ds_read_b128 v[44:47], v239 offset:0
  s_lshl_b32 s67, s92, 10
  s_add_u32 m0, s67, 65536
  s_lshl_b32 s67, s82, 15
  s_add_u32 s67, s67, s78
  buffer_load_dwordx4 v250, s[44:47], s67 offen lds
  s_add_u32 m0, s93, 65536
  s_mul_i32 s67, s82, 114688
  s_add_u32 s67, s67, s79
  buffer_load_dwordx4 v251, s[40:43], s67 offen lds
  s_add_u32 m0, m0, 1024
  s_nop 0
  buffer_load_dwordx4 v252, s[40:43], s67 offen lds
  s_add_u32 m0, m0, 1024
  s_nop 0
  buffer_load_dwordx4 v253, s[40:43], s67 offen lds
  s_add_u32 s82, s82, 1
  s_and_b32 s82, s82, 15
  s_waitcnt lgkmcnt(3)
  v_mfma_f32_32x32x16_bf16 v[64:79], v[32:35], v[40:43], v[64:79]
  s_waitcnt lgkmcnt(0)
  v_mfma_f32_32x32x16_bf16 v[64:79], v[36:39], v[44:47], v[64:79]
  s_waitcnt vmcnt(8)
  s_waitcnt lgkmcnt(0)
  s_barrier
  ds_read_b64_tr_b16 v[32:33], v28 offset:0
  ds_read_b64_tr_b16 v[34:35], v28 offset:1792
  ds_read_b128 v[40:43], v240 offset:0
  ds_read_b64_tr_b16 v[36:37], v28 offset:7168
  ds_read_b64_tr_b16 v[38:39], v28 offset:8960
  ds_read_b128 v[44:47], v241 offset:0
  s_lshl_b32 s67, s92, 10
  s_add_u32 m0, s67, 83968
  s_lshl_b32 s67, s82, 15
  s_add_u32 s67, s67, s78
  buffer_load_dwordx4 v250, s[44:47], s67 offen lds
  s_add_u32 m0, s93, 83968
  s_mul_i32 s67, s82, 114688
  s_add_u32 s67, s67, s79
  buffer_load_dwordx4 v251, s[40:43], s67 offen lds
  s_add_u32 m0, m0, 1024
  s_nop 0
  buffer_load_dwordx4 v252, s[40:43], s67 offen lds
  s_add_u32 m0, m0, 1024
  s_nop 0
  buffer_load_dwordx4 v253, s[40:43], s67 offen lds
  s_add_u32 s82, s82, 1
  s_and_b32 s82, s82, 15
  s_waitcnt lgkmcnt(3)
  v_mfma_f32_32x32x16_bf16 v[64:79], v[32:35], v[40:43], v[64:79]
  s_waitcnt lgkmcnt(0)
  v_mfma_f32_32x32x16_bf16 v[64:79], v[36:39], v[44:47], v[64:79]
  s_waitcnt vmcnt(8)
  s_waitcnt lgkmcnt(0)
  s_barrier
  ds_read_b64_tr_b16 v[32:33], v29 offset:0
  ds_read_b64_tr_b16 v[34:35], v29 offset:1792
  ds_read_b128 v[40:43], v242 offset:0
  ds_read_b64_tr_b16 v[36:37], v29 offset:7168
  ds_read_b64_tr_b16 v[38:39], v29 offset:8960
  ds_read_b128 v[44:47], v243 offset:0
  s_lshl_b32 s67, s92, 10
  s_add_u32 m0, s67, 102400
  s_lshl_b32 s67, s82, 15
  s_add_u32 s67, s67, s78
  buffer_load_dwordx4 v250, s[44:47], s67 offen lds
  s_add_u32 m0, s93, 102400
  s_mul_i32 s67, s82, 114688
  s_add_u32 s67, s67, s79
  buffer_load_dwordx4 v251, s[40:43], s67 offen lds
  s_add_u32 m0, m0, 1024
  s_nop 0
  buffer_load_dwordx4 v252, s[40:43], s67 offen lds
  s_add_u32 m0, m0, 1024
  s_nop 0
  buffer_load_dwordx4 v253, s[40:43], s67 offen lds
  s_add_u32 s82, s82, 1
  s_and_b32 s82, s82, 15
  s_waitcnt lgkmcnt(3)
  v_mfma_f32_32x32x16_bf16 v[64:79], v[32:35], v[40:43], v[64:79]
  s_waitcnt lgkmcnt(0)
  v_mfma_f32_32x32x16_bf16 v[64:79], v[36:39], v[44:47], v[64:79]
  s_waitcnt vmcnt(8)
  s_waitcnt lgkmcnt(0)
  s_barrier
  ds_read_b64_tr_b16 v[32:33], v26 offset:0
  ds_read_b64_tr_b16 v[34:35], v26 offset:1792
  ds_read_b128 v[40:43], v236 offset:16384
  ds_read_b64_tr_b16 v[36:37], v26 offset:7168
  ds_read_b64_tr_b16 v[38:39], v26 offset:8960
  ds_read_b128 v[44:47], v237 offset:16384
  s_lshl_b32 s67, s92, 10
  s_add_u32 m0, s67, 120832
  s_lshl_b32 s67, s82, 15
  s_add_u32 s67, s67, s78
  buffer_load_dwordx4 v250, s[44:47], s67 offen lds
  s_add_u32 m0, s93, 120832
  s_mul_i32 s67, s82, 114688
  s_add_u32 s67, s67, s79
  buffer_load_dwordx4 v251, s[40:43], s67 offen lds
  s_add_u32 m0, m0, 1024
  s_nop 0
  buffer_load_dwordx4 v252, s[40:43], s67 offen lds
  s_add_u32 m0, m0, 1024
  s_nop 0
  buffer_load_dwordx4 v253, s[40:43], s67 offen lds
  s_add_u32 s82, s82, 1
  s_and_b32 s82, s82, 15
  s_waitcnt lgkmcnt(3)
  v_mfma_f32_32x32x16_bf16 v[64:79], v[32:35], v[40:43], v[64:79]
  s_waitcnt lgkmcnt(0)
  v_mfma_f32_32x32x16_bf16 v[64:79], v[36:39], v[44:47], v[64:79]
  s_waitcnt vmcnt(8)
  s_waitcnt lgkmcnt(0)
  s_barrier
  ds_read_b64_tr_b16 v[32:33], v27 offset:0
  ds_read_b64_tr_b16 v[34:35], v27 offset:1792
  ds_read_b128 v[40:43], v238 offset:16384
  ds_read_b64_tr_b16 v[36:37], v27 offset:7168
  ds_read_b64_tr_b16 v[38:39], v27 offset:8960
  ds_read_b128 v[44:47], v239 offset:16384
  s_lshl_b32 s67, s92, 10
  s_add_u32 m0, s67, 65536
  s_lshl_b32 s67, s82, 15
  s_add_u32 s67, s67, s78
  buffer_load_dwordx4 v250, s[44:47], s67 offen lds
  s_add_u32 m0, s93, 65536
  s_mul_i32 s67, s82, 114688
  s_add_u32 s67, s67, s79
  buffer_load_dwordx4 v251, s[40:43], s67 offen lds
  s_add_u32 m0, m0, 1024
  s_nop 0
  buffer_load_dwordx4 v252, s[40:43], s67 offen lds
  s_add_u32 m0, m0, 1024
  s_nop 0
  buffer_load_dwordx4 v253, s[40:43], s67 offen lds
  s_add_u32 s82, s82, 1
  s_and_b32 s82, s82, 15
  s_waitcnt lgkmcnt(3)
  v_mfma_f32_32x32x16_bf16 v[64:79], v[32:35], v[40:43], v[64:79]
  s_waitcnt lgkmcnt(0)
  v_mfma_f32_32x32x16_bf16 v[64:79], v[36:39], v[44:47], v[64:79]
  s_waitcnt vmcnt(8)
  s_waitcnt lgkmcnt(0)
  s_barrier
  ds_read_b64_tr_b16 v[32:33], v28 offset:0
  ds_read_b64_tr_b16 v[34:35], v28 offset:1792
  ds_read_b128 v[40:43], v240 offset:16384
  ds_read_b64_tr_b16 v[36:37], v28 offset:7168
  ds_read_b64_tr_b16 v[38:39], v28 offset:8960
  ds_read_b128 v[44:47], v241 offset:16384
  s_lshl_b32 s67, s92, 10
  s_add_u32 m0, s67, 83968
  s_lshl_b32 s67, s82, 15
  s_add_u32 s67, s67, s78
  buffer_load_dwordx4 v250, s[44:47], s67 offen lds
  s_add_u32 m0, s93, 83968
  s_mul_i32 s67, s82, 114688
  s_add_u32 s67, s67, s79
  buffer_load_dwordx4 v251, s[40:43], s67 offen lds
  s_add_u32 m0, m0, 1024
  s_nop 0
  buffer_load_dwordx4 v252, s[40:43], s67 offen lds
  s_add_u32 m0, m0, 1024
  s_nop 0
  buffer_load_dwordx4 v253, s[40:43], s67 offen lds
  s_add_u32 s82, s82, 1
  s_and_b32 s82, s82, 15
  s_waitcnt lgkmcnt(3)
  v_mfma_f32_32x32x16_bf16 v[64:79], v[32:35], v[40:43], v[64:79]
  s_waitcnt lgkmcnt(0)
  v_mfma_f32_32x32x16_bf16 v[64:79], v[36:39], v[44:47], v[64:79]
  s_waitcnt vmcnt(8)
  s_waitcnt lgkmcnt(0)
  s_barrier
  ds_read_b64_tr_b16 v[32:33], v29 offset:0
  ds_read_b64_tr_b16 v[34:35], v29 offset:1792
  ds_read_b128 v[40:43], v242 offset:16384
  ds_read_b64_tr_b16 v[36:37], v29 offset:7168
  ds_read_b64_tr_b16 v[38:39], v29 offset:8960
  ds_read_b128 v[44:47], v243 offset:16384
  s_lshl_b32 s67, s92, 10
  s_add_u32 m0, s67, 102400
  s_lshl_b32 s67, s82, 15
  s_add_u32 s67, s67, s78
  buffer_load_dwordx4 v250, s[44:47], s67 offen lds
  s_add_u32 m0, s93, 102400
  s_mul_i32 s67, s82, 114688
  s_add_u32 s67, s67, s79
  buffer_load_dwordx4 v251, s[40:43], s67 offen lds
  s_add_u32 m0, m0, 1024
  s_nop 0
  buffer_load_dwordx4 v252, s[40:43], s67 offen lds
  s_add_u32 m0, m0, 1024
  s_nop 0
  buffer_load_dwordx4 v253, s[40:43], s67 offen lds
  s_add_u32 s82, s82, 1
  s_and_b32 s82, s82, 15
  s_waitcnt lgkmcnt(3)
  v_mfma_f32_32x32x16_bf16 v[64:79], v[32:35], v[40:43], v[64:79]
  s_waitcnt lgkmcnt(0)
  v_mfma_f32_32x32x16_bf16 v[64:79], v[36:39], v[44:47], v[64:79]
  s_waitcnt vmcnt(8)
  s_waitcnt lgkmcnt(0)
  s_barrier
  ds_read_b64_tr_b16 v[32:33], v26 offset:0
  ds_read_b64_tr_b16 v[34:35], v26 offset:1792
  ds_read_b128 v[40:43], v236 offset:32768
  ds_read_b64_tr_b16 v[36:37], v26 offset:7168
  ds_read_b64_tr_b16 v[38:39], v26 offset:8960
  ds_read_b128 v[44:47], v237 offset:32768
  s_lshl_b32 s67, s92, 10
  s_add_u32 m0, s67, 120832
  s_lshl_b32 s67, s82, 15
  s_add_u32 s67, s67, s78
  buffer_load_dwordx4 v250, s[44:47], s67 offen lds
  s_add_u32 m0, s93, 120832
  s_mul_i32 s67, s82, 114688
  s_add_u32 s67, s67, s79
  buffer_load_dwordx4 v251, s[40:43], s67 offen lds
  s_add_u32 m0, m0, 1024
  s_nop 0
  buffer_load_dwordx4 v252, s[40:43], s67 offen lds
  s_add_u32 m0, m0, 1024
  s_nop 0
  buffer_load_dwordx4 v253, s[40:43], s67 offen lds
  s_add_u32 s82, s82, 1
  s_and_b32 s82, s82, 15
  s_mov_b32 s16, s66
  s_mov_b32 s17, s64
  s_mov_b32 s18, s65
  s_lshl_b32 s32, s16, 10
  s_lshr_b32 s22, s16, 2
  s_and_b32 s28, s16, 3
  s_and_b32 s30, s16, 1
  s_bfe_u32 s29, s16, 0x10001
  s_lshr_b32 s35, s16, 1
  s_lshl_b32 s23, s18, 2
  s_add_u32 s23, s23, s28
  s_lshl_b32 s33, s17, 1
  s_add_u32 s33, s33, s22
  s_lshl_b32 s33, s33, 5
  s_add_u32 s33, s33, s23
  s_lshl_b32 s33, s33, 10
  s_add_u32 s37, s33, 13631488
  s_mul_i32 s19, s16, 14
  s_lshl_b32 s20, s18, 1
  s_add_u32 s20, s20, s29
  s_mul_i32 s24, s20, 112
  s_xor_b32 s20, s20, 1
  s_mul_i32 s25, s20, 112
  s_lshl_b32 s20, s17, 1
  s_add_u32 s20, s20, s30
  s_mul_i32 s26, s20, 112
  s_xor_b32 s20, s20, 1
  s_mul_i32 s27, s20, 112
  s_add_u32 s24, s24, s19
  s_lshl_b32 s24, s24, 10
  s_add_u32 s24, s24, 10485760
  s_add_u32 s25, s25, s19
  s_lshl_b32 s25, s25, 10
  s_add_u32 s25, s25, 10485760
  s_add_u32 s26, s26, s19
  s_lshl_b32 s26, s26, 10
  s_add_u32 s26, s26, 3145728
  s_add_u32 s27, s27, s19
  s_lshl_b32 s27, s27, 10
  s_add_u32 s27, s27, 3145728
  s_lshl_b32 s19, s17, 8
  s_add_u32 s19, s19, 2240512
  s_lshl_b32 s20, s18, 5
  s_add_u32 s50, s19, s20
  s_lshl_b32 s20, s16, 2
  s_add_u32 s50, s50, s20
  s_lshl_b32 s20, s16, 5
  s_add_u32 s51, s19, s20
  v_and_b32 v249, 7, v1
  v_lshlrev_b32 v249, 2, v249
  v_and_b32 v8, 31, v1
  v_lshrrev_b32 v9, 5, v1
  v_and_b32 v10, 11, v1
  v_cmp_eq_u32 vcc, 0, v10
  v_mov_b32 v10, 0x3c003c00
  s_nop 0
  v_cndmask_b32 v132, 0, v10, vcc
  v_mov_b32 v133, v132
  v_mov_b32 v134, v132
  v_mov_b32 v135, v132
  s_lshl_b32 s19, s16, 10
  s_add_u32 s19, s19, 155648
  v_add_u32 v10, s19, v5
  ds_write_b128 v10, v[132:135]
  s_nop 1
  v_lshlrev_b32 v10, 8, v9
  v_lshl_add_u32 v10, v8, 4, v10
  v_add_u32 v10, 65536, v10
  v_subrev_u32 v11, 20, v8
  v_cmp_gt_u32 vcc, 8, v11
  v_mov_b32 v11, 155648
  v_mov_b32 v12, 155712
  v_cndmask_b32 v11, v11, v12, vcc
  v_and_b32 v12, 11, v8
  v_cmp_ne_u32 vcc, 0, v12
  v_add_u32 v12, 16, v11
  s_nop 0
  v_cndmask_b32 v11, v11, v12, vcc
  v_cmp_gt_u32 vcc, 16, v8
  s_nop 1
  v_cndmask_b32 v3, v11, v10, vcc
  v_mov_b32 v11, 8192
  v_cndmask_b32 v4, 0, v11, vcc
  v_lshlrev_b32 v6, 2, v8
  v_mov_b32 v136, 0
  v_mov_b32 v137, 0
  v_mov_b32 v138, 0
  v_mov_b32 v139, 0
  v_mov_b32 v140, 0
  v_mov_b32 v141, 0
  v_mov_b32 v142, 0
  v_mov_b32 v143, 0
  v_mov_b32 v144, 0
  v_mov_b32 v145, 0
  v_mov_b32 v146, 0
  v_mov_b32 v147, 0
  v_mov_b32 v148, 0
  v_mov_b32 v149, 0
  v_mov_b32 v150, 0
  v_mov_b32 v151, 0
  v_mov_b32 v152, 0
  v_mov_b32 v153, 0
  v_mov_b32 v154, 0
  v_mov_b32 v155, 0
  v_mov_b32 v156, 0
  v_mov_b32 v157, 0
  v_mov_b32 v158, 0
  v_mov_b32 v159, 0
  v_mov_b32 v160, 0
  v_mov_b32 v161, 0
  v_mov_b32 v162, 0
  v_mov_b32 v163, 0
  v_mov_b32 v164, 0
  v_mov_b32 v165, 0
  v_mov_b32 v166, 0
  v_mov_b32 v167, 0
  v_mov_b32 v168, 0
  v_mov_b32 v169, 0
  v_mov_b32 v170, 0
  v_mov_b32 v171, 0
  v_mov_b32 v172, 0
  v_mov_b32 v173, 0
  v_mov_b32 v174, 0
  v_mov_b32 v175, 0
  v_mov_b32 v176, 0
  v_mov_b32 v177, 0
  v_mov_b32 v178, 0
  v_mov_b32 v179, 0
  v_mov_b32 v180, 0
  v_mov_b32 v181, 0
  v_mov_b32 v182, 0
  v_mov_b32 v183, 0
  v_mov_b32 v184, 0
  v_mov_b32 v185, 0
  v_mov_b32 v186, 0
  v_mov_b32 v187, 0
  v_mov_b32 v188, 0
  v_mov_b32 v189, 0
  v_mov_b32 v190, 0
  v_mov_b32 v191, 0
  v_mov_b32 v192, 0
  v_mov_b32 v193, 0
  v_mov_b32 v194, 0
  v_mov_b32 v195, 0
  v_mov_b32 v132, 0
  v_mov_b32 v133, 0
  v_mov_b32 v134, 0
  v_mov_b32 v135, 0
  s_lshl_b32 s19, s16, 13
  s_add_u32 s19, s19, 32768
  s_cmp_ge_u32 s16, 3
  s_cselect_b32 s20, 40960, 0
  s_add_u32 s19, s19, s20
  s_cmp_ge_u32 s16, 6
  s_cselect_b32 s20, 16384, 0
  s_add_u32 s19, s19, s20
  v_add_u32 v2, s19, v5
  s_xor_b32 s3, s16, 1
  s_lshl_b32 s19, s3, 13
  s_add_u32 s19, s19, 32768
  s_cmp_ge_u32 s3, 3
  s_cselect_b32 s20, 40960, 0
  s_add_u32 s19, s19, s20
  s_cmp_ge_u32 s3, 6
  s_cselect_b32 s20, 16384, 0
  s_add_u32 s19, s19, s20
  v_add_u32 v21, s19, v5
  s_lshl_b32 s20, s17, 1
  s_add_u32 s20, s20, s30
  s_lshl_b32 s20, s20, 5
  s_lshl_b32 s19, s35, 3
  s_add_u32 s20, s20, s19
  s_lshl_b32 s20, s20, 10
  s_add_u32 s36, s20, 13631488
  s_lshl_b32 s19, s16, 16
  s_lshl_b32 s20, s18, 7
  s_add_u32 s38, s19, s20
  v_lshrrev_b32 v14, 3, v1
  v_and_b32 v20, 7, v1
  v_bfe_u32 v13, v14, 1, 1
  v_lshlrev_b32 v13, 2, v13
  v_xor_b32 v20, v20, v13
  v_lshlrev_b32 v20, 4, v20
  v_lshl_add_u32 v20, v14, 10, v20
  s_waitcnt lgkmcnt(0)
  v_mfma_f32_32x32x16_bf16 v[64:79], v[32:35], v[40:43], v[64:79]
  s_waitcnt lgkmcnt(0)
  v_mfma_f32_32x32x16_bf16 v[64:79], v[36:39], v[44:47], v[64:79]
  s_waitcnt vmcnt(8)
  s_waitcnt lgkmcnt(0)
  s_barrier
  ds_read_b64_tr_b16 v[32:33], v27 offset:0
  ds_read_b64_tr_b16 v[34:35], v27 offset:1792
  ds_read_b128 v[40:43], v238 offset:32768
  ds_read_b64_tr_b16 v[36:37], v27 offset:7168
  ds_read_b64_tr_b16 v[38:39], v27 offset:8960
  ds_read_b128 v[44:47], v239 offset:32768
  s_lshl_b32 s67, s92, 10
  s_add_u32 m0, s67, 65536
  s_lshl_b32 s67, s82, 15
  s_add_u32 s67, s67, s78
  buffer_load_dwordx4 v250, s[44:47], s67 offen lds
  s_add_u32 m0, s93, 65536
  s_mul_i32 s67, s82, 114688
  s_add_u32 s67, s67, s79
  buffer_load_dwordx4 v251, s[40:43], s67 offen lds
  s_add_u32 m0, m0, 1024
  s_nop 0
  buffer_load_dwordx4 v252, s[40:43], s67 offen lds
  s_add_u32 m0, m0, 1024
  s_nop 0
  buffer_load_dwordx4 v253, s[40:43], s67 offen lds
  s_add_u32 s82, s82, 1
  s_and_b32 s82, s82, 15
  s_waitcnt lgkmcnt(3)
  v_mfma_f32_32x32x16_bf16 v[64:79], v[32:35], v[40:43], v[64:79]
  s_waitcnt lgkmcnt(0)
  v_mfma_f32_32x32x16_bf16 v[64:79], v[36:39], v[44:47], v[64:79]
  s_waitcnt vmcnt(8)
  s_waitcnt lgkmcnt(0)
  s_barrier
  ds_read_b64_tr_b16 v[32:33], v28 offset:0
  ds_read_b64_tr_b16 v[34:35], v28 offset:1792
  ds_read_b128 v[40:43], v240 offset:32768
  ds_read_b64_tr_b16 v[36:37], v28 offset:7168
  ds_read_b64_tr_b16 v[38:39], v28 offset:8960
  ds_read_b128 v[44:47], v241 offset:32768
  s_lshl_b32 s67, s92, 10
  s_add_u32 m0, s67, 83968
  s_lshl_b32 s67, s82, 15
  s_add_u32 s67, s67, s78
  buffer_load_dwordx4 v250, s[44:47], s67 offen lds
  s_add_u32 m0, s93, 83968
  s_mul_i32 s67, s82, 114688
  s_add_u32 s67, s67, s79
  buffer_load_dwordx4 v251, s[40:43], s67 offen lds
  s_add_u32 m0, m0, 1024
  s_nop 0
  buffer_load_dwordx4 v252, s[40:43], s67 offen lds
  s_add_u32 m0, m0, 1024
  s_nop 0
  buffer_load_dwordx4 v253, s[40:43], s67 offen lds
  s_add_u32 s82, s82, 1
  s_and_b32 s82, s82, 15
  s_waitcnt lgkmcnt(3)
  v_mfma_f32_32x32x16_bf16 v[64:79], v[32:35], v[40:43], v[64:79]
  s_waitcnt lgkmcnt(0)
  v_mfma_f32_32x32x16_bf16 v[64:79], v[36:39], v[44:47], v[64:79]
  s_waitcnt vmcnt(8)
  s_waitcnt lgkmcnt(0)
  s_barrier
  ds_read_b64_tr_b16 v[32:33], v29 offset:0
  ds_read_b64_tr_b16 v[34:35], v29 offset:1792
  ds_read_b128 v[40:43], v242 offset:32768
  ds_read_b64_tr_b16 v[36:37], v29 offset:7168
  ds_read_b64_tr_b16 v[38:39], v29 offset:8960
  ds_read_b128 v[44:47], v243 offset:32768
  s_lshl_b32 s67, s92, 10
  s_add_u32 m0, s67, 102400
  s_lshl_b32 s67, s82, 15
  s_add_u32 s67, s67, s78
  buffer_load_dwordx4 v250, s[44:47], s67 offen lds
  s_add_u32 m0, s93, 102400
  s_mul_i32 s67, s82, 114688
  s_add_u32 s67, s67, s79
  buffer_load_dwordx4 v251, s[40:43], s67 offen lds
  s_add_u32 m0, m0, 1024
  s_nop 0
  buffer_load_dwordx4 v252, s[40:43], s67 offen lds
  s_add_u32 m0, m0, 1024
  s_nop 0
  buffer_load_dwordx4 v253, s[40:43], s67 offen lds
  s_add_u32 s82, s82, 1
  s_and_b32 s82, s82, 15
  s_waitcnt lgkmcnt(3)
  v_mfma_f32_32x32x16_bf16 v[64:79], v[32:35], v[40:43], v[64:79]
  s_waitcnt lgkmcnt(0)
  v_mfma_f32_32x32x16_bf16 v[64:79], v[36:39], v[44:47], v[64:79]
  s_waitcnt vmcnt(8)
  s_waitcnt lgkmcnt(0)
  s_barrier
  ds_read_b64_tr_b16 v[32:33], v26 offset:0
  ds_read_b64_tr_b16 v[34:35], v26 offset:1792
  ds_read_b128 v[40:43], v236 offset:49152
  ds_read_b64_tr_b16 v[36:37], v26 offset:7168
  ds_read_b64_tr_b16 v[38:39], v26 offset:8960
  ds_read_b128 v[44:47], v237 offset:49152
  s_lshl_b32 s67, s92, 10
  s_add_u32 m0, s67, 120832
  s_lshl_b32 s67, s82, 15
  s_add_u32 s67, s67, s78
  buffer_load_dwordx4 v250, s[44:47], s67 offen lds
  s_add_u32 m0, s93, 120832
  s_mul_i32 s67, s82, 114688
  s_add_u32 s67, s67, s79
  buffer_load_dwordx4 v251, s[40:43], s67 offen lds
  s_add_u32 m0, m0, 1024
  s_nop 0
  buffer_load_dwordx4 v252, s[40:43], s67 offen lds
  s_add_u32 m0, m0, 1024
  s_nop 0
  buffer_load_dwordx4 v253, s[40:43], s67 offen lds
  s_add_u32 s82, s82, 1
  s_and_b32 s82, s82, 15
  s_waitcnt lgkmcnt(3)
  v_mfma_f32_32x32x16_bf16 v[64:79], v[32:35], v[40:43], v[64:79]
  s_waitcnt lgkmcnt(0)
  v_mfma_f32_32x32x16_bf16 v[64:79], v[36:39], v[44:47], v[64:79]
  s_waitcnt vmcnt(8)
  s_waitcnt lgkmcnt(0)
  s_barrier
  ds_read_b64_tr_b16 v[32:33], v27 offset:0
  ds_read_b64_tr_b16 v[34:35], v27 offset:1792
  ds_read_b128 v[40:43], v238 offset:49152
  ds_read_b64_tr_b16 v[36:37], v27 offset:7168
  ds_read_b64_tr_b16 v[38:39], v27 offset:8960
  ds_read_b128 v[44:47], v239 offset:49152
  s_waitcnt lgkmcnt(3)
  v_mfma_f32_32x32x16_bf16 v[64:79], v[32:35], v[40:43], v[64:79]
  s_waitcnt lgkmcnt(0)
  v_mfma_f32_32x32x16_bf16 v[64:79], v[36:39], v[44:47], v[64:79]
  s_waitcnt vmcnt(4)
  s_waitcnt lgkmcnt(0)
  s_barrier
  ds_read_b64_tr_b16 v[32:33], v28 offset:0
  ds_read_b64_tr_b16 v[34:35], v28 offset:1792
  ds_read_b128 v[40:43], v240 offset:49152
  ds_read_b64_tr_b16 v[36:37], v28 offset:7168
  ds_read_b64_tr_b16 v[38:39], v28 offset:8960
  ds_read_b128 v[44:47], v241 offset:49152
  s_mov_b32 m0, s32
  s_add_u32 s32, s32, 2097152
  buffer_load_dwordx4 v5, s[8:11], s32 offen sc1 lds
  s_add_u32 m0, m0, 65536
  s_add_u32 s32, s32, 65536
  buffer_load_dwordx4 v5, s[8:11], s32 offen sc1 lds
  s_sub_u32 m0, m0, 57344
  s_sub_u32 s32, s32, 57344
  buffer_load_dwordx4 v5, s[8:11], s32 offen sc1 lds
  s_add_u32 m0, m0, 65536
  s_add_u32 s32, s32, 65536
  buffer_load_dwordx4 v5, s[8:11], s32 offen sc1 lds
  s_sub_u32 m0, m0, 57344
  s_sub_u32 s32, s32, 57344
  s_mov_b32 s31, 2236416
  buffer_load_dwordx4 v[244:247], v5, s[8:11], s31 offen sc1
  buffer_load_dwordx4 v[196:199], v5, s[8:11], s24 offen offset:0 sc1
  buffer_load_dwordx4 v[200:203], v5, s[8:11], s25 offen offset:0 sc1
  buffer_load_dwordx4 v[212:215], v5, s[8:11], s24 offen offset:1024 sc1
  buffer_load_dwordx4 v[216:219], v5, s[8:11], s25 offen offset:1024 sc1
  s_waitcnt lgkmcnt(3)
  v_mfma_f32_32x32x16_bf16 v[64:79], v[32:35], v[40:43], v[64:79]
  s_waitcnt lgkmcnt(0)
  v_mfma_f32_32x32x16_bf16 v[64:79], v[36:39], v[44:47], v[64:79]
  s_waitcnt vmcnt(9)
  s_waitcnt lgkmcnt(0)
  s_barrier
  ds_read_b64_tr_b16 v[32:33], v29 offset:0
  ds_read_b64_tr_b16 v[34:35], v29 offset:1792
  ds_read_b128 v[40:43], v242 offset:49152
  ds_read_b64_tr_b16 v[36:37], v29 offset:7168
  ds_read_b64_tr_b16 v[38:39], v29 offset:8960
  ds_read_b128 v[44:47], v243 offset:49152
  s_waitcnt lgkmcnt(3)
  v_mfma_f32_32x32x16_bf16 v[64:79], v[32:35], v[40:43], v[64:79]
  s_waitcnt lgkmcnt(0)
  v_mfma_f32_32x32x16_bf16 v[64:79], v[36:39], v[44:47], v[64:79]
  s_lshl_b32 s67, s64, 1
  s_add_u32 s67, s67, s92
  s_mul_i32 s67, s67, 112
  s_mul_i32 s68, s65, 14
  s_add_u32 s67, s67, s68
  s_lshl_b32 s67, s67, 10
  s_add_u32 s67, s67, 3158016
  s_nop 4
  v_cvt_pk_bf16_f32 v32, v64, v65
  v_pk_max_i16 v32, v32, 0
  v_cvt_pk_bf16_f32 v33, v66, v67
  v_pk_max_i16 v33, v33, 0
  v_cvt_pk_bf16_f32 v34, v68, v69
  v_pk_max_i16 v34, v34, 0
  v_cvt_pk_bf16_f32 v35, v70, v71
  v_pk_max_i16 v35, v35, 0
  buffer_store_dwordx4 v[32:35], v5, s[8:11], s67 offen offset:0 sc1
  v_cvt_pk_bf16_f32 v36, v72, v73
  v_pk_max_i16 v36, v36, 0
  v_cvt_pk_bf16_f32 v37, v74, v75
  v_pk_max_i16 v37, v37, 0
  v_cvt_pk_bf16_f32 v38, v76, v77
  v_pk_max_i16 v38, v38, 0
  v_cvt_pk_bf16_f32 v39, v78, v79
  v_pk_max_i16 v39, v39, 0
  buffer_store_dwordx4 v[36:39], v5, s[8:11], s67 offen offset:1024 sc1
  v_mov_b32 v100, 0
  v_mov_b32 v101, 0
  v_mov_b32 v102, 0
  v_mov_b32 v103, 0
  v_mov_b32 v104, 0
  v_mov_b32 v105, 0
  v_mov_b32 v106, 0
  v_mov_b32 v107, 0
  v_mov_b32 v108, 0
  v_mov_b32 v109, 0
  v_mov_b32 v110, 0
  v_mov_b32 v111, 0
  v_mov_b32 v112, 0
  v_mov_b32 v113, 0
  v_mov_b32 v114, 0
  v_mov_b32 v115, 0
  s_waitcnt vmcnt(6)
  v_mov_b32 v48, 0x02000200
  v_mov_b32 v49, 0x39a839a8
  s_branch B_ENTRY
A_L67:
  s_cmp_eq_u32 s66, 7
  s_cbranch_scc1 A_L7
  s_lshl_b32 s67, s92, 10
  s_add_u32 m0, s67, 65536
  s_lshl_b32 s67, s82, 15
  s_add_u32 s67, s67, s78
  buffer_load_dwordx4 v250, s[44:47], s67 offen lds
  s_add_u32 m0, s93, 65536
  s_mul_i32 s67, s82, 114688
  s_add_u32 s67, s67, s79
  buffer_load_dwordx4 v251, s[40:43], s67 offen lds
  s_add_u32 m0, m0, 1024
  s_nop 0
  buffer_load_dwordx4 v252, s[40:43], s67 offen lds
  s_add_u32 m0, m0, 1024
  s_nop 0
  buffer_load_dwordx4 v253, s[40:43], s67 offen lds
  s_add_u32 m0, m0, 1024
  s_nop 0
  buffer_load_dwordx4 v254, s[40:43], s67 offen lds
  s_add_u32 s82, s82, 1
  s_and_b32 s82, s82, 15
  s_lshl_b32 s67, s92, 10
  s_add_u32 m0, s67, 83968
  s_lshl_b32 s67, s82, 15
  s_add_u32 s67, s67, s78
  buffer_load_dwordx4 v250, s[44:47], s67 offen lds
  s_add_u32 m0, s93, 83968
  s_mul_i32 s67, s82, 114688
  s_add_u32 s67, s67, s79
  buffer_load_dwordx4 v251, s[40:43], s67 offen lds
  s_add_u32 m0, m0, 1024
  s_nop 0
  buffer_load_dwordx4 v252, s[40:43], s67 offen lds
  s_add_u32 m0, m0, 1024
  s_nop 0
  buffer_load_dwordx4 v253, s[40:43], s67 offen lds
  s_add_u32 m0, m0, 1024
  s_nop 0
  buffer_load_dwordx4 v254, s[40:43], s67 offen lds
  s_add_u32 s82, s82, 1
  s_and_b32 s82, s82, 15
  s_add_u32 s67, s81, 1
  s_and_b32 s67, s67, 3
  s_add_u32 m0, s83, 16384
  s_lshl_b32 s67, s67, 8
  s_add_u32 s67, s67, s72
  buffer_load_dwordx4 v16, s[36:39], s67 offen lds
  s_add_u32 m0, m0, 1024
  s_add_u32 s67, s67, 4096
  buffer_load_dwordx4 v17, s[36:39], s67 offen lds
  s_add_u32 m0, m0, 1024
  s_add_u32 s67, s67, 4096
  buffer_load_dwordx4 v18, s[36:39], s67 offen lds
  s_add_u32 m0, m0, 1024
  s_add_u32 s67, s67, 4096
  buffer_load_dwordx4 v19, s[36:39], s67 offen lds
  s_lshl_b32 s67, s92, 10
  s_add_u32 m0, s67, 102400
  s_lshl_b32 s67, s82, 15
  s_add_u32 s67, s67, s78
  buffer_load_dwordx4 v250, s[44:47], s67 offen lds
  s_add_u32 m0, s93, 102400
  s_mul_i32 s67, s82, 114688
  s_add_u32 s67, s67, s79
  buffer_load_dwordx4 v251, s[40:43], s67 offen lds
  s_add_u32 m0, m0, 1024
  s_nop 0
  buffer_load_dwordx4 v252, s[40:43], s67 offen lds
  s_add_u32 m0, m0, 1024
  s_nop 0
  buffer_load_dwordx4 v253, s[40:43], s67 offen lds
  s_add_u32 m0, m0, 1024
  s_nop 0
  buffer_load_dwordx4 v254, s[40:43], s67 offen lds
  s_add_u32 s82, s82, 1
  s_and_b32 s82, s82, 15
  s_lshl_b32 s67, s92, 10
  s_add_u32 m0, s67, 120832
  s_lshl_b32 s67, s82, 15
  s_add_u32 s67, s67, s78
  buffer_load_dwordx4 v250, s[44:47], s67 offen lds
  s_add_u32 m0, s93, 120832
  s_mul_i32 s67, s82, 114688
  s_add_u32 s67, s67, s79
  buffer_load_dwordx4 v251, s[40:43], s67 offen lds
  s_add_u32 m0, m0, 1024
  s_nop 0
  buffer_load_dwordx4 v252, s[40:43], s67 offen lds
  s_add_u32 m0, m0, 1024
  s_nop 0
  buffer_load_dwordx4 v253, s[40:43], s67 offen lds
  s_add_u32 m0, m0, 1024
  s_nop 0
  buffer_load_dwordx4 v254, s[40:43], s67 offen lds
  s_add_u32 s82, s82, 1
  s_and_b32 s82, s82, 15
  s_mov_b32 s8, s54
  s_mov_b32 s9, s55
  s_mov_b32 s10, 16777216
  s_mov_b32 s11, 0x00020000
  s_mov_b32 s12, s52
  s_mov_b32 s13, s53
  s_mov_b32 s14, 256
  s_mov_b32 s15, 0x00020000
  s_mov_b64 s[4:5], s[24:25]
  s_mov_b64 s[6:7], s[34:35]
  v_and_b32 v8, 15, v1
  v_lshrrev_b32 v9, 4, v1
  v_xor_b32 v10, v8, v9
  v_lshlrev_b32 v10, 4, v10
  v_lshl_add_u32 v26, v8, 8, v10
  s_lshl_b32 s67, s76, 12
  v_add_u32 v26, s67, v26
  v_xor_b32 v27, 64, v26
  v_xor_b32 v28, 128, v26
  v_xor_b32 v29, 192, v26
  v_lshrrev_b32 v10, 1, v9
  v_lshlrev_b32 v10, 4, v10
  v_and_b32 v11, 1, v9
  v_lshl_add_u32 v10, v11, 2, v10
  v_lshrrev_b32 v11, 2, v8
  v_add_u32 v10, v10, v11
  v_lshlrev_b32 v10, 5, v10
  v_and_b32 v11, 3, v8
  v_lshl_add_u32 v10, v11, 3, v10
  v_add_u32 v30, 139264, v10
  v_lshlrev_b32 v31, 4, v9
  v_add_u32 v31, 155648, v31
  v_mov_b32 v56, 0
  v_mov_b32 v57, 0
  v_mov_b32 v58, 0
  v_mov_b32 v59, 0
  v_mov_b32 v60, 0
  v_mov_b32 v61, 0
  v_mov_b32 v62, 0
  v_mov_b32 v63, 0
  s_waitcnt vmcnt(19)
  s_barrier
  s_waitcnt vmcnt(14)
  s_waitcnt lgkmcnt(0)
  s_barrier
  s_lshl_b32 s67, s92, 10
  s_add_u32 m0, s67, 65536
  s_lshl_b32 s67, s82, 15
  s_add_u32 s67, s67, s78
  buffer_load_dwordx4 v250, s[44:47], s67 offen lds
  s_add_u32 m0, s93, 65536
  s_mul_i32 s67, s82, 114688
  s_add_u32 s67, s67, s79
  buffer_load_dwordx4 v251, s[40:43], s67 offen lds
  s_add_u32 m0, m0, 1024
  s_nop 0
  buffer_load_dwordx4 v252, s[40:43], s67 offen lds
  s_add_u32 m0, m0, 1024
  s_nop 0
  buffer_load_dwordx4 v253, s[40:43], s67 offen lds
  s_add_u32 m0, m0, 1024
  s_nop 0
  buffer_load_dwordx4 v254, s[40:43], s67 offen lds
  s_add_u32 s82, s82, 1
  s_and_b32 s82, s82, 15
  s_add_u32 s67, s81, 0
  s_and_b32 s67, s67, 3
  s_lshl_b32 s68, s67, 12
  v_add_u32 v64, s68, v30
  s_lshl_b32 s68, s67, 8
  v_add_u32 v65, s68, v31
  ds_read_b128 v[128:131], v26 offset:0
  ds_read_b64_tr_b16 v[144:145], v64 offset:0
  ds_read_b64_tr_b16 v[146:147], v64 offset:256
  ds_read_b128 v[160:163], v65 offset:0
  ds_read_b128 v[132:135], v27 offset:0
  ds_read_b64_tr_b16 v[148:149], v64 offset:1024
  ds_read_b64_tr_b16 v[150:151], v64 offset:1280
  ds_read_b128 v[164:167], v65 offset:64
  ds_read_b128 v[136:139], v28 offset:0
  ds_read_b64_tr_b16 v[152:153], v64 offset:2048
  ds_read_b64_tr_b16 v[154:155], v64 offset:2304
  ds_read_b128 v[168:171], v65 offset:128
  ds_read_b128 v[140:143], v29 offset:0
  ds_read_b64_tr_b16 v[156:157], v64 offset:3072
  ds_read_b64_tr_b16 v[158:159], v64 offset:3328
  ds_read_b128 v[172:175], v65 offset:192
  s_waitcnt lgkmcnt(0)
  s_cmp_eq_u32 s75, 0
  s_cbranch_scc0 A_M_V0
  v_mfma_f32_16x16x32_bf16 v[56:59], v[144:147], v[128:131], v[56:59]
  v_mfma_f32_16x16x32_bf16 v[60:63], v[160:163], v[128:131], v[60:63]
  v_mfma_f32_16x16x32_bf16 v[56:59], v[148:151], v[132:135], v[56:59]
  v_mfma_f32_16x16x32_bf16 v[60:63], v[164:167], v[132:135], v[60:63]
  v_mfma_f32_16x16x32_bf16 v[56:59], v[152:155], v[136:139], v[56:59]
  v_mfma_f32_16x16x32_bf16 v[60:63], v[168:171], v[136:139], v[60:63]
  v_mfma_f32_16x16x32_bf16 v[56:59], v[156:159], v[140:143], v[56:59]
  v_mfma_f32_16x16x32_bf16 v[60:63], v[172:175], v[140:143], v[60:63]
  s_branch A_M_S0
A_M_V0:
  v_mfma_f32_16x16x32_bf16 v[56:59], v[128:131], v[144:147], v[56:59]
  v_mfma_f32_16x16x32_bf16 v[56:59], v[132:135], v[148:151], v[56:59]
  v_mfma_f32_16x16x32_bf16 v[56:59], v[136:139], v[152:155], v[56:59]
  v_mfma_f32_16x16x32_bf16 v[56:59], v[140:143], v[156:159], v[56:59]
A_M_S0:
  s_waitcnt vmcnt(10)
  s_waitcnt lgkmcnt(0)
  s_barrier
  s_lshl_b32 s67, s92, 10
  s_add_u32 m0, s67, 83968
  s_lshl_b32 s67, s82, 15
  s_add_u32 s67, s67, s78
  buffer_load_dwordx4 v250, s[44:47], s67 offen lds
  s_add_u32 m0, s93, 83968
  s_mul_i32 s67, s82, 114688
  s_add_u32 s67, s67, s79
  buffer_load_dwordx4 v251, s[40:43], s67 offen lds
  s_add_u32 m0, m0, 1024
  s_nop 0
  buffer_load_dwordx4 v252, s[40:43], s67 offen lds
  s_add_u32 m0, m0, 1024
  s_nop 0
  buffer_load_dwordx4 v253, s[40:43], s67 offen lds
  s_add_u32 m0, m0, 1024
  s_nop 0
  buffer_load_dwordx4 v254, s[40:43], s67 offen lds
  s_add_u32 s82, s82, 1
  s_and_b32 s82, s82, 15
  s_add_u32 s67, s81, 1
  s_and_b32 s67, s67, 3
  s_lshl_b32 s68, s67, 12
  v_add_u32 v64, s68, v30
  s_lshl_b32 s68, s67, 8
  v_add_u32 v65, s68, v31
  ds_read_b128 v[128:131], v26 offset:16384
  ds_read_b64_tr_b16 v[144:145], v64 offset:0
  ds_read_b64_tr_b16 v[146:147], v64 offset:256
  ds_read_b128 v[160:163], v65 offset:0
  ds_read_b128 v[132:135], v27 offset:16384
  ds_read_b64_tr_b16 v[148:149], v64 offset:1024
  ds_read_b64_tr_b16 v[150:151], v64 offset:1280
  ds_read_b128 v[164:167], v65 offset:64
  ds_read_b128 v[136:139], v28 offset:16384
  ds_read_b64_tr_b16 v[152:153], v64 offset:2048
  ds_read_b64_tr_b16 v[154:155], v64 offset:2304
  ds_read_b128 v[168:171], v65 offset:128
  ds_read_b128 v[140:143], v29 offset:16384
  ds_read_b64_tr_b16 v[156:157], v64 offset:3072
  ds_read_b64_tr_b16 v[158:159], v64 offset:3328
  ds_read_b128 v[172:175], v65 offset:192
  s_waitcnt lgkmcnt(0)
  s_cmp_eq_u32 s75, 0
  s_cbranch_scc0 A_M_V1
  v_mfma_f32_16x16x32_bf16 v[56:59], v[144:147], v[128:131], v[56:59]
  v_mfma_f32_16x16x32_bf16 v[60:63], v[160:163], v[128:131], v[60:63]
  v_mfma_f32_16x16x32_bf16 v[56:59], v[148:151], v[132:135], v[56:59]
  v_mfma_f32_16x16x32_bf16 v[60:63], v[164:167], v[132:135], v[60:63]
  v_mfma_f32_16x16x32_bf16 v[56:59], v[152:155], v[136:139], v[56:59]
  v_mfma_f32_16x16x32_bf16 v[60:63], v[168:171], v[136:139], v[60:63]
  v_mfma_f32_16x16x32_bf16 v[56:59], v[156:159], v[140:143], v[56:59]
  v_mfma_f32_16x16x32_bf16 v[60:63], v[172:175], v[140:143], v[60:63]
  s_branch A_M_S1
A_M_V1:
  v_mfma_f32_16x16x32_bf16 v[56:59], v[128:131], v[144:147], v[56:59]
  v_mfma_f32_16x16x32_bf16 v[56:59], v[132:135], v[148:151], v[56:59]
  v_mfma_f32_16x16x32_bf16 v[56:59], v[136:139], v[152:155], v[56:59]
  v_mfma_f32_16x16x32_bf16 v[56:59], v[140:143], v[156:159], v[56:59]
A_M_S1:
  s_add_u32 s67, s81, 2
  s_and_b32 s67, s67, 3
  s_lshl_b32 s68, s67, 12
  v_add_u32 v64, s68, v30
  s_lshl_b32 s68, s67, 8
  v_add_u32 v65, s68, v31
  ds_read_b128 v[128:131], v26 offset:32768
  ds_read_b64_tr_b16 v[144:145], v64 offset:0
  ds_read_b64_tr_b16 v[146:147], v64 offset:256
  ds_read_b128 v[160:163], v65 offset:0
  ds_read_b128 v[132:135], v27 offset:32768
  ds_read_b64_tr_b16 v[148:149], v64 offset:1024
  ds_read_b64_tr_b16 v[150:151], v64 offset:1280
  ds_read_b128 v[164:167], v65 offset:64
  ds_read_b128 v[136:139], v28 offset:32768
  ds_read_b64_tr_b16 v[152:153], v64 offset:2048
  ds_read_b64_tr_b16 v[154:155], v64 offset:2304
  ds_read_b128 v[168:171], v65 offset:128
  ds_read_b128 v[140:143], v29 offset:32768
  ds_read_b64_tr_b16 v[156:157], v64 offset:3072
  ds_read_b64_tr_b16 v[158:159], v64 offset:3328
  ds_read_b128 v[172:175], v65 offset:192
  s_waitcnt lgkmcnt(0)
  s_cmp_eq_u32 s75, 0
  s_cbranch_scc0 A_M_V2
  v_mfma_f32_16x16x32_bf16 v[56:59], v[144:147], v[128:131], v[56:59]
  v_mfma_f32_16x16x32_bf16 v[60:63], v[160:163], v[128:131], v[60:63]
  v_mfma_f32_16x16x32_bf16 v[56:59], v[148:151], v[132:135], v[56:59]
  v_mfma_f32_16x16x32_bf16 v[60:63], v[164:167], v[132:135], v[60:63]
  v_mfma_f32_16x16x32_bf16 v[56:59], v[152:155], v[136:139], v[56:59]
  v_mfma_f32_16x16x32_bf16 v[60:63], v[168:171], v[136:139], v[60:63]
  v_mfma_f32_16x16x32_bf16 v[56:59], v[156:159], v[140:143], v[56:59]
  v_mfma_f32_16x16x32_bf16 v[60:63], v[172:175], v[140:143], v[60:63]
  s_branch A_M_S2
A_M_V2:
  v_mfma_f32_16x16x32_bf16 v[56:59], v[128:131], v[144:147], v[56:59]
  v_mfma_f32_16x16x32_bf16 v[56:59], v[132:135], v[148:151], v[56:59]
  v_mfma_f32_16x16x32_bf16 v[56:59], v[136:139], v[152:155], v[56:59]
  v_mfma_f32_16x16x32_bf16 v[56:59], v[140:143], v[156:159], v[56:59]
A_M_S2:
  s_add_u32 s67, s81, 3
  s_and_b32 s67, s67, 3
  s_lshl_b32 s68, s67, 12
  v_add_u32 v64, s68, v30
  s_lshl_b32 s68, s67, 8
  v_add_u32 v65, s68, v31
  ds_read_b128 v[128:131], v26 offset:49152
  ds_read_b64_tr_b16 v[144:145], v64 offset:0
  ds_read_b64_tr_b16 v[146:147], v64 offset:256
  ds_read_b128 v[160:163], v65 offset:0
  ds_read_b128 v[132:135], v27 offset:49152
  ds_read_b64_tr_b16 v[148:149], v64 offset:1024
  ds_read_b64_tr_b16 v[150:151], v64 offset:1280
  ds_read_b128 v[164:167], v65 offset:64
  ds_read_b128 v[136:139], v28 offset:49152
  ds_read_b64_tr_b16 v[152:153], v64 offset:2048
  ds_read_b64_tr_b16 v[154:155], v64 offset:2304
  ds_read_b128 v[168:171], v65 offset:128
  ds_read_b128 v[140:143], v29 offset:49152
  ds_read_b64_tr_b16 v[156:157], v64 offset:3072
  ds_read_b64_tr_b16 v[158:159], v64 offset:3328
  ds_read_b128 v[172:175], v65 offset:192
  s_waitcnt lgkmcnt(0)
  s_cmp_eq_u32 s75, 0
  s_cbranch_scc0 A_M_V3
  v_mfma_f32_16x16x32_bf16 v[56:59], v[144:147], v[128:131], v[56:59]
  v_mfma_f32_16x16x32_bf16 v[60:63], v[160:163], v[128:131], v[60:63]
  v_mfma_f32_16x16x32_bf16 v[56:59], v[148:151], v[132:135], v[56:59]
  v_mfma_f32_16x16x32_bf16 v[60:63], v[164:167], v[132:135], v[60:63]
  v_mfma_f32_16x16x32_bf16 v[56:59], v[152:155], v[136:139], v[56:59]
  v_mfma_f32_16x16x32_bf16 v[60:63], v[168:171], v[136:139], v[60:63]
  v_mfma_f32_16x16x32_bf16 v[56:59], v[156:159], v[140:143], v[56:59]
  v_mfma_f32_16x16x32_bf16 v[60:63], v[172:175], v[140:143], v[60:63]
  s_branch A_M_S3
A_M_V3:
  v_mfma_f32_16x16x32_bf16 v[56:59], v[128:131], v[144:147], v[56:59]
  v_mfma_f32_16x16x32_bf16 v[56:59], v[132:135], v[148:151], v[56:59]
  v_mfma_f32_16x16x32_bf16 v[56:59], v[136:139], v[152:155], v[56:59]
  v_mfma_f32_16x16x32_bf16 v[56:59], v[140:143], v[156:159], v[56:59]
A_M_S3:
  v_and_b32 v8, 15, v1
  v_lshrrev_b32 v9, 4, v1
  s_nop 5
  v_cvt_pk_bf16_f32 v32, v56, v57
  v_cvt_pk_bf16_f32 v33, v58, v59
  v_and_b32 v10, 1, v9
  v_lshrrev_b32 v11, 1, v9
  v_lshlrev_b32 v11, 3, v11
  v_lshl_add_u32 v11, v8, 4, v11
  s_lshl_b32 s67, s64, 1
  s_lshr_b32 s68, s76, 1
  s_add_u32 s67, s67, s68
  s_lshl_b32 s67, s67, 10
  s_and_b32 s68, s76, 1
  s_lshl_b32 s73, s64, 2
  s_add_u32 s73, s73, s76
  s_lshl_b32 s73, s73, 2
  v_lshlrev_b32 v36, 16, v32
  v_and_b32 v37, 0xffff0000, v32
  v_lshlrev_b32 v38, 16, v33
  v_and_b32 v39, 0xffff0000, v33
  s_cmp_eq_u32 s75, 0
  s_cbranch_scc0 A_M_VST
  v_lshl_add_u32 v11, v10, 9, v11
  s_lshl_b32 s68, s68, 8
  s_add_u32 s67, s67, s68
  s_add_u32 s67, s67, 2097152
  buffer_store_dwordx2 v[32:33], v11, s[8:11], s67 offen sc1
  v_mul_f32 v40, v36, v36
  v_fmac_f32 v40, v37, v37
  v_fmac_f32 v40, v38, v38
  v_fmac_f32 v40, v39, v39
  v_mov_b32 v41, v40
  s_nop 1
  v_permlane32_swap_b32 v40, v41
  v_add_f32 v40, v40, v41
  v_mov_b32 v41, v40
  s_nop 1
  v_permlane16_swap_b32 v40, v41
  v_add_f32 v40, v40, v41
  s_nop 1
  v_max_u32_dpp v40, v40, v40 row_shr:1 row_mask:0xf bank_mask:0xf
  s_nop 1
  v_max_u32_dpp v40, v40, v40 row_shr:2 row_mask:0xf bank_mask:0xf
  s_nop 1
  v_max_u32_dpp v40, v40, v40 row_shr:4 row_mask:0xf bank_mask:0xf
  s_nop 1
  v_max_u32_dpp v40, v40, v40 row_shr:8 row_mask:0xf bank_mask:0xf
  s_nop 0
  v_readlane_b32 s74, v40, 15
  v_mul_f32 v60, 0xbfb8aa3b, v60
  v_exp_f32 v60, v60
  s_nop 0
  v_add_f32 v60, 1.0, v60
  v_rcp_f32 v60, v60
  v_lshlrev_b32 v12, 2, v1
  s_lshl_b32 s67, s73, 4
  s_add_u32 s67, s67, 2228224
  s_add_u32 s73, s73, 2236416
  s_mov_b64 exec, 0xffff
  buffer_store_dword v60, v12, s[8:11], s67 offen sc1
  s_branch A_M_MX
A_M_VST:
  v_lshl_add_u32 v11, v10, 8, v11
  s_lshl_b32 s68, s68, 9
  s_add_u32 s67, s67, s68
  s_add_u32 s68, s67, 2293760
  s_add_u32 s67, s67, 2162688
  buffer_store_dwordx2 v[32:33], v11, s[8:11], s68 offen sc1
  v_cvt_pkrtz_f16_f32 v40, v36, v37
  v_cvt_pkrtz_f16_f32 v41, v38, v39
  buffer_store_dwordx2 v[40:41], v11, s[8:11], s67 offen sc1
  v_and_b32 v36, 0x7fffffff, v36
  v_and_b32 v37, 0x7fffffff, v37
  v_and_b32 v38, 0x7fffffff, v38
  v_and_b32 v39, 0x7fffffff, v39
  v_max_u32 v36, v36, v37
  v_max3_u32 v36, v36, v38, v39
  v_mov_b32 v37, v36
  s_nop 1
  v_permlane32_swap_b32 v36, v37
  v_max_u32 v36, v36, v37
  v_mov_b32 v37, v36
  s_nop 1
  v_permlane16_swap_b32 v36, v37
  v_max_u32 v36, v36, v37
  s_nop 1
  v_max_u32_dpp v36, v36, v36 row_shr:1 row_mask:0xf bank_mask:0xf
  s_nop 1
  v_max_u32_dpp v36, v36, v36 row_shr:2 row_mask:0xf bank_mask:0xf
  s_nop 1
  v_max_u32_dpp v36, v36, v36 row_shr:4 row_mask:0xf bank_mask:0xf
  s_nop 1
  v_max_u32_dpp v36, v36, v36 row_shr:8 row_mask:0xf bank_mask:0xf
  s_nop 0
  v_readlane_b32 s74, v36, 15
  s_add_u32 s73, s73, 2236928
A_M_MX:
  s_mov_b64 exec, 1
  v_mov_b32 v42, s74
  v_mov_b32 v43, 0
  buffer_store_dword v42, v43, s[8:11], s73 offen sc1
  s_mov_b64 exec, -1
  s_waitcnt vmcnt(13)
  s_waitcnt lgkmcnt(0)
  s_barrier
  s_lshl_b32 s67, s92, 10
  s_add_u32 m0, s67, 102400
  s_lshl_b32 s67, s82, 15
  s_add_u32 s67, s67, s78
  buffer_load_dwordx4 v250, s[44:47], s67 offen lds
  s_add_u32 m0, s93, 102400
  s_mul_i32 s67, s82, 114688
  s_add_u32 s67, s67, s79
  buffer_load_dwordx4 v251, s[40:43], s67 offen lds
  s_add_u32 m0, m0, 1024
  s_nop 0
  buffer_load_dwordx4 v252, s[40:43], s67 offen lds
  s_add_u32 m0, m0, 1024
  s_nop 0
  buffer_load_dwordx4 v253, s[40:43], s67 offen lds
  s_add_u32 m0, m0, 1024
  s_nop 0
  buffer_load_dwordx4 v254, s[40:43], s67 offen lds
  s_add_u32 s82, s82, 1
  s_and_b32 s82, s82, 15
  s_waitcnt vmcnt(13)
  s_waitcnt lgkmcnt(0)
  s_barrier
  s_lshl_b32 s67, s92, 10
  s_add_u32 m0, s67, 120832
  s_lshl_b32 s67, s82, 15
  s_add_u32 s67, s67, s78
  buffer_load_dwordx4 v250, s[44:47], s67 offen lds
  s_add_u32 m0, s93, 120832
  s_mul_i32 s67, s82, 114688
  s_add_u32 s67, s67, s79
  buffer_load_dwordx4 v251, s[40:43], s67 offen lds
  s_add_u32 m0, m0, 1024
  s_nop 0
  buffer_load_dwordx4 v252, s[40:43], s67 offen lds
  s_add_u32 m0, m0, 1024
  s_nop 0
  buffer_load_dwordx4 v253, s[40:43], s67 offen lds
  s_add_u32 m0, m0, 1024
  s_nop 0
  buffer_load_dwordx4 v254, s[40:43], s67 offen lds
  s_add_u32 s82, s82, 1
  s_and_b32 s82, s82, 15
  s_waitcnt vmcnt(13)
  s_waitcnt lgkmcnt(0)
  s_barrier
  s_lshl_b32 s67, s92, 10
  s_add_u32 m0, s67, 65536
  s_lshl_b32 s67, s82, 15
  s_add_u32 s67, s67, s78
  buffer_load_dwordx4 v250, s[44:47], s67 offen lds
  s_add_u32 m0, s93, 65536
  s_mul_i32 s67, s82, 114688
  s_add_u32 s67, s67, s79
  buffer_load_dwordx4 v251, s[40:43], s67 offen lds
  s_add_u32 m0, m0, 1024
  s_nop 0
  buffer_load_dwordx4 v252, s[40:43], s67 offen lds
  s_add_u32 m0, m0, 1024
  s_nop 0
  buffer_load_dwordx4 v253, s[40:43], s67 offen lds
  s_add_u32 m0, m0, 1024
  s_nop 0
  buffer_load_dwordx4 v254, s[40:43], s67 offen lds
  s_add_u32 s82, s82, 1
  s_and_b32 s82, s82, 15
  s_waitcnt vmcnt(10)
  s_waitcnt lgkmcnt(0)
  s_barrier
  s_lshl_b32 s67, s92, 10
  s_add_u32 m0, s67, 83968
  s_lshl_b32 s67, s82, 15
  s_add_u32 s67, s67, s78
  buffer_load_dwordx4 v250, s[44:47], s67 offen lds
  s_add_u32 m0, s93, 83968
  s_mul_i32 s67, s82, 114688
  s_add_u32 s67, s67, s79
  buffer_load_dwordx4 v251, s[40:43], s67 offen lds
  s_add_u32 m0, m0, 1024
  s_nop 0
  buffer_load_dwordx4 v252, s[40:43], s67 offen lds
  s_add_u32 m0, m0, 1024
  s_nop 0
  buffer_load_dwordx4 v253, s[40:43], s67 offen lds
  s_add_u32 m0, m0, 1024
  s_nop 0
  buffer_load_dwordx4 v254, s[40:43], s67 offen lds
  s_add_u32 s82, s82, 1
  s_and_b32 s82, s82, 15
  s_waitcnt vmcnt(10)
  s_waitcnt lgkmcnt(0)
  s_barrier
  s_lshl_b32 s67, s92, 10
  s_add_u32 m0, s67, 102400
  s_lshl_b32 s67, s82, 15
  s_add_u32 s67, s67, s78
  buffer_load_dwordx4 v250, s[44:47], s67 offen lds
  s_add_u32 m0, s93, 102400
  s_mul_i32 s67, s82, 114688
  s_add_u32 s67, s67, s79
  buffer_load_dwordx4 v251, s[40:43], s67 offen lds
  s_add_u32 m0, m0, 1024
  s_nop 0
  buffer_load_dwordx4 v252, s[40:43], s67 offen lds
  s_add_u32 m0, m0, 1024
  s_nop 0
  buffer_load_dwordx4 v253, s[40:43], s67 offen lds
  s_add_u32 m0, m0, 1024
  s_nop 0
  buffer_load_dwordx4 v254, s[40:43], s67 offen lds
  s_add_u32 s82, s82, 1
  s_and_b32 s82, s82, 15
  s_waitcnt vmcnt(10)
  s_waitcnt lgkmcnt(0)
  s_barrier
  s_lshl_b32 s67, s92, 10
  s_add_u32 m0, s67, 120832
  s_lshl_b32 s67, s82, 15
  s_add_u32 s67, s67, s78
  buffer_load_dwordx4 v250, s[44:47], s67 offen lds
  s_add_u32 m0, s93, 120832
  s_mul_i32 s67, s82, 114688
  s_add_u32 s67, s67, s79
  buffer_load_dwordx4 v251, s[40:43], s67 offen lds
  s_add_u32 m0, m0, 1024
  s_nop 0
  buffer_load_dwordx4 v252, s[40:43], s67 offen lds
  s_add_u32 m0, m0, 1024
  s_nop 0
  buffer_load_dwordx4 v253, s[40:43], s67 offen lds
  s_add_u32 m0, m0, 1024
  s_nop 0
  buffer_load_dwordx4 v254, s[40:43], s67 offen lds
  s_add_u32 s82, s82, 1
  s_and_b32 s82, s82, 15
  s_mov_b32 s16, s66
  s_mov_b32 s17, s64
  s_mov_b32 s18, s65
  s_lshl_b32 s32, s16, 10
  s_lshr_b32 s22, s16, 2
  s_and_b32 s28, s16, 3
  s_and_b32 s30, s16, 1
  s_bfe_u32 s29, s16, 0x10001
  s_lshr_b32 s35, s16, 1
  s_lshl_b32 s23, s18, 2
  s_add_u32 s23, s23, s28
  s_lshl_b32 s33, s17, 1
  s_add_u32 s33, s33, s22
  s_lshl_b32 s33, s33, 5
  s_add_u32 s33, s33, s23
  s_lshl_b32 s33, s33, 10
  s_add_u32 s37, s33, 13631488
  s_mul_i32 s19, s16, 14
  s_lshl_b32 s20, s18, 1
  s_add_u32 s20, s20, s29
  s_mul_i32 s24, s20, 112
  s_xor_b32 s20, s20, 1
  s_mul_i32 s25, s20, 112
  s_lshl_b32 s20, s17, 1
  s_add_u32 s20, s20, s30
  s_mul_i32 s26, s20, 112
  s_xor_b32 s20, s20, 1
  s_mul_i32 s27, s20, 112
  s_add_u32 s24, s24, s19
  s_lshl_b32 s24, s24, 10
  s_add_u32 s24, s24, 10485760
  s_add_u32 s25, s25, s19
  s_lshl_b32 s25, s25, 10
  s_add_u32 s25, s25, 10485760
  s_add_u32 s26, s26, s19
  s_lshl_b32 s26, s26, 10
  s_add_u32 s26, s26, 3145728
  s_add_u32 s27, s27, s19
  s_lshl_b32 s27, s27, 10
  s_add_u32 s27, s27, 3145728
  s_lshl_b32 s19, s17, 8
  s_add_u32 s19, s19, 2240512
  s_lshl_b32 s20, s18, 5
  s_add_u32 s50, s19, s20
  s_lshl_b32 s20, s16, 2
  s_add_u32 s50, s50, s20
  s_lshl_b32 s20, s16, 5
  s_add_u32 s51, s19, s20
  v_and_b32 v249, 7, v1
  v_lshlrev_b32 v249, 2, v249
  v_and_b32 v8, 31, v1
  v_lshrrev_b32 v9, 5, v1
  v_and_b32 v10, 11, v1
  v_cmp_eq_u32 vcc, 0, v10
  v_mov_b32 v10, 0x3c003c00
  s_nop 0
  v_cndmask_b32 v132, 0, v10, vcc
  v_mov_b32 v133, v132
  v_mov_b32 v134, v132
  v_mov_b32 v135, v132
  s_lshl_b32 s19, s16, 10
  s_add_u32 s19, s19, 155648
  v_add_u32 v10, s19, v5
  ds_write_b128 v10, v[132:135]
  s_nop 1
  v_lshlrev_b32 v10, 8, v9
  v_lshl_add_u32 v10, v8, 4, v10
  v_add_u32 v10, 65536, v10
  v_subrev_u32 v11, 20, v8
  v_cmp_gt_u32 vcc, 8, v11
  v_mov_b32 v11, 155648
  v_mov_b32 v12, 155712
  v_cndmask_b32 v11, v11, v12, vcc
  v_and_b32 v12, 11, v8
  v_cmp_ne_u32 vcc, 0, v12
  v_add_u32 v12, 16, v11
  s_nop 0
  v_cndmask_b32 v11, v11, v12, vcc
  v_cmp_gt_u32 vcc, 16, v8
  s_nop 1
  v_cndmask_b32 v3, v11, v10, vcc
  v_mov_b32 v11, 8192
  v_cndmask_b32 v4, 0, v11, vcc
  v_lshlrev_b32 v6, 2, v8
  v_mov_b32 v136, 0
  v_mov_b32 v137, 0
  v_mov_b32 v138, 0
  v_mov_b32 v139, 0
  v_mov_b32 v140, 0
  v_mov_b32 v141, 0
  v_mov_b32 v142, 0
  v_mov_b32 v143, 0
  v_mov_b32 v144, 0
  v_mov_b32 v145, 0
  v_mov_b32 v146, 0
  v_mov_b32 v147, 0
  v_mov_b32 v148, 0
  v_mov_b32 v149, 0
  v_mov_b32 v150, 0
  v_mov_b32 v151, 0
  v_mov_b32 v152, 0
  v_mov_b32 v153, 0
  v_mov_b32 v154, 0
  v_mov_b32 v155, 0
  v_mov_b32 v156, 0
  v_mov_b32 v157, 0
  v_mov_b32 v158, 0
  v_mov_b32 v159, 0
  v_mov_b32 v160, 0
  v_mov_b32 v161, 0
  v_mov_b32 v162, 0
  v_mov_b32 v163, 0
  v_mov_b32 v164, 0
  v_mov_b32 v165, 0
  v_mov_b32 v166, 0
  v_mov_b32 v167, 0
  v_mov_b32 v168, 0
  v_mov_b32 v169, 0
  v_mov_b32 v170, 0
  v_mov_b32 v171, 0
  v_mov_b32 v172, 0
  v_mov_b32 v173, 0
  v_mov_b32 v174, 0
  v_mov_b32 v175, 0
  v_mov_b32 v176, 0
  v_mov_b32 v177, 0
  v_mov_b32 v178, 0
  v_mov_b32 v179, 0
  v_mov_b32 v180, 0
  v_mov_b32 v181, 0
  v_mov_b32 v182, 0
  v_mov_b32 v183, 0
  v_mov_b32 v184, 0
  v_mov_b32 v185, 0
  v_mov_b32 v186, 0
  v_mov_b32 v187, 0
  v_mov_b32 v188, 0
  v_mov_b32 v189, 0
  v_mov_b32 v190, 0
  v_mov_b32 v191, 0
  v_mov_b32 v192, 0
  v_mov_b32 v193, 0
  v_mov_b32 v194, 0
  v_mov_b32 v195, 0
  v_mov_b32 v132, 0
  v_mov_b32 v133, 0
  v_mov_b32 v134, 0
  v_mov_b32 v135, 0
  s_lshl_b32 s19, s16, 13
  s_add_u32 s19, s19, 32768
  s_cmp_ge_u32 s16, 3
  s_cselect_b32 s20, 40960, 0
  s_add_u32 s19, s19, s20
  s_cmp_ge_u32 s16, 6
  s_cselect_b32 s20, 16384, 0
  s_add_u32 s19, s19, s20
  v_add_u32 v2, s19, v5
  s_xor_b32 s3, s16, 1
  s_lshl_b32 s19, s3, 13
  s_add_u32 s19, s19, 32768
  s_cmp_ge_u32 s3, 3
  s_cselect_b32 s20, 40960, 0
  s_add_u32 s19, s19, s20
  s_cmp_ge_u32 s3, 6
  s_cselect_b32 s20, 16384, 0
  s_add_u32 s19, s19, s20
  v_add_u32 v21, s19, v5
  s_lshl_b32 s20, s17, 1
  s_add_u32 s20, s20, s30
  s_lshl_b32 s20, s20, 5
  s_lshl_b32 s19, s35, 3
  s_add_u32 s20, s20, s19
  s_lshl_b32 s20, s20, 10
  s_add_u32 s36, s20, 13631488
  s_lshl_b32 s19, s16, 16
  s_lshl_b32 s20, s18, 7
  s_add_u32 s38, s19, s20
  v_lshrrev_b32 v14, 3, v1
  v_and_b32 v20, 7, v1
  v_bfe_u32 v13, v14, 1, 1
  v_lshlrev_b32 v13, 2, v13
  v_xor_b32 v20, v20, v13
  v_lshlrev_b32 v20, 4, v20
  v_lshl_add_u32 v20, v14, 10, v20
  s_waitcnt vmcnt(10)
  s_waitcnt lgkmcnt(0)
  s_barrier
  s_lshl_b32 s67, s92, 10
  s_add_u32 m0, s67, 65536
  s_lshl_b32 s67, s82, 15
  s_add_u32 s67, s67, s78
  buffer_load_dwordx4 v250, s[44:47], s67 offen lds
  s_add_u32 m0, s93, 65536
  s_mul_i32 s67, s82, 114688
  s_add_u32 s67, s67, s79
  buffer_load_dwordx4 v251, s[40:43], s67 offen lds
  s_add_u32 m0, m0, 1024
  s_nop 0
  buffer_load_dwordx4 v252, s[40:43], s67 offen lds
  s_add_u32 m0, m0, 1024
  s_nop 0
  buffer_load_dwordx4 v253, s[40:43], s67 offen lds
  s_add_u32 m0, m0, 1024
  s_nop 0
  buffer_load_dwordx4 v254, s[40:43], s67 offen lds
  s_add_u32 s82, s82, 1
  s_and_b32 s82, s82, 15
  s_waitcnt vmcnt(10)
  s_waitcnt lgkmcnt(0)
  s_barrier
  s_lshl_b32 s67, s92, 10
  s_add_u32 m0, s67, 83968
  s_lshl_b32 s67, s82, 15
  s_add_u32 s67, s67, s78
  buffer_load_dwordx4 v250, s[44:47], s67 offen lds
  s_add_u32 m0, s93, 83968
  s_mul_i32 s67, s82, 114688
  s_add_u32 s67, s67, s79
  buffer_load_dwordx4 v251, s[40:43], s67 offen lds
  s_add_u32 m0, m0, 1024
  s_nop 0
  buffer_load_dwordx4 v252, s[40:43], s67 offen lds
  s_add_u32 m0, m0, 1024
  s_nop 0
  buffer_load_dwordx4 v253, s[40:43], s67 offen lds
  s_add_u32 m0, m0, 1024
  s_nop 0
  buffer_load_dwordx4 v254, s[40:43], s67 offen lds
  s_add_u32 s82, s82, 1
  s_and_b32 s82, s82, 15
  s_waitcnt vmcnt(10)
  s_waitcnt lgkmcnt(0)
  s_barrier
  s_lshl_b32 s67, s92, 10
  s_add_u32 m0, s67, 102400
  s_lshl_b32 s67, s82, 15
  s_add_u32 s67, s67, s78
  buffer_load_dwordx4 v250, s[44:47], s67 offen lds
  s_add_u32 m0, s93, 102400
  s_mul_i32 s67, s82, 114688
  s_add_u32 s67, s67, s79
  buffer_load_dwordx4 v251, s[40:43], s67 offen lds
  s_add_u32 m0, m0, 1024
  s_nop 0
  buffer_load_dwordx4 v252, s[40:43], s67 offen lds
  s_add_u32 m0, m0, 1024
  s_nop 0
  buffer_load_dwordx4 v253, s[40:43], s67 offen lds
  s_add_u32 m0, m0, 1024
  s_nop 0
  buffer_load_dwordx4 v254, s[40:43], s67 offen lds
  s_add_u32 s82, s82, 1
  s_and_b32 s82, s82, 15
  s_waitcnt vmcnt(10)
  s_waitcnt lgkmcnt(0)
  s_barrier
  s_lshl_b32 s67, s92, 10
  s_add_u32 m0, s67, 120832
  s_lshl_b32 s67, s82, 15
  s_add_u32 s67, s67, s78
  buffer_load_dwordx4 v250, s[44:47], s67 offen lds
  s_add_u32 m0, s93, 120832
  s_mul_i32 s67, s82, 114688
  s_add_u32 s67, s67, s79
  buffer_load_dwordx4 v251, s[40:43], s67 offen lds
  s_add_u32 m0, m0, 1024
  s_nop 0
  buffer_load_dwordx4 v252, s[40:43], s67 offen lds
  s_add_u32 m0, m0, 1024
  s_nop 0
  buffer_load_dwordx4 v253, s[40:43], s67 offen lds
  s_add_u32 m0, m0, 1024
  s_nop 0
  buffer_load_dwordx4 v254, s[40:43], s67 offen lds
  s_add_u32 s82, s82, 1
  s_and_b32 s82, s82, 15
  s_waitcnt vmcnt(10)
  s_waitcnt lgkmcnt(0)
  s_barrier
  s_waitcnt vmcnt(5)
  s_waitcnt lgkmcnt(0)
  s_barrier
  s_mov_b32 m0, s32
  s_add_u32 s32, s32, 2097152
  buffer_load_dwordx4 v5, s[8:11], s32 offen sc1 lds
  s_add_u32 m0, m0, 65536
  s_add_u32 s32, s32, 65536
  buffer_load_dwordx4 v5, s[8:11], s32 offen sc1 lds
  s_sub_u32 m0, m0, 57344
  s_sub_u32 s32, s32, 57344
  buffer_load_dwordx4 v5, s[8:11], s32 offen sc1 lds
  s_add_u32 m0, m0, 65536
  s_add_u32 s32, s32, 65536
  buffer_load_dwordx4 v5, s[8:11], s32 offen sc1 lds
  s_sub_u32 m0, m0, 57344
  s_sub_u32 s32, s32, 57344
  s_mov_b32 s31, 2236416
  buffer_load_dwordx4 v[244:247], v5, s[8:11], s31 offen sc1
  buffer_load_dwordx4 v[196:199], v5, s[8:11], s24 offen offset:0 sc1
  buffer_load_dwordx4 v[200:203], v5, s[8:11], s25 offen offset:0 sc1
  buffer_load_dwordx4 v[212:215], v5, s[8:11], s24 offen offset:1024 sc1
  buffer_load_dwordx4 v[216:219], v5, s[8:11], s25 offen offset:1024 sc1
  s_waitcnt vmcnt(9)
  s_waitcnt lgkmcnt(0)
  s_barrier
  v_mov_b32 v100, 0
  v_mov_b32 v101, 0
  v_mov_b32 v102, 0
  v_mov_b32 v103, 0
  v_mov_b32 v104, 0
  v_mov_b32 v105, 0
  v_mov_b32 v106, 0
  v_mov_b32 v107, 0
  v_mov_b32 v108, 0
  v_mov_b32 v109, 0
  v_mov_b32 v110, 0
  v_mov_b32 v111, 0
  v_mov_b32 v112, 0
  v_mov_b32 v113, 0
  v_mov_b32 v114, 0
  v_mov_b32 v115, 0
  s_waitcnt vmcnt(4)
  v_mov_b32 v48, 0x02000200
  v_mov_b32 v49, 0x39a839a8
  s_branch B_ENTRY
A_L7:
  s_lshl_b32 s67, s92, 10
  s_add_u32 m0, s67, 65536
  s_lshl_b32 s67, s82, 15
  s_add_u32 s67, s67, s78
  buffer_load_dwordx4 v250, s[44:47], s67 offen lds
  s_add_u32 m0, s93, 65536
  s_mul_i32 s67, s82, 114688
  s_add_u32 s67, s67, s79
  buffer_load_dwordx4 v251, s[40:43], s67 offen lds
  s_add_u32 m0, m0, 1024
  s_nop 0
  buffer_load_dwordx4 v252, s[40:43], s67 offen lds
  s_add_u32 m0, m0, 1024
  s_nop 0
  buffer_load_dwordx4 v253, s[40:43], s67 offen lds
  s_add_u32 m0, m0, 1024
  s_nop 0
  buffer_load_dwordx4 v254, s[40:43], s67 offen lds
  s_add_u32 s82, s82, 1
  s_and_b32 s82, s82, 15
  s_lshl_b32 s67, s92, 10
  s_add_u32 m0, s67, 83968
  s_lshl_b32 s67, s82, 15
  s_add_u32 s67, s67, s78
  buffer_load_dwordx4 v250, s[44:47], s67 offen lds
  s_add_u32 m0, s93, 83968
  s_mul_i32 s67, s82, 114688
  s_add_u32 s67, s67, s79
  buffer_load_dwordx4 v251, s[40:43], s67 offen lds
  s_add_u32 m0, m0, 1024
  s_nop 0
  buffer_load_dwordx4 v252, s[40:43], s67 offen lds
  s_add_u32 m0, m0, 1024
  s_nop 0
  buffer_load_dwordx4 v253, s[40:43], s67 offen lds
  s_add_u32 m0, m0, 1024
  s_nop 0
  buffer_load_dwordx4 v254, s[40:43], s67 offen lds
  s_add_u32 s82, s82, 1
  s_and_b32 s82, s82, 15
  s_add_u32 s67, s81, 1
  s_and_b32 s67, s67, 3
  s_add_u32 m0, s83, 16384
  s_lshl_b32 s67, s67, 8
  s_add_u32 s67, s67, s72
  buffer_load_dwordx4 v16, s[36:39], s67 offen lds
  s_add_u32 m0, m0, 1024
  s_add_u32 s67, s67, 4096
  buffer_load_dwordx4 v17, s[36:39], s67 offen lds
  s_add_u32 m0, m0, 1024
  s_add_u32 s67, s67, 4096
  buffer_load_dwordx4 v18, s[36:39], s67 offen lds
  s_add_u32 m0, m0, 1024
  s_add_u32 s67, s67, 4096
  buffer_load_dwordx4 v19, s[36:39], s67 offen lds
  s_lshl_b32 s67, s92, 10
  s_add_u32 m0, s67, 102400
  s_lshl_b32 s67, s82, 15
  s_add_u32 s67, s67, s78
  buffer_load_dwordx4 v250, s[44:47], s67 offen lds
  s_add_u32 m0, s93, 102400
  s_mul_i32 s67, s82, 114688
  s_add_u32 s67, s67, s79
  buffer_load_dwordx4 v251, s[40:43], s67 offen lds
  s_add_u32 m0, m0, 1024
  s_nop 0
  buffer_load_dwordx4 v252, s[40:43], s67 offen lds
  s_add_u32 m0, m0, 1024
  s_nop 0
  buffer_load_dwordx4 v253, s[40:43], s67 offen lds
  s_add_u32 m0, m0, 1024
  s_nop 0
  buffer_load_dwordx4 v254, s[40:43], s67 offen lds
  s_add_u32 s82, s82, 1
  s_and_b32 s82, s82, 15
  s_mov_b32 s56, s30
  s_mov_b32 s57, s31
  s_mov_b32 s58, 1835008
  s_mov_b32 s59, 0x00020000
  s_mov_b32 m0, 156672
  s_mov_b32 s67, s94
  buffer_load_dwordx4 v255, s[56:59], s67 offen lds
  s_add_u32 m0, m0, 1024
  s_add_u32 s67, s67, 16384
  buffer_load_dwordx4 v255, s[56:59], s67 offen lds
  s_add_u32 m0, m0, 1024
  s_add_u32 s67, s67, 16384
  buffer_load_dwordx4 v255, s[56:59], s67 offen lds
  s_add_u32 m0, m0, 1024
  s_add_u32 s67, s67, 16384
  buffer_load_dwordx4 v255, s[56:59], s67 offen lds
  s_add_u32 m0, m0, 1024
  s_add_u32 s67, s67, 16384
  buffer_load_dwordx4 v255, s[56:59], s67 offen lds
  s_add_u32 m0, m0, 1024
  s_add_u32 s67, s67, 16384
  buffer_load_dwordx4 v255, s[56:59], s67 offen lds
  s_add_u32 m0, m0, 1024
  s_add_u32 s67, s67, 16384
  buffer_load_dwordx4 v255, s[56:59], s67 offen lds
  s_lshl_b32 s67, s92, 10
  s_add_u32 m0, s67, 120832
  s_lshl_b32 s67, s82, 15
  s_add_u32 s67, s67, s78
  buffer_load_dwordx4 v250, s[44:47], s67 offen lds
  s_add_u32 m0, s93, 120832
  s_mul_i32 s67, s82, 114688
  s_add_u32 s67, s67, s79
  buffer_load_dwordx4 v251, s[40:43], s67 offen lds
  s_add_u32 m0, m0, 1024
  s_nop 0
  buffer_load_dwordx4 v252, s[40:43], s67 offen lds
  s_add_u32 m0, m0, 1024
  s_nop 0
  buffer_load_dwordx4 v253, s[40:43], s67 offen lds
  s_add_u32 m0, m0, 1024
  s_nop 0
  buffer_load_dwordx4 v254, s[40:43], s67 offen lds
  s_add_u32 s82, s82, 1
  s_and_b32 s82, s82, 15
  s_mov_b32 s8, s54
  s_mov_b32 s9, s55
  s_mov_b32 s10, 16777216
  s_mov_b32 s11, 0x00020000
  s_mov_b32 s12, s52
  s_mov_b32 s13, s53
  s_mov_b32 s14, 256
  s_mov_b32 s15, 0x00020000
  s_mov_b64 s[4:5], s[24:25]
  s_mov_b64 s[6:7], s[34:35]
  v_lshrrev_b32 v8, 5, v1
  v_bfe_u32 v10, v1, 2, 2
  v_lshl_add_u32 v11, v8, 2, v10
  v_lshlrev_b32 v11, 6, v11
  v_bfe_u32 v12, v1, 4, 1
  v_lshl_add_u32 v11, v12, 5, v11
  v_and_b32 v13, 3, v1
  v_lshl_add_u32 v11, v13, 3, v11
  v_add_u32 v28, 156672, v11
  s_lshl_b32 s67, s64, 3
  s_add_u32 s67, s67, s65
  s_lshl_b32 s73, s67, 5
  s_add_u32 s73, s73, 2240512
  s_and_b32 s68, s67, 15
  s_mul_i32 s68, s68, 112
  s_lshr_b32 s67, s67, 4
  s_mul_i32 s67, s67, 7
  s_add_u32 s67, s67, s68
  s_lshl_b32 s67, s67, 10
  s_add_u32 s77, s67, 10485760
  s_lshl_b32 s95, s2, 13
  s_add_u32 s95, s95, 13631488
  v_mov_b32 v40, -1
  v_mov_b32 v41, -1
  v_mov_b32 v42, -1
  v_mov_b32 v43, -1
  v_mov_b32 v36, 0
  v_mov_b32 v37, 0
  v_mov_b32 v38, 0
  v_mov_b32 v39, 0
  s_mov_b64 exec, 3
  buffer_store_dwordx4 v[36:39], v5, s[8:11], s73 offen sc1
  s_mov_b64 exec, -1
  buffer_store_dwordx4 v[40:43], v5, s[8:11], s95 offen offset:0 sc1
  buffer_store_dwordx4 v[40:43], v5, s[8:11], s95 offen offset:1024 sc1
  buffer_store_dwordx4 v[40:43], v5, s[8:11], s95 offen offset:2048 sc1
  buffer_store_dwordx4 v[40:43], v5, s[8:11], s95 offen offset:3072 sc1
  s_add_u32 s95, s95, 4096
  buffer_store_dwordx4 v[40:43], v5, s[8:11], s95 offen offset:0 sc1
  buffer_store_dwordx4 v[40:43], v5, s[8:11], s95 offen offset:1024 sc1
  buffer_store_dwordx4 v[40:43], v5, s[8:11], s95 offen offset:2048 sc1
  buffer_store_dwordx4 v[40:43], v5, s[8:11], s95 offen offset:3072 sc1
  s_waitcnt vmcnt(35)
  s_barrier
  s_waitcnt vmcnt(30)
  s_waitcnt lgkmcnt(0)
  s_barrier
  s_lshl_b32 s67, s92, 10
  s_add_u32 m0, s67, 65536
  s_lshl_b32 s67, s82, 15
  s_add_u32 s67, s67, s78
  buffer_load_dwordx4 v250, s[44:47], s67 offen lds
  s_add_u32 m0, s93, 65536
  s_mul_i32 s67, s82, 114688
  s_add_u32 s67, s67, s79
  buffer_load_dwordx4 v251, s[40:43], s67 offen lds
  s_add_u32 m0, m0, 1024
  s_nop 0
  buffer_load_dwordx4 v252, s[40:43], s67 offen lds
  s_add_u32 m0, m0, 1024
  s_nop 0
  buffer_load_dwordx4 v253, s[40:43], s67 offen lds
  s_add_u32 m0, m0, 1024
  s_nop 0
  buffer_load_dwordx4 v254, s[40:43], s67 offen lds
  s_add_u32 s82, s82, 1
  s_and_b32 s82, s82, 15
  s_waitcnt vmcnt(26)
  s_waitcnt vmcnt(19)
  s_waitcnt lgkmcnt(0)
  s_barrier
  ds_read_b64_tr_b16 v[44:45], v28 offset:0
  ds_read_b64_tr_b16 v[46:47], v28 offset:512
  ds_read_b64_tr_b16 v[48:49], v28 offset:1024
  ds_read_b64_tr_b16 v[50:51], v28 offset:1536
  ds_read_b64_tr_b16 v[52:53], v28 offset:2048
  ds_read_b64_tr_b16 v[54:55], v28 offset:2560
  ds_read_b64_tr_b16 v[56:57], v28 offset:3072
  ds_read_b64_tr_b16 v[58:59], v28 offset:3584
  ds_read_b64_tr_b16 v[60:61], v28 offset:4096
  ds_read_b64_tr_b16 v[62:63], v28 offset:4608
  ds_read_b64_tr_b16 v[64:65], v28 offset:5120
  ds_read_b64_tr_b16 v[66:67], v28 offset:5632
  ds_read_b64_tr_b16 v[68:69], v28 offset:6144
  ds_read_b64_tr_b16 v[70:71], v28 offset:6656
  s_lshl_b32 s67, s92, 10
  s_add_u32 m0, s67, 83968
  s_lshl_b32 s67, s82, 15
  s_add_u32 s67, s67, s78
  buffer_load_dwordx4 v250, s[44:47], s67 offen lds
  s_add_u32 m0, s93, 83968
  s_mul_i32 s67, s82, 114688
  s_add_u32 s67, s67, s79
  buffer_load_dwordx4 v251, s[40:43], s67 offen lds
  s_add_u32 m0, m0, 1024
  s_nop 0
  buffer_load_dwordx4 v252, s[40:43], s67 offen lds
  s_add_u32 m0, m0, 1024
  s_nop 0
  buffer_load_dwordx4 v253, s[40:43], s67 offen lds
  s_add_u32 m0, m0, 1024
  s_nop 0
  buffer_load_dwordx4 v254, s[40:43], s67 offen lds
  s_add_u32 s82, s82, 1
  s_and_b32 s82, s82, 15
  s_waitcnt lgkmcnt(12)
  buffer_store_dwordx4 v[44:47], v5, s[8:11], s77 offen sc1
  s_add_u32 s77, s77, 1024
  s_waitcnt lgkmcnt(10)
  buffer_store_dwordx4 v[48:51], v5, s[8:11], s77 offen sc1
  s_add_u32 s77, s77, 1024
  s_waitcnt lgkmcnt(8)
  buffer_store_dwordx4 v[52:55], v5, s[8:11], s77 offen sc1
  s_add_u32 s77, s77, 1024
  s_waitcnt lgkmcnt(6)
  buffer_store_dwordx4 v[56:59], v5, s[8:11], s77 offen sc1
  s_add_u32 s77, s77, 1024
  s_waitcnt lgkmcnt(4)
  buffer_store_dwordx4 v[60:63], v5, s[8:11], s77 offen sc1
  s_add_u32 s77, s77, 1024
  s_waitcnt lgkmcnt(2)
  buffer_store_dwordx4 v[64:67], v5, s[8:11], s77 offen sc1
  s_add_u32 s77, s77, 1024
  s_waitcnt lgkmcnt(0)
  buffer_store_dwordx4 v[68:71], v5, s[8:11], s77 offen sc1
  s_add_u32 s77, s77, 1024
  s_waitcnt vmcnt(26)
  s_waitcnt lgkmcnt(0)
  s_barrier
  buffer_load_dword v27, off, s[12:15], 0 sc1
  s_lshl_b32 s67, s92, 10
  s_add_u32 m0, s67, 102400
  s_lshl_b32 s67, s82, 15
  s_add_u32 s67, s67, s78
  buffer_load_dwordx4 v250, s[44:47], s67 offen lds
  s_add_u32 m0, s93, 102400
  s_mul_i32 s67, s82, 114688
  s_add_u32 s67, s67, s79
  buffer_load_dwordx4 v251, s[40:43], s67 offen lds
  s_add_u32 m0, m0, 1024
  s_nop 0
  buffer_load_dwordx4 v252, s[40:43], s67 offen lds
  s_add_u32 m0, m0, 1024
  s_nop 0
  buffer_load_dwordx4 v253, s[40:43], s67 offen lds
  s_add_u32 m0, m0, 1024
  s_nop 0
  buffer_load_dwordx4 v254, s[40:43], s67 offen lds
  s_add_u32 s82, s82, 1
  s_and_b32 s82, s82, 15
  s_waitcnt vmcnt(18)
  s_waitcnt lgkmcnt(0)
  s_barrier
  s_lshl_b32 s67, s92, 10
  s_add_u32 m0, s67, 120832
  s_lshl_b32 s67, s82, 15
  s_add_u32 s67, s67, s78
  buffer_load_dwordx4 v250, s[44:47], s67 offen lds
  s_add_u32 m0, s93, 120832
  s_mul_i32 s67, s82, 114688
  s_add_u32 s67, s67, s79
  buffer_load_dwordx4 v251, s[40:43], s67 offen lds
  s_add_u32 m0, m0, 1024
  s_nop 0
  buffer_load_dwordx4 v252, s[40:43], s67 offen lds
  s_add_u32 m0, m0, 1024
  s_nop 0
  buffer_load_dwordx4 v253, s[40:43], s67 offen lds
  s_add_u32 m0, m0, 1024
  s_nop 0
  buffer_load_dwordx4 v254, s[40:43], s67 offen lds
  s_add_u32 s82, s82, 1
  s_and_b32 s82, s82, 15
  s_waitcnt vmcnt(18)
  s_waitcnt lgkmcnt(0)
  s_barrier
  s_lshl_b32 s67, s92, 10
  s_add_u32 m0, s67, 65536
  s_lshl_b32 s67, s82, 15
  s_add_u32 s67, s67, s78
  buffer_load_dwordx4 v250, s[44:47], s67 offen lds
  s_add_u32 m0, s93, 65536
  s_mul_i32 s67, s82, 114688
  s_add_u32 s67, s67, s79
  buffer_load_dwordx4 v251, s[40:43], s67 offen lds
  s_add_u32 m0, m0, 1024
  s_nop 0
  buffer_load_dwordx4 v252, s[40:43], s67 offen lds
  s_add_u32 m0, m0, 1024
  s_nop 0
  buffer_load_dwordx4 v253, s[40:43], s67 offen lds
  s_add_u32 m0, m0, 1024
  s_nop 0
  buffer_load_dwordx4 v254, s[40:43], s67 offen lds
  s_add_u32 s82, s82, 1
  s_and_b32 s82, s82, 15
  s_waitcnt vmcnt(10)
  s_mov_b32 s67, 8192
A_RDW:
  v_cmp_ne_u32 vcc, 1, v27
  s_cbranch_vccz A_RDWOK
  s_sub_u32 s67, s67, 1
  s_cmp_eq_u32 s67, 0
  s_cbranch_scc1 A_RDWOK
  buffer_load_dword v27, off, s[12:15], 0 sc1
  s_waitcnt vmcnt(0)
  s_branch A_RDW
A_RDWOK:
  s_waitcnt lgkmcnt(0)
  s_barrier
  v_mov_b32 v26, 1
  s_and_b32 s67, s2, 63
  s_lshl_b32 s67, s67, 4
  s_lshr_b32 s68, s2, 6
  s_lshl_b32 s68, s68, 10
  s_add_u32 s67, s67, s68
  s_add_u32 s67, s67, 2260992
  buffer_store_dword v26, off, s[8:11], s67 sc1
  s_lshl_b32 s67, s92, 10
  s_add_u32 m0, s67, 83968
  s_lshl_b32 s67, s82, 15
  s_add_u32 s67, s67, s78
  buffer_load_dwordx4 v250, s[44:47], s67 offen lds
  s_add_u32 m0, s93, 83968
  s_mul_i32 s67, s82, 114688
  s_add_u32 s67, s67, s79
  buffer_load_dwordx4 v251, s[40:43], s67 offen lds
  s_add_u32 m0, m0, 1024
  s_nop 0
  buffer_load_dwordx4 v252, s[40:43], s67 offen lds
  s_add_u32 m0, m0, 1024
  s_nop 0
  buffer_load_dwordx4 v253, s[40:43], s67 offen lds
  s_add_u32 m0, m0, 1024
  s_nop 0
  buffer_load_dwordx4 v254, s[40:43], s67 offen lds
  s_add_u32 s82, s82, 1
  s_and_b32 s82, s82, 15
  s_waitcnt vmcnt(11)
  s_waitcnt lgkmcnt(0)
  s_barrier
  s_lshl_b32 s67, s92, 10
  s_add_u32 m0, s67, 102400
  s_lshl_b32 s67, s82, 15
  s_add_u32 s67, s67, s78
  buffer_load_dwordx4 v250, s[44:47], s67 offen lds
  s_add_u32 m0, s93, 102400
  s_mul_i32 s67, s82, 114688
  s_add_u32 s67, s67, s79
  buffer_load_dwordx4 v251, s[40:43], s67 offen lds
  s_add_u32 m0, m0, 1024
  s_nop 0
  buffer_load_dwordx4 v252, s[40:43], s67 offen lds
  s_add_u32 m0, m0, 1024
  s_nop 0
  buffer_load_dwordx4 v253, s[40:43], s67 offen lds
  s_add_u32 m0, m0, 1024
  s_nop 0
  buffer_load_dwordx4 v254, s[40:43], s67 offen lds
  s_add_u32 s82, s82, 1
  s_and_b32 s82, s82, 15
  s_waitcnt vmcnt(11)
  s_waitcnt lgkmcnt(0)
  s_barrier
  s_lshl_b32 s67, s92, 10
  s_add_u32 m0, s67, 120832
  s_lshl_b32 s67, s82, 15
  s_add_u32 s67, s67, s78
  buffer_load_dwordx4 v250, s[44:47], s67 offen lds
  s_add_u32 m0, s93, 120832
  s_mul_i32 s67, s82, 114688
  s_add_u32 s67, s67, s79
  buffer_load_dwordx4 v251, s[40:43], s67 offen lds
  s_add_u32 m0, m0, 1024
  s_nop 0
  buffer_load_dwordx4 v252, s[40:43], s67 offen lds
  s_add_u32 m0, m0, 1024
  s_nop 0
  buffer_load_dwordx4 v253, s[40:43], s67 offen lds
  s_add_u32 m0, m0, 1024
  s_nop 0
  buffer_load_dwordx4 v254, s[40:43], s67 offen lds
  s_add_u32 s82, s82, 1
  s_and_b32 s82, s82, 15
  s_mov_b32 s16, s66
  s_mov_b32 s17, s64
  s_mov_b32 s18, s65
  s_lshl_b32 s32, s16, 10
  s_lshr_b32 s22, s16, 2
  s_and_b32 s28, s16, 3
  s_and_b32 s30, s16, 1
  s_bfe_u32 s29, s16, 0x10001
  s_lshr_b32 s35, s16, 1
  s_lshl_b32 s23, s18, 2
  s_add_u32 s23, s23, s28
  s_lshl_b32 s33, s17, 1
  s_add_u32 s33, s33, s22
  s_lshl_b32 s33, s33, 5
  s_add_u32 s33, s33, s23
  s_lshl_b32 s33, s33, 10
  s_add_u32 s37, s33, 13631488
  s_mul_i32 s19, s16, 14
  s_lshl_b32 s20, s18, 1
  s_add_u32 s20, s20, s29
  s_mul_i32 s24, s20, 112
  s_xor_b32 s20, s20, 1
  s_mul_i32 s25, s20, 112
  s_lshl_b32 s20, s17, 1
  s_add_u32 s20, s20, s30
  s_mul_i32 s26, s20, 112
  s_xor_b32 s20, s20, 1
  s_mul_i32 s27, s20, 112
  s_add_u32 s24, s24, s19
  s_lshl_b32 s24, s24, 10
  s_add_u32 s24, s24, 10485760
  s_add_u32 s25, s25, s19
  s_lshl_b32 s25, s25, 10
  s_add_u32 s25, s25, 10485760
  s_add_u32 s26, s26, s19
  s_lshl_b32 s26, s26, 10
  s_add_u32 s26, s26, 3145728
  s_add_u32 s27, s27, s19
  s_lshl_b32 s27, s27, 10
  s_add_u32 s27, s27, 3145728
  s_lshl_b32 s19, s17, 8
  s_add_u32 s19, s19, 2240512
  s_lshl_b32 s20, s18, 5
  s_add_u32 s50, s19, s20
  s_lshl_b32 s20, s16, 2
  s_add_u32 s50, s50, s20
  s_lshl_b32 s20, s16, 5
  s_add_u32 s51, s19, s20
  v_and_b32 v249, 7, v1
  v_lshlrev_b32 v249, 2, v249
  v_and_b32 v8, 31, v1
  v_lshrrev_b32 v9, 5, v1
  v_and_b32 v10, 11, v1
  v_cmp_eq_u32 vcc, 0, v10
  v_mov_b32 v10, 0x3c003c00
  s_nop 0
  v_cndmask_b32 v132, 0, v10, vcc
  v_mov_b32 v133, v132
  v_mov_b32 v134, v132
  v_mov_b32 v135, v132
  s_lshl_b32 s19, s16, 10
  s_add_u32 s19, s19, 155648
  v_add_u32 v10, s19, v5
  ds_write_b128 v10, v[132:135]
  s_nop 1
  v_lshlrev_b32 v10, 8, v9
  v_lshl_add_u32 v10, v8, 4, v10
  v_add_u32 v10, 65536, v10
  v_subrev_u32 v11, 20, v8
  v_cmp_gt_u32 vcc, 8, v11
  v_mov_b32 v11, 155648
  v_mov_b32 v12, 155712
  v_cndmask_b32 v11, v11, v12, vcc
  v_and_b32 v12, 11, v8
  v_cmp_ne_u32 vcc, 0, v12
  v_add_u32 v12, 16, v11
  s_nop 0
  v_cndmask_b32 v11, v11, v12, vcc
  v_cmp_gt_u32 vcc, 16, v8
  s_nop 1
  v_cndmask_b32 v3, v11, v10, vcc
  v_mov_b32 v11, 8192
  v_cndmask_b32 v4, 0, v11, vcc
  v_lshlrev_b32 v6, 2, v8
  v_mov_b32 v136, 0
  v_mov_b32 v137, 0
  v_mov_b32 v138, 0
  v_mov_b32 v139, 0
  v_mov_b32 v140, 0
  v_mov_b32 v141, 0
  v_mov_b32 v142, 0
  v_mov_b32 v143, 0
  v_mov_b32 v144, 0
  v_mov_b32 v145, 0
  v_mov_b32 v146, 0
  v_mov_b32 v147, 0
  v_mov_b32 v148, 0
  v_mov_b32 v149, 0
  v_mov_b32 v150, 0
  v_mov_b32 v151, 0
  v_mov_b32 v152, 0
  v_mov_b32 v153, 0
  v_mov_b32 v154, 0
  v_mov_b32 v155, 0
  v_mov_b32 v156, 0
  v_mov_b32 v157, 0
  v_mov_b32 v158, 0
  v_mov_b32 v159, 0
  v_mov_b32 v160, 0
  v_mov_b32 v161, 0
  v_mov_b32 v162, 0
  v_mov_b32 v163, 0
  v_mov_b32 v164, 0
  v_mov_b32 v165, 0
  v_mov_b32 v166, 0
  v_mov_b32 v167, 0
  v_mov_b32 v168, 0
  v_mov_b32 v169, 0
  v_mov_b32 v170, 0
  v_mov_b32 v171, 0
  v_mov_b32 v172, 0
  v_mov_b32 v173, 0
  v_mov_b32 v174, 0
  v_mov_b32 v175, 0
  v_mov_b32 v176, 0
  v_mov_b32 v177, 0
  v_mov_b32 v178, 0
  v_mov_b32 v179, 0
  v_mov_b32 v180, 0
  v_mov_b32 v181, 0
  v_mov_b32 v182, 0
  v_mov_b32 v183, 0
  v_mov_b32 v184, 0
  v_mov_b32 v185, 0
  v_mov_b32 v186, 0
  v_mov_b32 v187, 0
  v_mov_b32 v188, 0
  v_mov_b32 v189, 0
  v_mov_b32 v190, 0
  v_mov_b32 v191, 0
  v_mov_b32 v192, 0
  v_mov_b32 v193, 0
  v_mov_b32 v194, 0
  v_mov_b32 v195, 0
  v_mov_b32 v132, 0
  v_mov_b32 v133, 0
  v_mov_b32 v134, 0
  v_mov_b32 v135, 0
  s_lshl_b32 s19, s16, 13
  s_add_u32 s19, s19, 32768
  s_cmp_ge_u32 s16, 3
  s_cselect_b32 s20, 40960, 0
  s_add_u32 s19, s19, s20
  s_cmp_ge_u32 s16, 6
  s_cselect_b32 s20, 16384, 0
  s_add_u32 s19, s19, s20
  v_add_u32 v2, s19, v5
  s_xor_b32 s3, s16, 1
  s_lshl_b32 s19, s3, 13
  s_add_u32 s19, s19, 32768
  s_cmp_ge_u32 s3, 3
  s_cselect_b32 s20, 40960, 0
  s_add_u32 s19, s19, s20
  s_cmp_ge_u32 s3, 6
  s_cselect_b32 s20, 16384, 0
  s_add_u32 s19, s19, s20
  v_add_u32 v21, s19, v5
  s_lshl_b32 s20, s17, 1
  s_add_u32 s20, s20, s30
  s_lshl_b32 s20, s20, 5
  s_lshl_b32 s19, s35, 3
  s_add_u32 s20, s20, s19
  s_lshl_b32 s20, s20, 10
  s_add_u32 s36, s20, 13631488
  s_lshl_b32 s19, s16, 16
  s_lshl_b32 s20, s18, 7
  s_add_u32 s38, s19, s20
  v_lshrrev_b32 v14, 3, v1
  v_and_b32 v20, 7, v1
  v_bfe_u32 v13, v14, 1, 1
  v_lshlrev_b32 v13, 2, v13
  v_xor_b32 v20, v20, v13
  v_lshlrev_b32 v20, 4, v20
  v_lshl_add_u32 v20, v14, 10, v20
  s_waitcnt vmcnt(10)
  s_waitcnt lgkmcnt(0)
  s_barrier
  s_lshl_b32 s67, s92, 10
  s_add_u32 m0, s67, 65536
  s_lshl_b32 s67, s82, 15
  s_add_u32 s67, s67, s78
  buffer_load_dwordx4 v250, s[44:47], s67 offen lds
  s_add_u32 m0, s93, 65536
  s_mul_i32 s67, s82, 114688
  s_add_u32 s67, s67, s79
  buffer_load_dwordx4 v251, s[40:43], s67 offen lds
  s_add_u32 m0, m0, 1024
  s_nop 0
  buffer_load_dwordx4 v252, s[40:43], s67 offen lds
  s_add_u32 m0, m0, 1024
  s_nop 0
  buffer_load_dwordx4 v253, s[40:43], s67 offen lds
  s_add_u32 m0, m0, 1024
  s_nop 0
  buffer_load_dwordx4 v254, s[40:43], s67 offen lds
  s_add_u32 s82, s82, 1
  s_and_b32 s82, s82, 15
  s_waitcnt vmcnt(10)
  s_waitcnt lgkmcnt(0)
  s_barrier
  s_lshl_b32 s67, s92, 10
  s_add_u32 m0, s67, 83968
  s_lshl_b32 s67, s82, 15
  s_add_u32 s67, s67, s78
  buffer_load_dwordx4 v250, s[44:47], s67 offen lds
  s_add_u32 m0, s93, 83968
  s_mul_i32 s67, s82, 114688
  s_add_u32 s67, s67, s79
  buffer_load_dwordx4 v251, s[40:43], s67 offen lds
  s_add_u32 m0, m0, 1024
  s_nop 0
  buffer_load_dwordx4 v252, s[40:43], s67 offen lds
  s_add_u32 m0, m0, 1024
  s_nop 0
  buffer_load_dwordx4 v253, s[40:43], s67 offen lds
  s_add_u32 m0, m0, 1024
  s_nop 0
  buffer_load_dwordx4 v254, s[40:43], s67 offen lds
  s_add_u32 s82, s82, 1
  s_and_b32 s82, s82, 15
  s_waitcnt vmcnt(10)
  s_waitcnt lgkmcnt(0)
  s_barrier
  s_mov_b32 s77, 2260992
  buffer_load_dword v32, v5, s[8:11], s77 offen offset:0 sc1
  buffer_load_dword v33, v5, s[8:11], s77 offen offset:1024 sc1
  buffer_load_dword v34, v5, s[8:11], s77 offen offset:2048 sc1
  buffer_load_dword v35, v5, s[8:11], s77 offen offset:3072 sc1
  s_lshl_b32 s67, s92, 10
  s_add_u32 m0, s67, 102400
  s_lshl_b32 s67, s82, 15
  s_add_u32 s67, s67, s78
  buffer_load_dwordx4 v250, s[44:47], s67 offen lds
  s_add_u32 m0, s93, 102400
  s_mul_i32 s67, s82, 114688
  s_add_u32 s67, s67, s79
  buffer_load_dwordx4 v251, s[40:43], s67 offen lds
  s_add_u32 m0, m0, 1024
  s_nop 0
  buffer_load_dwordx4 v252, s[40:43], s67 offen lds
  s_add_u32 m0, m0, 1024
  s_nop 0
  buffer_load_dwordx4 v253, s[40:43], s67 offen lds
  s_add_u32 m0, m0, 1024
  s_nop 0
  buffer_load_dwordx4 v254, s[40:43], s67 offen lds
  s_add_u32 s82, s82, 1
  s_and_b32 s82, s82, 15
  s_waitcnt vmcnt(14)
  s_waitcnt lgkmcnt(0)
  s_barrier
  s_lshl_b32 s67, s92, 10
  s_add_u32 m0, s67, 120832
  s_lshl_b32 s67, s82, 15
  s_add_u32 s67, s67, s78
  buffer_load_dwordx4 v250, s[44:47], s67 offen lds
  s_add_u32 m0, s93, 120832
  s_mul_i32 s67, s82, 114688
  s_add_u32 s67, s67, s79
  buffer_load_dwordx4 v251, s[40:43], s67 offen lds
  s_add_u32 m0, m0, 1024
  s_nop 0
  buffer_load_dwordx4 v252, s[40:43], s67 offen lds
  s_add_u32 m0, m0, 1024
  s_nop 0
  buffer_load_dwordx4 v253, s[40:43], s67 offen lds
  s_add_u32 m0, m0, 1024
  s_nop 0
  buffer_load_dwordx4 v254, s[40:43], s67 offen lds
  s_add_u32 s82, s82, 1
  s_and_b32 s82, s82, 15
  s_waitcnt vmcnt(14)
  s_waitcnt lgkmcnt(0)
  s_barrier
  s_waitcnt vmcnt(5)
  s_mov_b32 s67, 8192
A_POLL:
  v_and_b32 v32, v32, v33
  v_and_b32 v34, v34, v35
  v_and_b32 v32, v32, v34
  v_cmp_ne_u32 vcc, 1, v32
  s_cbranch_vccz A_POLLOK
  s_sub_u32 s67, s67, 1
  s_cmp_eq_u32 s67, 0
  s_cbranch_scc1 A_POLLOK
  buffer_load_dword v32, v5, s[8:11], s77 offen offset:0 sc1
  buffer_load_dword v33, v5, s[8:11], s77 offen offset:1024 sc1
  buffer_load_dword v34, v5, s[8:11], s77 offen offset:2048 sc1
  buffer_load_dword v35, v5, s[8:11], s77 offen offset:3072 sc1
  s_waitcnt vmcnt(0)
  s_branch A_POLL
A_POLLOK:
  s_waitcnt lgkmcnt(0)
  s_barrier
  s_mov_b32 m0, s32
  s_add_u32 s32, s32, 2097152
  buffer_load_dwordx4 v5, s[8:11], s32 offen sc1 lds
  s_add_u32 m0, m0, 65536
  s_add_u32 s32, s32, 65536
  buffer_load_dwordx4 v5, s[8:11], s32 offen sc1 lds
  s_sub_u32 m0, m0, 57344
  s_sub_u32 s32, s32, 57344
  buffer_load_dwordx4 v5, s[8:11], s32 offen sc1 lds
  s_add_u32 m0, m0, 65536
  s_add_u32 s32, s32, 65536
  buffer_load_dwordx4 v5, s[8:11], s32 offen sc1 lds
  s_sub_u32 m0, m0, 57344
  s_sub_u32 s32, s32, 57344
  s_mov_b32 s31, 2236416
  buffer_load_dwordx4 v[244:247], v5, s[8:11], s31 offen sc1
  buffer_load_dwordx4 v[196:199], v5, s[8:11], s24 offen offset:0 sc1
  buffer_load_dwordx4 v[200:203], v5, s[8:11], s25 offen offset:0 sc1
  buffer_load_dwordx4 v[212:215], v5, s[8:11], s24 offen offset:1024 sc1
  buffer_load_dwordx4 v[216:219], v5, s[8:11], s25 offen offset:1024 sc1
  s_waitcnt vmcnt(9)
  s_waitcnt lgkmcnt(0)
  s_barrier
  v_mov_b32 v100, 0
  v_mov_b32 v101, 0
  v_mov_b32 v102, 0
  v_mov_b32 v103, 0
  v_mov_b32 v104, 0
  v_mov_b32 v105, 0
  v_mov_b32 v106, 0
  v_mov_b32 v107, 0
  v_mov_b32 v108, 0
  v_mov_b32 v109, 0
  v_mov_b32 v110, 0
  v_mov_b32 v111, 0
  v_mov_b32 v112, 0
  v_mov_b32 v113, 0
  v_mov_b32 v114, 0
  v_mov_b32 v115, 0
  s_waitcnt vmcnt(4)
  v_mov_b32 v48, 0x02000200
  v_mov_b32 v49, 0x39a839a8
  s_branch B_ENTRY
B_ENTRY:
  s_mov_b32 s12, s6
  s_mov_b32 s13, s7
  s_mov_b32 s14, 2097152
  s_mov_b32 s15, 0x00020000
  s_mov_b32 s60, s4
  s_mov_b32 s61, s5
  s_mov_b32 s62, 524288
  s_mov_b32 s63, 0x00020000
  v_max_u32 v244, v244, v245
  v_max3_u32 v244, v244, v246, v247
  s_nop 1
  v_max_u32_dpp v244, v244, v244 row_shr:1 row_mask:0xf bank_mask:0xf
  s_nop 1
  v_max_u32_dpp v244, v244, v244 row_shr:2 row_mask:0xf bank_mask:0xf
  s_nop 1
  v_max_u32_dpp v244, v244, v244 row_shr:4 row_mask:0xf bank_mask:0xf
  s_nop 1
  v_max_u32_dpp v244, v244, v244 row_shr:8 row_mask:0xf bank_mask:0xf
  s_nop 1
  v_max_u32_dpp v244, v244, v244 row_bcast:15 row_mask:0xa bank_mask:0xf
  s_nop 0
  v_readlane_b32 s31, v244, 31
  v_readlane_b32 s39, v244, 63
  s_lshl_b32 s19, s16, 10
  s_add_u32 s19, s19, 139264
  v_add_u32 v8, s19, v5
  s_sub_u32 s19, s39, 0x3c800000
  s_cmp_le_u32 s19, 176160768
  s_cselect_b32 s19, 0, 0x7f800000
  s_waitcnt lgkmcnt(0)
  s_barrier
  ds_read_b128 v[16:19], v8
  ds_read_b128 v[24:27], v5
  ds_read_b128 v[32:35], v5 offset:1024
  ds_read_b128 v[28:31], v3
  s_waitcnt lgkmcnt(3)
  v_mov_b32 v10, 0
  v_dot2_f32_bf16 v10, v16, v16, v10
  v_dot2_f32_bf16 v10, v17, v17, v10
  v_dot2_f32_bf16 v10, v18, v18, v10
  v_dot2_f32_bf16 v10, v19, v19, v10
  s_nop 2
  v_mov_b32 v13, v10
  s_nop 1
  v_permlane32_swap_b32 v10, v13
  v_add_f32 v10, v10, v13
  v_mul_f32 v10, s31, v10
  v_sqrt_f32 v10, v10
  s_nop 0
  v_add_f32 v10, s19, v10
  v_sub_f32 v52, 0x3eee00ee, v10
  v_mov_b32 v53, v52
  v_mov_b32 v54, v52
  v_mov_b32 v55, v52
  v_mov_b32 v56, v52
  v_mov_b32 v57, v52
  v_mov_b32 v58, v52
  v_mov_b32 v59, v52
  v_mov_b32 v60, v52
  v_mov_b32 v61, v52
  v_mov_b32 v62, v52
  v_mov_b32 v63, v52
  v_mov_b32 v64, v52
  v_mov_b32 v65, v52
  v_mov_b32 v66, v52
  v_mov_b32 v67, v52
  s_waitcnt lgkmcnt(2)
  s_nop 0
  v_mfma_f32_32x32x16_bf16 v[68:83], v[24:27], v[16:19], v[52:67]
  s_nop 11
  v_cvt_pknorm_u16_f32 v36, v68, v69
  v_cvt_pknorm_u16_f32 v37, v70, v71
  v_add_u32 v44, v48, v36
  v_cvt_pknorm_u16_f32 v38, v72, v73
  v_add_u32 v45, v48, v37
  buffer_load_dwordx4 v5, s[8:11], s32 offen sc1 lds
  s_add_u32 m0, m0, 65536
  s_add_u32 s32, s32, 65536
  v_pk_fma_f16 v36, v44, v49, v36
  v_cvt_pknorm_u16_f32 v39, v74, v75
  v_add_u32 v46, v48, v38
  s_waitcnt lgkmcnt(1)
  v_mfma_f32_32x32x16_bf16 v[84:99], v[32:35], v[16:19], v[52:67]
  ds_read_b128 v[32:35], v3 offset:512
  ds_read_b128 v[24:27], v5 offset:2048
  v_pk_fma_f16 v37, v45, v49, v37
  v_cvt_pknorm_u16_f32 v40, v76, v77
  v_add_u32 v47, v48, v39
  v_pk_fma_f16 v38, v46, v49, v38
  v_cvt_pknorm_u16_f32 v41, v78, v79
  v_add_u32 v44, v48, v40
  v_pk_fma_f16 v39, v47, v49, v39
  v_cvt_pknorm_u16_f32 v42, v80, v81
  v_add_u32 v45, v48, v41
  v_pk_fma_f16 v40, v44, v49, v40
  v_cvt_pknorm_u16_f32 v43, v82, v83
  v_add_u32 v46, v48, v42
  s_waitcnt lgkmcnt(2)
  v_mfma_f32_32x32x16_f16 v[100:115], v[28:31], v[36:39], v[100:115]
  ds_read_b128 v[28:31], v3 offset:1024
  v_pk_fma_f16 v41, v45, v49, v41
  v_add_u32 v47, v48, v43
  v_pk_fma_f16 v42, v46, v49, v42
  v_pk_fma_f16 v43, v47, v49, v43
  v_cvt_pknorm_u16_f32 v36, v84, v85
  v_cvt_pknorm_u16_f32 v37, v86, v87
  s_waitcnt lgkmcnt(2)
  v_mfma_f32_32x32x16_f16 v[100:115], v[32:35], v[40:43], v[100:115]
  ds_read_b128 v[32:35], v3 offset:1536
  v_add_u32 v44, v48, v36
  v_cvt_pknorm_u16_f32 v38, v88, v89
  v_add_u32 v45, v48, v37
  buffer_load_dwordx4 v5, s[8:11], s32 offen sc1 lds
  s_sub_u32 m0, m0, 57344
  s_sub_u32 s32, s32, 57344
  v_pk_fma_f16 v36, v44, v49, v36
  v_cvt_pknorm_u16_f32 v39, v90, v91
  v_add_u32 v46, v48, v38
  s_waitcnt lgkmcnt(2)
  v_mfma_f32_32x32x16_bf16 v[68:83], v[24:27], v[16:19], v[52:67]
  ds_read_b128 v[24:27], v5 offset:3072
  v_pk_fma_f16 v37, v45, v49, v37
  v_cvt_pknorm_u16_f32 v40, v92, v93
  v_add_u32 v47, v48, v39
  v_pk_fma_f16 v38, v46, v49, v38
  v_cvt_pknorm_u16_f32 v41, v94, v95
  v_add_u32 v44, v48, v40
  v_pk_fma_f16 v39, v47, v49, v39
  v_cvt_pknorm_u16_f32 v42, v96, v97
  v_add_u32 v45, v48, v41
  v_pk_fma_f16 v40, v44, v49, v40
  v_cvt_pknorm_u16_f32 v43, v98, v99
  v_add_u32 v46, v48, v42
  s_waitcnt lgkmcnt(2)
  v_mfma_f32_32x32x16_f16 v[100:115], v[28:31], v[36:39], v[100:115]
  ds_read_b128 v[28:31], v3 offset:2048
  v_pk_fma_f16 v41, v45, v49, v41
  v_add_u32 v47, v48, v43
  v_pk_fma_f16 v42, v46, v49, v42
  v_pk_fma_f16 v43, v47, v49, v43
  v_cvt_pknorm_u16_f32 v36, v68, v69
  v_cvt_pknorm_u16_f32 v37, v70, v71
  s_waitcnt lgkmcnt(2)
  v_mfma_f32_32x32x16_f16 v[100:115], v[32:35], v[40:43], v[100:115]
  ds_read_b128 v[32:35], v3 offset:2560
  v_add_u32 v44, v48, v36
  v_cvt_pknorm_u16_f32 v38, v72, v73
  v_add_u32 v45, v48, v37
  buffer_load_dwordx4 v5, s[8:11], s32 offen sc1 lds
  s_add_u32 m0, m0, 65536
  s_add_u32 s32, s32, 65536
  v_pk_fma_f16 v36, v44, v49, v36
  v_cvt_pknorm_u16_f32 v39, v74, v75
  v_add_u32 v46, v48, v38
  s_waitcnt lgkmcnt(2)
  v_mfma_f32_32x32x16_bf16 v[84:99], v[24:27], v[16:19], v[52:67]
  ds_read_b128 v[24:27], v5 offset:4096
  v_pk_fma_f16 v37, v45, v49, v37
  v_cvt_pknorm_u16_f32 v40, v76, v77
  v_add_u32 v47, v48, v39
  v_pk_fma_f16 v38, v46, v49, v38
  v_cvt_pknorm_u16_f32 v41, v78, v79
  v_add_u32 v44, v48, v40
  v_pk_fma_f16 v39, v47, v49, v39
  v_cvt_pknorm_u16_f32 v42, v80, v81
  v_add_u32 v45, v48, v41
  v_pk_fma_f16 v40, v44, v49, v40
  v_cvt_pknorm_u16_f32 v43, v82, v83
  v_add_u32 v46, v48, v42
  s_waitcnt lgkmcnt(2)
  v_mfma_f32_32x32x16_f16 v[100:115], v[28:31], v[36:39], v[100:115]
  ds_read_b128 v[28:31], v3 offset:3072
  v_pk_fma_f16 v41, v45, v49, v41
  v_add_u32 v47, v48, v43
  v_pk_fma_f16 v42, v46, v49, v42
  v_pk_fma_f16 v43, v47, v49, v43
  v_cvt_pknorm_u16_f32 v36, v84, v85
  v_cvt_pknorm_u16_f32 v37, v86, v87
  s_waitcnt lgkmcnt(2)
  v_mfma_f32_32x32x16_f16 v[100:115], v[32:35], v[40:43], v[100:115]
  ds_read_b128 v[32:35], v3 offset:3584
  v_add_u32 v44, v48, v36
  v_cvt_pknorm_u16_f32 v38, v88, v89
  v_add_u32 v45, v48, v37
  buffer_load_dwordx4 v5, s[8:11], s32 offen sc1 lds
  s_sub_u32 m0, m0, 57344
  s_sub_u32 s32, s32, 57344
  v_pk_fma_f16 v36, v44, v49, v36
  v_cvt_pknorm_u16_f32 v39, v90, v91
  v_add_u32 v46, v48, v38
  s_waitcnt lgkmcnt(2)
  v_mfma_f32_32x32x16_bf16 v[68:83], v[24:27], v[16:19], v[52:67]
  ds_read_b128 v[24:27], v5 offset:5120
  v_pk_fma_f16 v37, v45, v49, v37
  v_cvt_pknorm_u16_f32 v40, v92, v93
  v_add_u32 v47, v48, v39
  v_pk_fma_f16 v38, v46, v49, v38
  v_cvt_pknorm_u16_f32 v41, v94, v95
  v_add_u32 v44, v48, v40
  v_pk_fma_f16 v39, v47, v49, v39
  v_cvt_pknorm_u16_f32 v42, v96, v97
  v_add_u32 v45, v48, v41
  v_pk_fma_f16 v40, v44, v49, v40
  v_cvt_pknorm_u16_f32 v43, v98, v99
  v_add_u32 v46, v48, v42
  s_waitcnt lgkmcnt(2)
  v_mfma_f32_32x32x16_f16 v[100:115], v[28:31], v[36:39], v[100:115]
  ds_read_b128 v[28:31], v3 offset:4096
  v_pk_fma_f16 v41, v45, v49, v41
  v_add_u32 v47, v48, v43
  v_pk_fma_f16 v42, v46, v49, v42
  v_pk_fma_f16 v43, v47, v49, v43
  v_cvt_pknorm_u16_f32 v36, v68, v69
  v_cvt_pknorm_u16_f32 v37, v70, v71
  s_waitcnt lgkmcnt(2)
  v_mfma_f32_32x32x16_f16 v[100:115], v[32:35], v[40:43], v[100:115]
  ds_read_b128 v[32:35], v3 offset:4608
  v_add_u32 v44, v48, v36
  v_cvt_pknorm_u16_f32 v38, v72, v73
  v_add_u32 v45, v48, v37
  v_pk_fma_f16 v36, v44, v49, v36
  v_cvt_pknorm_u16_f32 v39, v74, v75
  v_add_u32 v46, v48, v38
  s_waitcnt lgkmcnt(2)
  v_mfma_f32_32x32x16_bf16 v[84:99], v[24:27], v[16:19], v[52:67]
  ds_read_b128 v[24:27], v5 offset:6144
  v_pk_fma_f16 v37, v45, v49, v37
  v_cvt_pknorm_u16_f32 v40, v76, v77
  v_add_u32 v47, v48, v39
  v_pk_fma_f16 v38, v46, v49, v38
  v_cvt_pknorm_u16_f32 v41, v78, v79
  v_add_u32 v44, v48, v40
  v_pk_fma_f16 v39, v47, v49, v39
  v_cvt_pknorm_u16_f32 v42, v80, v81
  v_add_u32 v45, v48, v41
  v_pk_fma_f16 v40, v44, v49, v40
  v_cvt_pknorm_u16_f32 v43, v82, v83
  v_add_u32 v46, v48, v42
  s_waitcnt lgkmcnt(2)
  v_mfma_f32_32x32x16_f16 v[100:115], v[28:31], v[36:39], v[100:115]
  ds_read_b128 v[28:31], v3 offset:5120
  v_pk_fma_f16 v41, v45, v49, v41
  v_add_u32 v47, v48, v43
  v_pk_fma_f16 v42, v46, v49, v42
  v_pk_fma_f16 v43, v47, v49, v43
  v_cvt_pknorm_u16_f32 v36, v84, v85
  s_waitcnt vmcnt(4)
  v_mov_b32 v248, 1
  buffer_store_dword v248, off, s[8:11], s50 sc1
  v_cvt_pknorm_u16_f32 v37, v86, v87
  s_waitcnt lgkmcnt(2)
  v_mfma_f32_32x32x16_f16 v[100:115], v[32:35], v[40:43], v[100:115]
  ds_read_b128 v[32:35], v3 offset:5632
  v_add_u32 v44, v48, v36
  v_cvt_pknorm_u16_f32 v38, v88, v89
  v_add_u32 v45, v48, v37
  v_pk_fma_f16 v36, v44, v49, v36
  v_cvt_pknorm_u16_f32 v39, v90, v91
  v_add_u32 v46, v48, v38
  s_waitcnt lgkmcnt(2)
  v_mfma_f32_32x32x16_bf16 v[68:83], v[24:27], v[16:19], v[52:67]
  ds_read_b128 v[24:27], v5 offset:7168
  v_pk_fma_f16 v37, v45, v49, v37
  v_cvt_pknorm_u16_f32 v40, v92, v93
  v_add_u32 v47, v48, v39
  v_pk_fma_f16 v38, v46, v49, v38
  v_cvt_pknorm_u16_f32 v41, v94, v95
  v_add_u32 v44, v48, v40
  v_pk_fma_f16 v39, v47, v49, v39
  v_cvt_pknorm_u16_f32 v42, v96, v97
  v_add_u32 v45, v48, v41
  v_pk_fma_f16 v40, v44, v49, v40
  v_cvt_pknorm_u16_f32 v43, v98, v99
  v_add_u32 v46, v48, v42
  s_waitcnt lgkmcnt(2)
  v_mfma_f32_32x32x16_f16 v[100:115], v[28:31], v[36:39], v[100:115]
  ds_read_b128 v[28:31], v3 offset:6144
  v_pk_fma_f16 v41, v45, v49, v41
  v_add_u32 v47, v48, v43
  v_pk_fma_f16 v42, v46, v49, v42
  v_pk_fma_f16 v43, v47, v49, v43
  v_cvt_pknorm_u16_f32 v36, v68, v69
  v_cvt_pknorm_u16_f32 v37, v70, v71
  s_waitcnt lgkmcnt(2)
  v_mfma_f32_32x32x16_f16 v[100:115], v[32:35], v[40:43], v[100:115]
  ds_read_b128 v[32:35], v3 offset:6656
  v_add_u32 v44, v48, v36
  v_cvt_pknorm_u16_f32 v38, v72, v73
  v_add_u32 v45, v48, v37
  v_pk_fma_f16 v36, v44, v49, v36
  v_cvt_pknorm_u16_f32 v39, v74, v75
  v_add_u32 v46, v48, v38
  s_waitcnt lgkmcnt(2)
  v_mfma_f32_32x32x16_bf16 v[84:99], v[24:27], v[16:19], v[52:67]
  ds_read_b128 v[24:27], v5 offset:8192
  v_pk_fma_f16 v37, v45, v49, v37
  v_cvt_pknorm_u16_f32 v40, v76, v77
  v_add_u32 v47, v48, v39
  v_pk_fma_f16 v38, v46, v49, v38
  v_cvt_pknorm_u16_f32 v41, v78, v79
  v_add_u32 v44, v48, v40
  v_pk_fma_f16 v39, v47, v49, v39
  v_cvt_pknorm_u16_f32 v42, v80, v81
  v_add_u32 v45, v48, v41
  v_pk_fma_f16 v40, v44, v49, v40
  v_cvt_pknorm_u16_f32 v43, v82, v83
  v_add_u32 v46, v48, v42
  s_waitcnt lgkmcnt(2)
  v_mfma_f32_32x32x16_f16 v[100:115], v[28:31], v[36:39], v[100:115]
  ds_read_b128 v[28:31], v3 offset:7168
  v_pk_fma_f16 v41, v45, v49, v41
  v_add_u32 v47, v48, v43
  v_pk_fma_f16 v42, v46, v49, v42
  v_pk_fma_f16 v43, v47, v49, v43
  v_cvt_pknorm_u16_f32 v36, v84, v85
  v_cvt_pknorm_u16_f32 v37, v86, v87
  s_waitcnt lgkmcnt(2)
  v_mfma_f32_32x32x16_f16 v[100:115], v[32:35], v[40:43], v[100:115]
  ds_read_b128 v[32:35], v3 offset:7680
  v_add_u32 v44, v48, v36
  v_cvt_pknorm_u16_f32 v38, v88, v89
  v_add_u32 v45, v48, v37
  v_pk_fma_f16 v36, v44, v49, v36
  v_cvt_pknorm_u16_f32 v39, v90, v91
  v_add_u32 v46, v48, v38
  s_waitcnt lgkmcnt(2)
  v_mfma_f32_32x32x16_bf16 v[68:83], v[24:27], v[16:19], v[52:67]
  ds_read_b128 v[24:27], v5 offset:9216
  v_pk_fma_f16 v37, v45, v49, v37
  v_cvt_pknorm_u16_f32 v40, v92, v93
  v_add_u32 v47, v48, v39
  v_pk_fma_f16 v38, v46, v49, v38
  v_cvt_pknorm_u16_f32 v41, v94, v95
  v_add_u32 v44, v48, v40
  v_pk_fma_f16 v39, v47, v49, v39
  v_cvt_pknorm_u16_f32 v42, v96, v97
  v_add_u32 v45, v48, v41
  v_pk_fma_f16 v40, v44, v49, v40
  v_cvt_pknorm_u16_f32 v43, v98, v99
  v_add_u32 v46, v48, v42
  s_waitcnt lgkmcnt(2)
  v_mfma_f32_32x32x16_f16 v[100:115], v[28:31], v[36:39], v[100:115]
  v_add_u32 v3, v4, v3
  ds_read_b128 v[28:31], v3 offset:0
  v_pk_fma_f16 v41, v45, v49, v41
  v_add_u32 v47, v48, v43
  v_pk_fma_f16 v42, v46, v49, v42
  v_pk_fma_f16 v43, v47, v49, v43
  v_cvt_pknorm_u16_f32 v36, v68, v69
  buffer_load_dword v248, v249, s[8:11], s51 offen sc1
  v_cvt_pknorm_u16_f32 v37, v70, v71
  s_waitcnt lgkmcnt(2)
  v_mfma_f32_32x32x16_f16 v[100:115], v[32:35], v[40:43], v[100:115]
  ds_read_b128 v[32:35], v3 offset:512
  v_add_u32 v44, v48, v36
  v_cvt_pknorm_u16_f32 v38, v72, v73
  v_add_u32 v45, v48, v37
  buffer_load_dwordx4 v5, s[8:11], s32 offen sc1 lds
  s_add_u32 m0, m0, 65536
  s_add_u32 s32, s32, 65536
  v_pk_fma_f16 v36, v44, v49, v36
  v_cvt_pknorm_u16_f32 v39, v74, v75
  v_add_u32 v46, v48, v38
  s_waitcnt lgkmcnt(2)
  v_mfma_f32_32x32x16_bf16 v[84:99], v[24:27], v[16:19], v[52:67]
  ds_read_b128 v[24:27], v5 offset:10240
  v_pk_fma_f16 v37, v45, v49, v37
  v_cvt_pknorm_u16_f32 v40, v76, v77
  v_add_u32 v47, v48, v39
  v_pk_fma_f16 v38, v46, v49, v38
  v_cvt_pknorm_u16_f32 v41, v78, v79
  v_add_u32 v44, v48, v40
  v_pk_fma_f16 v39, v47, v49, v39
  v_cvt_pknorm_u16_f32 v42, v80, v81
  v_add_u32 v45, v48, v41
  v_pk_fma_f16 v40, v44, v49, v40
  v_cvt_pknorm_u16_f32 v43, v82, v83
  v_add_u32 v46, v48, v42
  s_waitcnt lgkmcnt(2)
  v_mfma_f32_32x32x16_f16 v[100:115], v[28:31], v[36:39], v[100:115]
  ds_read_b128 v[28:31], v3 offset:1024
  v_pk_fma_f16 v41, v45, v49, v41
  v_add_u32 v47, v48, v43
  v_pk_fma_f16 v42, v46, v49, v42
  v_pk_fma_f16 v43, v47, v49, v43
  v_cvt_pknorm_u16_f32 v36, v84, v85
  v_cvt_pknorm_u16_f32 v37, v86, v87
  s_waitcnt lgkmcnt(2)
  v_mfma_f32_32x32x16_f16 v[100:115], v[32:35], v[40:43], v[100:115]
  ds_read_b128 v[32:35], v3 offset:1536
  v_add_u32 v44, v48, v36
  v_cvt_pknorm_u16_f32 v38, v88, v89
  v_add_u32 v45, v48, v37
  v_pk_fma_f16 v36, v44, v49, v36
  v_cvt_pknorm_u16_f32 v39, v90, v91
  v_add_u32 v46, v48, v38
  s_waitcnt lgkmcnt(2)
  v_mfma_f32_32x32x16_bf16 v[68:83], v[24:27], v[16:19], v[52:67]
  ds_read_b128 v[24:27], v5 offset:11264
  v_pk_fma_f16 v37, v45, v49, v37
  v_cvt_pknorm_u16_f32 v40, v92, v93
  v_add_u32 v47, v48, v39
  v_pk_fma_f16 v38, v46, v49, v38
  v_cvt_pknorm_u16_f32 v41, v94, v95
  v_add_u32 v44, v48, v40
  v_pk_fma_f16 v39, v47, v49, v39
  v_cvt_pknorm_u16_f32 v42, v96, v97
  v_add_u32 v45, v48, v41
  v_pk_fma_f16 v40, v44, v49, v40
  v_cvt_pknorm_u16_f32 v43, v98, v99
  v_add_u32 v46, v48, v42
  s_waitcnt lgkmcnt(2)
  v_mfma_f32_32x32x16_f16 v[100:115], v[28:31], v[36:39], v[100:115]
  ds_read_b128 v[28:31], v3 offset:2048
  v_pk_fma_f16 v41, v45, v49, v41
  v_add_u32 v47, v48, v43
  v_pk_fma_f16 v42, v46, v49, v42
  v_pk_fma_f16 v43, v47, v49, v43
  v_cvt_pknorm_u16_f32 v36, v68, v69
  v_cvt_pknorm_u16_f32 v37, v70, v71
  s_waitcnt lgkmcnt(2)
  v_mfma_f32_32x32x16_f16 v[100:115], v[32:35], v[40:43], v[100:115]
  ds_read_b128 v[32:35], v3 offset:2560
  v_add_u32 v44, v48, v36
  v_cvt_pknorm_u16_f32 v38, v72, v73
  v_add_u32 v45, v48, v37
  buffer_load_dwordx4 v5, s[8:11], s32 offen sc1 lds
  s_sub_u32 m0, m0, 57344
  s_sub_u32 s32, s32, 57344
  v_pk_fma_f16 v36, v44, v49, v36
  v_cvt_pknorm_u16_f32 v39, v74, v75
  v_add_u32 v46, v48, v38
  s_waitcnt lgkmcnt(2)
  v_mfma_f32_32x32x16_bf16 v[84:99], v[24:27], v[16:19], v[52:67]
  ds_read_b128 v[24:27], v5 offset:12288
  v_pk_fma_f16 v37, v45, v49, v37
  v_cvt_pknorm_u16_f32 v40, v76, v77
  v_add_u32 v47, v48, v39
  v_pk_fma_f16 v38, v46, v49, v38
  v_cvt_pknorm_u16_f32 v41, v78, v79
  v_add_u32 v44, v48, v40
  v_pk_fma_f16 v39, v47, v49, v39
  v_cvt_pknorm_u16_f32 v42, v80, v81
  v_add_u32 v45, v48, v41
  v_pk_fma_f16 v40, v44, v49, v40
  v_cvt_pknorm_u16_f32 v43, v82, v83
  v_add_u32 v46, v48, v42
  s_waitcnt lgkmcnt(2)
  v_mfma_f32_32x32x16_f16 v[100:115], v[28:31], v[36:39], v[100:115]
  ds_read_b128 v[28:31], v3 offset:3072
  v_pk_fma_f16 v41, v45, v49, v41
  v_add_u32 v47, v48, v43
  v_pk_fma_f16 v42, v46, v49, v42
  v_pk_fma_f16 v43, v47, v49, v43
  v_cvt_pknorm_u16_f32 v36, v84, v85
  s_waitcnt vmcnt(2)
  s_mov_b32 s34, 8192
B_HP:
  v_cmp_ne_u32 vcc, 1, v248
  s_cbranch_vccz B_HPOK
  s_sub_u32 s34, s34, 1
  s_cmp_eq_u32 s34, 0
  s_cbranch_scc1 B_HPOK
  buffer_load_dword v248, v249, s[8:11], s51 offen sc1
  s_waitcnt vmcnt(0)
  s_branch B_HP
B_HPOK:
  buffer_load_dwordx4 v[204:207], v5, s[8:11], s26 offen offset:0 sc1
  buffer_load_dwordx4 v[208:211], v5, s[8:11], s27 offen offset:0 sc1
  buffer_load_dwordx4 v[220:223], v5, s[8:11], s26 offen offset:1024 sc1
  buffer_load_dwordx4 v[224:227], v5, s[8:11], s27 offen offset:1024 sc1
  v_cvt_pknorm_u16_f32 v37, v86, v87
  s_waitcnt lgkmcnt(2)
  v_mfma_f32_32x32x16_f16 v[100:115], v[32:35], v[40:43], v[100:115]
  ds_read_b128 v[32:35], v3 offset:3584
  v_add_u32 v44, v48, v36
  v_cvt_pknorm_u16_f32 v38, v88, v89
  v_add_u32 v45, v48, v37
  v_pk_fma_f16 v36, v44, v49, v36
  v_cvt_pknorm_u16_f32 v39, v90, v91
  v_add_u32 v46, v48, v38
  s_waitcnt lgkmcnt(2)
  v_mfma_f32_32x32x16_bf16 v[68:83], v[24:27], v[16:19], v[52:67]
  ds_read_b128 v[24:27], v5 offset:13312
  v_pk_fma_f16 v37, v45, v49, v37
  v_cvt_pknorm_u16_f32 v40, v92, v93
  v_add_u32 v47, v48, v39
  v_pk_fma_f16 v38, v46, v49, v38
  v_cvt_pknorm_u16_f32 v41, v94, v95
  v_add_u32 v44, v48, v40
  v_pk_fma_f16 v39, v47, v49, v39
  v_cvt_pknorm_u16_f32 v42, v96, v97
  v_add_u32 v45, v48, v41
  v_pk_fma_f16 v40, v44, v49, v40
  v_cvt_pknorm_u16_f32 v43, v98, v99
  v_add_u32 v46, v48, v42
  s_waitcnt lgkmcnt(2)
  v_mfma_f32_32x32x16_f16 v[100:115], v[28:31], v[36:39], v[100:115]
  ds_read_b128 v[28:31], v3 offset:4096
  v_pk_fma_f16 v41, v45, v49, v41
  v_add_u32 v47, v48, v43
  v_pk_fma_f16 v42, v46, v49, v42
  v_pk_fma_f16 v43, v47, v49, v43
  v_cvt_pknorm_u16_f32 v36, v68, v69
  v_cvt_pknorm_u16_f32 v37, v70, v71
  s_waitcnt lgkmcnt(2)
  v_mfma_f32_32x32x16_f16 v[100:115], v[32:35], v[40:43], v[100:115]
  ds_read_b128 v[32:35], v3 offset:4608
  v_add_u32 v44, v48, v36
  v_cvt_pknorm_u16_f32 v38, v72, v73
  v_add_u32 v45, v48, v37
  buffer_load_dwordx4 v5, s[8:11], s32 offen sc1 lds
  s_add_u32 m0, m0, 65536
  s_add_u32 s32, s32, 65536
  v_pk_fma_f16 v36, v44, v49, v36
  v_cvt_pknorm_u16_f32 v39, v74, v75
  v_add_u32 v46, v48, v38
  s_waitcnt lgkmcnt(2)
  v_mfma_f32_32x32x16_bf16 v[84:99], v[24:27], v[16:19], v[52:67]
  ds_read_b128 v[24:27], v5 offset:14336
  v_pk_fma_f16 v37, v45, v49, v37
  v_cvt_pknorm_u16_f32 v40, v76, v77
  v_add_u32 v47, v48, v39
  v_pk_fma_f16 v38, v46, v49, v38
  v_cvt_pknorm_u16_f32 v41, v78, v79
  v_add_u32 v44, v48, v40
  v_pk_fma_f16 v39, v47, v49, v39
  v_cvt_pknorm_u16_f32 v42, v80, v81
  v_add_u32 v45, v48, v41
  v_pk_fma_f16 v40, v44, v49, v40
  v_cvt_pknorm_u16_f32 v43, v82, v83
  v_add_u32 v46, v48, v42
  s_waitcnt lgkmcnt(2)
  v_mfma_f32_32x32x16_f16 v[100:115], v[28:31], v[36:39], v[100:115]
  ds_read_b128 v[28:31], v3 offset:5120
  v_pk_fma_f16 v41, v45, v49, v41
  v_add_u32 v47, v48, v43
  v_pk_fma_f16 v42, v46, v49, v42
  v_pk_fma_f16 v43, v47, v49, v43
  v_cvt_pknorm_u16_f32 v36, v84, v85
  v_cvt_pknorm_u16_f32 v37, v86, v87
  s_waitcnt lgkmcnt(2)
  v_mfma_f32_32x32x16_f16 v[100:115], v[32:35], v[40:43], v[100:115]
  ds_read_b128 v[32:35], v3 offset:5632
  v_add_u32 v44, v48, v36
  v_cvt_pknorm_u16_f32 v38, v88, v89
  v_add_u32 v45, v48, v37
  v_pk_fma_f16 v36, v44, v49, v36
  v_cvt_pknorm_u16_f32 v39, v90, v91
  v_add_u32 v46, v48, v38
  s_waitcnt lgkmcnt(2)
  v_mfma_f32_32x32x16_bf16 v[68:83], v[24:27], v[16:19], v[52:67]
  ds_read_b128 v[24:27], v5 offset:15360
  v_pk_fma_f16 v37, v45, v49, v37
  v_cvt_pknorm_u16_f32 v40, v92, v93
  v_add_u32 v47, v48, v39
  v_pk_fma_f16 v38, v46, v49, v38
  v_cvt_pknorm_u16_f32 v41, v94, v95
  v_add_u32 v44, v48, v40
  v_pk_fma_f16 v39, v47, v49, v39
  v_cvt_pknorm_u16_f32 v42, v96, v97
  v_add_u32 v45, v48, v41
  v_pk_fma_f16 v40, v44, v49, v40
  v_cvt_pknorm_u16_f32 v43, v98, v99
  v_add_u32 v46, v48, v42
  s_waitcnt lgkmcnt(2)
  v_mfma_f32_32x32x16_f16 v[100:115], v[28:31], v[36:39], v[100:115]
  ds_read_b128 v[28:31], v3 offset:6144
  v_pk_fma_f16 v41, v45, v49, v41
  v_add_u32 v47, v48, v43
  v_pk_fma_f16 v42, v46, v49, v42
  v_pk_fma_f16 v43, v47, v49, v43
  s_barrier
  v_cvt_pknorm_u16_f32 v36, v68, v69
  v_cvt_pknorm_u16_f32 v37, v70, v71
  s_waitcnt lgkmcnt(2)
  v_mfma_f32_32x32x16_f16 v[100:115], v[32:35], v[40:43], v[100:115]
  ds_read_b128 v[32:35], v3 offset:6656
  v_add_u32 v44, v48, v36
  v_cvt_pknorm_u16_f32 v38, v72, v73
  v_add_u32 v45, v48, v37
  v_pk_fma_f16 v36, v44, v49, v36
  v_cvt_pknorm_u16_f32 v39, v74, v75
  v_add_u32 v46, v48, v38
  s_waitcnt lgkmcnt(2)
  v_mfma_f32_32x32x16_bf16 v[84:99], v[24:27], v[16:19], v[52:67]
  ds_read_b128 v[24:27], v5 offset:16384
  v_pk_fma_f16 v37, v45, v49, v37
  v_cvt_pknorm_u16_f32 v40, v76, v77
  v_add_u32 v47, v48, v39
  v_pk_fma_f16 v38, v46, v49, v38
  v_cvt_pknorm_u16_f32 v41, v78, v79
  v_add_u32 v44, v48, v40
  v_pk_fma_f16 v39, v47, v49, v39
  v_cvt_pknorm_u16_f32 v42, v80, v81
  v_add_u32 v45, v48, v41
  v_pk_fma_f16 v40, v44, v49, v40
  v_cvt_pknorm_u16_f32 v43, v82, v83
  v_add_u32 v46, v48, v42
  s_waitcnt lgkmcnt(2)
  v_mfma_f32_32x32x16_f16 v[100:115], v[28:31], v[36:39], v[100:115]
  ds_read_b128 v[28:31], v3 offset:7168
  v_pk_fma_f16 v41, v45, v49, v41
  v_add_u32 v47, v48, v43
  v_pk_fma_f16 v42, v46, v49, v42
  v_pk_fma_f16 v43, v47, v49, v43
  v_cvt_pknorm_u16_f32 v36, v84, v85
  v_cvt_pknorm_u16_f32 v37, v86, v87
  s_waitcnt lgkmcnt(2)
  v_mfma_f32_32x32x16_f16 v[100:115], v[32:35], v[40:43], v[100:115]
  ds_read_b128 v[32:35], v3 offset:7680
  v_add_u32 v44, v48, v36
  v_cvt_pknorm_u16_f32 v38, v88, v89
  v_add_u32 v45, v48, v37
  buffer_load_dwordx4 v5, s[8:11], s32 offen sc1 lds
  s_sub_u32 m0, m0, 57344
  s_sub_u32 s32, s32, 57344
  v_pk_fma_f16 v36, v44, v49, v36
  v_cvt_pknorm_u16_f32 v39, v90, v91
  v_add_u32 v46, v48, v38
  s_waitcnt lgkmcnt(2)
  v_mfma_f32_32x32x16_bf16 v[68:83], v[24:27], v[16:19], v[52:67]
  ds_read_b128 v[24:27], v5 offset:17408
  v_pk_fma_f16 v37, v45, v49, v37
  v_cvt_pknorm_u16_f32 v40, v92, v93
  v_add_u32 v47, v48, v39
  v_pk_fma_f16 v38, v46, v49, v38
  v_cvt_pknorm_u16_f32 v41, v94, v95
  v_add_u32 v44, v48, v40
  v_pk_fma_f16 v39, v47, v49, v39
  v_cvt_pknorm_u16_f32 v42, v96, v97
  v_add_u32 v45, v48, v41
  v_pk_fma_f16 v40, v44, v49, v40
  v_cvt_pknorm_u16_f32 v43, v98, v99
  v_add_u32 v46, v48, v42
  s_waitcnt lgkmcnt(2)
  v_mfma_f32_32x32x16_f16 v[100:115], v[28:31], v[36:39], v[100:115]
  v_add_u32 v3, v4, v3
  ds_read_b128 v[28:31], v3 offset:0
  v_pk_fma_f16 v41, v45, v49, v41
  v_add_u32 v47, v48, v43
  v_pk_fma_f16 v42, v46, v49, v42
  v_pk_fma_f16 v43, v47, v49, v43
  v_cvt_pknorm_u16_f32 v36, v68, v69
  v_cvt_pknorm_u16_f32 v37, v70, v71
  s_waitcnt lgkmcnt(2)
  v_mfma_f32_32x32x16_f16 v[100:115], v[32:35], v[40:43], v[100:115]
  ds_read_b128 v[32:35], v3 offset:512
  s_waitcnt vmcnt(5)
  v_mfma_f32_32x32x16_bf16 v[132:147], v[196:199], v[204:207], v[132:147]
  v_add_u32 v44, v48, v36
  v_cvt_pknorm_u16_f32 v38, v72, v73
  v_add_u32 v45, v48, v37
  v_pk_fma_f16 v36, v44, v49, v36
  v_cvt_pknorm_u16_f32 v39, v74, v75
  v_add_u32 v46, v48, v38
  s_waitcnt lgkmcnt(2)
  v_mfma_f32_32x32x16_bf16 v[84:99], v[24:27], v[16:19], v[52:67]
  ds_read_b128 v[24:27], v5 offset:18432
  v_pk_fma_f16 v37, v45, v49, v37
  v_cvt_pknorm_u16_f32 v40, v76, v77
  v_add_u32 v47, v48, v39
  v_pk_fma_f16 v38, v46, v49, v38
  v_cvt_pknorm_u16_f32 v41, v78, v79
  v_add_u32 v44, v48, v40
  s_waitcnt vmcnt(4)
  v_mfma_f32_32x32x16_bf16 v[164:179], v[196:199], v[208:211], v[164:179]
  buffer_load_dwordx4 v[196:199], v5, s[8:11], s24 offen offset:2048 sc1
  v_pk_fma_f16 v39, v47, v49, v39
  v_cvt_pknorm_u16_f32 v42, v80, v81
  v_add_u32 v45, v48, v41
  v_pk_fma_f16 v40, v44, v49, v40
  v_cvt_pknorm_u16_f32 v43, v82, v83
  v_add_u32 v46, v48, v42
  s_waitcnt lgkmcnt(2)
  v_mfma_f32_32x32x16_f16 v[100:115], v[28:31], v[36:39], v[100:115]
  ds_read_b128 v[28:31], v3 offset:1024
  v_pk_fma_f16 v41, v45, v49, v41
  v_add_u32 v47, v48, v43
  v_pk_fma_f16 v42, v46, v49, v42
  v_pk_fma_f16 v43, v47, v49, v43
  v_cvt_pknorm_u16_f32 v36, v84, v85
  v_cvt_pknorm_u16_f32 v37, v86, v87
  s_waitcnt lgkmcnt(2)
  v_mfma_f32_32x32x16_f16 v[100:115], v[32:35], v[40:43], v[100:115]
  ds_read_b128 v[32:35], v3 offset:1536
  v_add_u32 v44, v48, v36
  v_cvt_pknorm_u16_f32 v38, v88, v89
  v_add_u32 v45, v48, v37
  v_pk_fma_f16 v36, v44, v49, v36
  v_cvt_pknorm_u16_f32 v39, v90, v91
  v_add_u32 v46, v48, v38
  s_waitcnt lgkmcnt(2)
  v_mfma_f32_32x32x16_bf16 v[68:83], v[24:27], v[16:19], v[52:67]
  ds_read_b128 v[24:27], v5 offset:19456
  v_pk_fma_f16 v37, v45, v49, v37
  v_cvt_pknorm_u16_f32 v40, v92, v93
  v_add_u32 v47, v48, v39
  v_pk_fma_f16 v38, v46, v49, v38
  v_cvt_pknorm_u16_f32 v41, v94, v95
  v_add_u32 v44, v48, v40
  v_mfma_f32_32x32x16_bf16 v[148:163], v[200:203], v[204:207], v[148:163]
  buffer_load_dwordx4 v[204:207], v5, s[8:11], s26 offen offset:2048 sc1
  v_pk_fma_f16 v39, v47, v49, v39
  v_cvt_pknorm_u16_f32 v42, v96, v97
  v_add_u32 v45, v48, v41
  v_pk_fma_f16 v40, v44, v49, v40
  v_cvt_pknorm_u16_f32 v43, v98, v99
  v_add_u32 v46, v48, v42
  s_waitcnt lgkmcnt(2)
  v_mfma_f32_32x32x16_f16 v[100:115], v[28:31], v[36:39], v[100:115]
  ds_read_b128 v[28:31], v3 offset:2048
  v_pk_fma_f16 v41, v45, v49, v41
  v_add_u32 v47, v48, v43
  v_pk_fma_f16 v42, v46, v49, v42
  v_pk_fma_f16 v43, v47, v49, v43
  v_cvt_pknorm_u16_f32 v36, v68, v69
  v_cvt_pknorm_u16_f32 v37, v70, v71
  s_waitcnt lgkmcnt(2)
  v_mfma_f32_32x32x16_f16 v[100:115], v[32:35], v[40:43], v[100:115]
  ds_read_b128 v[32:35], v3 offset:2560
  v_add_u32 v44, v48, v36
  v_cvt_pknorm_u16_f32 v38, v72, v73
  v_add_u32 v45, v48, v37
  v_pk_fma_f16 v36, v44, v49, v36
  v_cvt_pknorm_u16_f32 v39, v74, v75
  v_add_u32 v46, v48, v38
  s_waitcnt lgkmcnt(2)
  v_mfma_f32_32x32x16_bf16 v[84:99], v[24:27], v[16:19], v[52:67]
  ds_read_b128 v[24:27], v5 offset:20480
  v_pk_fma_f16 v37, v45, v49, v37
  v_cvt_pknorm_u16_f32 v40, v76, v77
  v_add_u32 v47, v48, v39
  v_pk_fma_f16 v38, v46, v49, v38
  v_cvt_pknorm_u16_f32 v41, v78, v79
  v_add_u32 v44, v48, v40
  v_mfma_f32_32x32x16_bf16 v[180:195], v[200:203], v[208:211], v[180:195]
  buffer_load_dwordx4 v[208:211], v5, s[8:11], s27 offen offset:2048 sc1
  buffer_load_dwordx4 v[200:203], v5, s[8:11], s25 offen offset:2048 sc1
  v_pk_fma_f16 v39, v47, v49, v39
  v_cvt_pknorm_u16_f32 v42, v80, v81
  v_add_u32 v45, v48, v41
  v_pk_fma_f16 v40, v44, v49, v40
  v_cvt_pknorm_u16_f32 v43, v82, v83
  v_add_u32 v46, v48, v42
  s_waitcnt lgkmcnt(2)
  v_mfma_f32_32x32x16_f16 v[100:115], v[28:31], v[36:39], v[100:115]
  ds_read_b128 v[28:31], v3 offset:3072
  v_pk_fma_f16 v41, v45, v49, v41
  v_add_u32 v47, v48, v43
  v_pk_fma_f16 v42, v46, v49, v42
  v_pk_fma_f16 v43, v47, v49, v43
  v_cvt_pknorm_u16_f32 v36, v84, v85
  v_cvt_pknorm_u16_f32 v37, v86, v87
  s_waitcnt lgkmcnt(2)
  v_mfma_f32_32x32x16_f16 v[100:115], v[32:35], v[40:43], v[100:115]
  ds_read_b128 v[32:35], v3 offset:3584
  s_waitcnt vmcnt(7)
  v_mfma_f32_32x32x16_bf16 v[132:147], v[212:215], v[220:223], v[132:147]
  v_add_u32 v44, v48, v36
  v_cvt_pknorm_u16_f32 v38, v88, v89
  v_add_u32 v45, v48, v37
  v_pk_fma_f16 v36, v44, v49, v36
  v_cvt_pknorm_u16_f32 v39, v90, v91
  v_add_u32 v46, v48, v38
  s_waitcnt lgkmcnt(2)
  v_mfma_f32_32x32x16_bf16 v[68:83], v[24:27], v[16:19], v[52:67]
  ds_read_b128 v[24:27], v5 offset:21504
  v_pk_fma_f16 v37, v45, v49, v37
  v_cvt_pknorm_u16_f32 v40, v92, v93
  v_add_u32 v47, v48, v39
  v_pk_fma_f16 v38, v46, v49, v38
  v_cvt_pknorm_u16_f32 v41, v94, v95
  v_add_u32 v44, v48, v40
  s_waitcnt vmcnt(6)
  v_mfma_f32_32x32x16_bf16 v[164:179], v[212:215], v[224:227], v[164:179]
  buffer_load_dwordx4 v[212:215], v5, s[8:11], s24 offen offset:3072 sc1
  v_pk_fma_f16 v39, v47, v49, v39
  v_cvt_pknorm_u16_f32 v42, v96, v97
  v_add_u32 v45, v48, v41
  v_pk_fma_f16 v40, v44, v49, v40
  v_cvt_pknorm_u16_f32 v43, v98, v99
  v_add_u32 v46, v48, v42
  s_waitcnt lgkmcnt(2)
  v_mfma_f32_32x32x16_f16 v[100:115], v[28:31], v[36:39], v[100:115]
  ds_read_b128 v[28:31], v3 offset:4096
  v_pk_fma_f16 v41, v45, v49, v41
  v_add_u32 v47, v48, v43
  v_pk_fma_f16 v42, v46, v49, v42
  v_pk_fma_f16 v43, v47, v49, v43
  v_cvt_pknorm_u16_f32 v36, v68, v69
  v_cvt_pknorm_u16_f32 v37, v70, v71
  s_waitcnt lgkmcnt(2)
  v_mfma_f32_32x32x16_f16 v[100:115], v[32:35], v[40:43], v[100:115]
  ds_read_b128 v[32:35], v3 offset:4608
  v_add_u32 v44, v48, v36
  v_cvt_pknorm_u16_f32 v38, v72, v73
  v_add_u32 v45, v48, v37
  s_lshl_b32 s19, s17, 8
  s_add_u32 s19, s19, 2228224
  s_lshl_b32 s20, s30, 7
  s_add_u32 s20, s20, s19
  buffer_load_dword v7, v6, s[8:11], s20 offen sc1
  s_lshl_b32 s20, s22, 7
  s_add_u32 s20, s20, s19
  buffer_load_dword v6, v6, s[8:11], s20 offen sc1
  v_pk_fma_f16 v36, v44, v49, v36
  v_cvt_pknorm_u16_f32 v39, v74, v75
  v_add_u32 v46, v48, v38
  s_waitcnt lgkmcnt(2)
  v_mfma_f32_32x32x16_bf16 v[84:99], v[24:27], v[16:19], v[52:67]
  ds_read_b128 v[24:27], v5 offset:22528
  v_pk_fma_f16 v37, v45, v49, v37
  v_cvt_pknorm_u16_f32 v40, v76, v77
  v_add_u32 v47, v48, v39
  v_pk_fma_f16 v38, v46, v49, v38
  v_cvt_pknorm_u16_f32 v41, v78, v79
  v_add_u32 v44, v48, v40
  v_mfma_f32_32x32x16_bf16 v[148:163], v[216:219], v[220:223], v[148:163]
  buffer_load_dwordx4 v[220:223], v5, s[8:11], s26 offen offset:3072 sc1
  v_pk_fma_f16 v39, v47, v49, v39
  v_cvt_pknorm_u16_f32 v42, v80, v81
  v_add_u32 v45, v48, v41
  v_pk_fma_f16 v40, v44, v49, v40
  v_cvt_pknorm_u16_f32 v43, v82, v83
  v_add_u32 v46, v48, v42
  s_waitcnt lgkmcnt(2)
  v_mfma_f32_32x32x16_f16 v[100:115], v[28:31], v[36:39], v[100:115]
  ds_read_b128 v[28:31], v3 offset:5120
  v_pk_fma_f16 v41, v45, v49, v41
  v_add_u32 v47, v48, v43
  v_pk_fma_f16 v42, v46, v49, v42
  v_pk_fma_f16 v43, v47, v49, v43
  v_cvt_pknorm_u16_f32 v36, v84, v85
  v_cvt_pknorm_u16_f32 v37, v86, v87
  s_waitcnt lgkmcnt(2)
  v_mfma_f32_32x32x16_f16 v[100:115], v[32:35], v[40:43], v[100:115]
  ds_read_b128 v[32:35], v3 offset:5632
  v_add_u32 v44, v48, v36
  v_cvt_pknorm_u16_f32 v38, v88, v89
  v_add_u32 v45, v48, v37
  v_pk_fma_f16 v36, v44, v49, v36
  v_cvt_pknorm_u16_f32 v39, v90, v91
  v_add_u32 v46, v48, v38
  s_waitcnt lgkmcnt(2)
  v_mfma_f32_32x32x16_bf16 v[68:83], v[24:27], v[16:19], v[52:67]
  ds_read_b128 v[24:27], v5 offset:23552
  v_pk_fma_f16 v37, v45, v49, v37
  v_cvt_pknorm_u16_f32 v40, v92, v93
  v_add_u32 v47, v48, v39
  v_pk_fma_f16 v38, v46, v49, v38
  v_cvt_pknorm_u16_f32 v41, v94, v95
  v_add_u32 v44, v48, v40
  v_mfma_f32_32x32x16_bf16 v[180:195], v[216:219], v[224:227], v[180:195]
  buffer_load_dwordx4 v[224:227], v5, s[8:11], s27 offen offset:3072 sc1
  buffer_load_dwordx4 v[216:219], v5, s[8:11], s25 offen offset:3072 sc1
  v_pk_fma_f16 v39, v47, v49, v39
  v_cvt_pknorm_u16_f32 v42, v96, v97
  v_add_u32 v45, v48, v41
  v_pk_fma_f16 v40, v44, v49, v40
  v_cvt_pknorm_u16_f32 v43, v98, v99
  v_add_u32 v46, v48, v42
  s_waitcnt lgkmcnt(2)
  v_mfma_f32_32x32x16_f16 v[100:115], v[28:31], v[36:39], v[100:115]
  ds_read_b128 v[28:31], v3 offset:6144
  v_pk_fma_f16 v41, v45, v49, v41
  v_add_u32 v47, v48, v43
  v_pk_fma_f16 v42, v46, v49, v42
  v_pk_fma_f16 v43, v47, v49, v43
  v_cvt_pknorm_u16_f32 v36, v68, v69
  v_cvt_pknorm_u16_f32 v37, v70, v71
  s_waitcnt lgkmcnt(2)
  v_mfma_f32_32x32x16_f16 v[100:115], v[32:35], v[40:43], v[100:115]
  ds_read_b128 v[32:35], v3 offset:6656
  v_add_u32 v44, v48, v36
  v_cvt_pknorm_u16_f32 v38, v72, v73
  v_add_u32 v45, v48, v37
  v_pk_fma_f16 v36, v44, v49, v36
  v_cvt_pknorm_u16_f32 v39, v74, v75
  v_add_u32 v46, v48, v38
  s_waitcnt lgkmcnt(2)
  v_mfma_f32_32x32x16_bf16 v[84:99], v[24:27], v[16:19], v[52:67]
  ds_read_b128 v[24:27], v5 offset:24576
  v_pk_fma_f16 v37, v45, v49, v37
  v_cvt_pknorm_u16_f32 v40, v76, v77
  v_add_u32 v47, v48, v39
  v_pk_fma_f16 v38, v46, v49, v38
  v_cvt_pknorm_u16_f32 v41, v78, v79
  v_add_u32 v44, v48, v40
  s_waitcnt vmcnt(8)
  v_mfma_f32_32x32x16_bf16 v[132:147], v[196:199], v[204:207], v[132:147]
  v_pk_fma_f16 v39, v47, v49, v39
  v_cvt_pknorm_u16_f32 v42, v80, v81
  v_add_u32 v45, v48, v41
  v_pk_fma_f16 v40, v44, v49, v40
  v_cvt_pknorm_u16_f32 v43, v82, v83
  v_add_u32 v46, v48, v42
  s_waitcnt lgkmcnt(2)
  v_mfma_f32_32x32x16_f16 v[100:115], v[28:31], v[36:39], v[100:115]
  ds_read_b128 v[28:31], v3 offset:7168
  v_pk_fma_f16 v41, v45, v49, v41
  v_add_u32 v47, v48, v43
  v_pk_fma_f16 v42, v46, v49, v42
  v_pk_fma_f16 v43, v47, v49, v43
  v_cvt_pknorm_u16_f32 v36, v84, v85
  v_cvt_pknorm_u16_f32 v37, v86, v87
  s_waitcnt lgkmcnt(2)
  v_mfma_f32_32x32x16_f16 v[100:115], v[32:35], v[40:43], v[100:115]
  ds_read_b128 v[32:35], v3 offset:7680
  s_waitcnt vmcnt(7)
  v_mfma_f32_32x32x16_bf16 v[164:179], v[196:199], v[208:211], v[164:179]
  s_add_u32 s24, s24, 4096
  buffer_load_dwordx4 v[196:199], v5, s[8:11], s24 offen offset:0 sc1
  v_add_u32 v44, v48, v36
  v_cvt_pknorm_u16_f32 v38, v88, v89
  v_add_u32 v45, v48, v37
  v_pk_fma_f16 v36, v44, v49, v36
  v_cvt_pknorm_u16_f32 v39, v90, v91
  v_add_u32 v46, v48, v38
  s_waitcnt lgkmcnt(2)
  v_mfma_f32_32x32x16_bf16 v[68:83], v[24:27], v[16:19], v[52:67]
  ds_read_b128 v[24:27], v5 offset:25600
  v_pk_fma_f16 v37, v45, v49, v37
  v_cvt_pknorm_u16_f32 v40, v92, v93
  v_add_u32 v47, v48, v39
  v_pk_fma_f16 v38, v46, v49, v38
  v_cvt_pknorm_u16_f32 v41, v94, v95
  v_add_u32 v44, v48, v40
  s_waitcnt vmcnt(7)
  v_mfma_f32_32x32x16_bf16 v[148:163], v[200:203], v[204:207], v[148:163]
  s_add_u32 s26, s26, 4096
  buffer_load_dwordx4 v[204:207], v5, s[8:11], s26 offen offset:0 sc1
  v_pk_fma_f16 v39, v47, v49, v39
  v_cvt_pknorm_u16_f32 v42, v96, v97
  v_add_u32 v45, v48, v41
  v_pk_fma_f16 v40, v44, v49, v40
  v_cvt_pknorm_u16_f32 v43, v98, v99
  v_add_u32 v46, v48, v42
  s_waitcnt lgkmcnt(2)
  v_mfma_f32_32x32x16_f16 v[100:115], v[28:31], v[36:39], v[100:115]
  v_add_u32 v3, v4, v3
  ds_read_b128 v[28:31], v3 offset:0
  v_pk_fma_f16 v41, v45, v49, v41
  v_add_u32 v47, v48, v43
  v_pk_fma_f16 v42, v46, v49, v42
  v_pk_fma_f16 v43, v47, v49, v43
  v_cvt_pknorm_u16_f32 v36, v68, v69
  v_cvt_pknorm_u16_f32 v37, v70, v71
  s_waitcnt lgkmcnt(2)
  v_mfma_f32_32x32x16_f16 v[100:115], v[32:35], v[40:43], v[100:115]
  ds_read_b128 v[32:35], v3 offset:512
  v_add_u32 v44, v48, v36
  v_cvt_pknorm_u16_f32 v38, v72, v73
  v_add_u32 v45, v48, v37
  buffer_load_dwordx4 v5, s[8:11], s32 offen sc1 lds
  s_add_u32 m0, m0, 65536
  s_add_u32 s32, s32, 65536
  v_pk_fma_f16 v36, v44, v49, v36
  v_cvt_pknorm_u16_f32 v39, v74, v75
  v_add_u32 v46, v48, v38
  s_waitcnt lgkmcnt(2)
  v_mfma_f32_32x32x16_bf16 v[84:99], v[24:27], v[16:19], v[52:67]
  ds_read_b128 v[24:27], v5 offset:26624
  v_pk_fma_f16 v37, v45, v49, v37
  v_cvt_pknorm_u16_f32 v40, v76, v77
  v_add_u32 v47, v48, v39
  v_pk_fma_f16 v38, v46, v49, v38
  v_cvt_pknorm_u16_f32 v41, v78, v79
  v_add_u32 v44, v48, v40
  v_mfma_f32_32x32x16_bf16 v[180:195], v[200:203], v[208:211], v[180:195]
  s_add_u32 s27, s27, 4096
  buffer_load_dwordx4 v[208:211], v5, s[8:11], s27 offen offset:0 sc1
  s_add_u32 s25, s25, 4096
  buffer_load_dwordx4 v[200:203], v5, s[8:11], s25 offen offset:0 sc1
  v_pk_fma_f16 v39, v47, v49, v39
  v_cvt_pknorm_u16_f32 v42, v80, v81
  v_add_u32 v45, v48, v41
  v_pk_fma_f16 v40, v44, v49, v40
  v_cvt_pknorm_u16_f32 v43, v82, v83
  v_add_u32 v46, v48, v42
  s_waitcnt lgkmcnt(2)
  v_mfma_f32_32x32x16_f16 v[100:115], v[28:31], v[36:39], v[100:115]
  ds_read_b128 v[28:31], v3 offset:1024
  v_pk_fma_f16 v41, v45, v49, v41
  v_add_u32 v47, v48, v43
  v_pk_fma_f16 v42, v46, v49, v42
  v_pk_fma_f16 v43, v47, v49, v43
  v_cvt_pknorm_u16_f32 v36, v84, v85
  v_cvt_pknorm_u16_f32 v37, v86, v87
  s_waitcnt lgkmcnt(2)
  v_mfma_f32_32x32x16_f16 v[100:115], v[32:35], v[40:43], v[100:115]
  ds_read_b128 v[32:35], v3 offset:1536
  v_add_u32 v44, v48, v36
  v_cvt_pknorm_u16_f32 v38, v88, v89
  v_add_u32 v45, v48, v37
  v_pk_fma_f16 v36, v44, v49, v36
  v_cvt_pknorm_u16_f32 v39, v90, v91
  v_add_u32 v46, v48, v38
  s_waitcnt lgkmcnt(2)
  v_mfma_f32_32x32x16_bf16 v[68:83], v[24:27], v[16:19], v[52:67]
  ds_read_b128 v[24:27], v5 offset:27648
  v_pk_fma_f16 v37, v45, v49, v37
  v_cvt_pknorm_u16_f32 v40, v92, v93
  v_add_u32 v47, v48, v39
  v_pk_fma_f16 v38, v46, v49, v38
  v_cvt_pknorm_u16_f32 v41, v94, v95
  v_add_u32 v44, v48, v40
  s_waitcnt vmcnt(7)
  v_mfma_f32_32x32x16_bf16 v[132:147], v[212:215], v[220:223], v[132:147]
  v_pk_fma_f16 v39, v47, v49, v39
  v_cvt_pknorm_u16_f32 v42, v96, v97
  v_add_u32 v45, v48, v41
  v_pk_fma_f16 v40, v44, v49, v40
  v_cvt_pknorm_u16_f32 v43, v98, v99
  v_add_u32 v46, v48, v42
  s_waitcnt lgkmcnt(2)
  v_mfma_f32_32x32x16_f16 v[100:115], v[28:31], v[36:39], v[100:115]
  ds_read_b128 v[28:31], v3 offset:2048
  v_pk_fma_f16 v41, v45, v49, v41
  v_add_u32 v47, v48, v43
  v_pk_fma_f16 v42, v46, v49, v42
  v_pk_fma_f16 v43, v47, v49, v43
  v_cvt_pknorm_u16_f32 v36, v68, v69
  v_cvt_pknorm_u16_f32 v37, v70, v71
  s_waitcnt lgkmcnt(2)
  v_mfma_f32_32x32x16_f16 v[100:115], v[32:35], v[40:43], v[100:115]
  ds_read_b128 v[32:35], v3 offset:2560
  v_add_u32 v44, v48, v36
  v_cvt_pknorm_u16_f32 v38, v72, v73
  v_add_u32 v45, v48, v37
  buffer_load_dwordx4 v5, s[8:11], s32 offen sc1 lds
  s_sub_u32 m0, m0, 57344
  s_sub_u32 s32, s32, 57344
  v_pk_fma_f16 v36, v44, v49, v36
  v_cvt_pknorm_u16_f32 v39, v74, v75
  v_add_u32 v46, v48, v38
  s_waitcnt lgkmcnt(2)
  v_mfma_f32_32x32x16_bf16 v[84:99], v[24:27], v[16:19], v[52:67]
  ds_read_b128 v[24:27], v5 offset:28672
  v_pk_fma_f16 v37, v45, v49, v37
  v_cvt_pknorm_u16_f32 v40, v76, v77
  v_add_u32 v47, v48, v39
  v_pk_fma_f16 v38, v46, v49, v38
  v_cvt_pknorm_u16_f32 v41, v78, v79
  v_add_u32 v44, v48, v40
  s_waitcnt vmcnt(7)
  v_mfma_f32_32x32x16_bf16 v[164:179], v[212:215], v[224:227], v[164:179]
  buffer_load_dwordx4 v[212:215], v5, s[8:11], s24 offen offset:1024 sc1
  v_pk_fma_f16 v39, v47, v49, v39
  v_cvt_pknorm_u16_f32 v42, v80, v81
  v_add_u32 v45, v48, v41
  v_pk_fma_f16 v40, v44, v49, v40
  v_cvt_pknorm_u16_f32 v43, v82, v83
  v_add_u32 v46, v48, v42
  s_waitcnt lgkmcnt(2)
  v_mfma_f32_32x32x16_f16 v[100:115], v[28:31], v[36:39], v[100:115]
  ds_read_b128 v[28:31], v3 offset:3072
  v_pk_fma_f16 v41, v45, v49, v41
  v_add_u32 v47, v48, v43
  v_pk_fma_f16 v42, v46, v49, v42
  v_pk_fma_f16 v43, v47, v49, v43
  v_cvt_pknorm_u16_f32 v36, v84, v85
  v_cvt_pknorm_u16_f32 v37, v86, v87
  s_waitcnt lgkmcnt(2)
  v_mfma_f32_32x32x16_f16 v[100:115], v[32:35], v[40:43], v[100:115]
  ds_read_b128 v[32:35], v3 offset:3584
  s_waitcnt vmcnt(7)
  v_mfma_f32_32x32x16_bf16 v[148:163], v[216:219], v[220:223], v[148:163]
  buffer_load_dwordx4 v[220:223], v5, s[8:11], s26 offen offset:1024 sc1
  v_add_u32 v44, v48, v36
  v_cvt_pknorm_u16_f32 v38, v88, v89
  v_add_u32 v45, v48, v37
  v_pk_fma_f16 v36, v44, v49, v36
  v_cvt_pknorm_u16_f32 v39, v90, v91
  v_add_u32 v46, v48, v38
  s_waitcnt lgkmcnt(2)
  v_mfma_f32_32x32x16_bf16 v[68:83], v[24:27], v[16:19], v[52:67]
  ds_read_b128 v[24:27], v5 offset:29696
  v_pk_fma_f16 v37, v45, v49, v37
  v_cvt_pknorm_u16_f32 v40, v92, v93
  v_add_u32 v47, v48, v39
  v_pk_fma_f16 v38, v46, v49, v38
  v_cvt_pknorm_u16_f32 v41, v94, v95
  v_add_u32 v44, v48, v40
  v_mfma_f32_32x32x16_bf16 v[180:195], v[216:219], v[224:227], v[180:195]
  buffer_load_dwordx4 v[224:227], v5, s[8:11], s27 offen offset:1024 sc1
  buffer_load_dwordx4 v[216:219], v5, s[8:11], s25 offen offset:1024 sc1
  v_pk_fma_f16 v39, v47, v49, v39
  v_cvt_pknorm_u16_f32 v42, v96, v97
  v_add_u32 v45, v48, v41
  v_pk_fma_f16 v40, v44, v49, v40
  v_cvt_pknorm_u16_f32 v43, v98, v99
  v_add_u32 v46, v48, v42
  s_waitcnt lgkmcnt(2)
  v_mfma_f32_32x32x16_f16 v[100:115], v[28:31], v[36:39], v[100:115]
  ds_read_b128 v[28:31], v3 offset:4096
  v_pk_fma_f16 v41, v45, v49, v41
  v_add_u32 v47, v48, v43
  v_pk_fma_f16 v42, v46, v49, v42
  v_pk_fma_f16 v43, v47, v49, v43
  v_cvt_pknorm_u16_f32 v36, v68, v69
  v_cvt_pknorm_u16_f32 v37, v70, v71
  s_waitcnt lgkmcnt(2)
  v_mfma_f32_32x32x16_f16 v[100:115], v[32:35], v[40:43], v[100:115]
  ds_read_b128 v[32:35], v3 offset:4608
  v_add_u32 v44, v48, v36
  v_cvt_pknorm_u16_f32 v38, v72, v73
  v_add_u32 v45, v48, v37
  buffer_load_dwordx4 v5, s[8:11], s32 offen sc1 lds
  s_add_u32 m0, m0, 65536
  s_add_u32 s32, s32, 65536
  v_pk_fma_f16 v36, v44, v49, v36
  v_cvt_pknorm_u16_f32 v39, v74, v75
  v_add_u32 v46, v48, v38
  s_waitcnt lgkmcnt(2)
  v_mfma_f32_32x32x16_bf16 v[84:99], v[24:27], v[16:19], v[52:67]
  ds_read_b128 v[24:27], v5 offset:30720
  v_pk_fma_f16 v37, v45, v49, v37
  v_cvt_pknorm_u16_f32 v40, v76, v77
  v_add_u32 v47, v48, v39
  v_pk_fma_f16 v38, v46, v49, v38
  v_cvt_pknorm_u16_f32 v41, v78, v79
  v_add_u32 v44, v48, v40
  s_waitcnt vmcnt(9)
  v_mfma_f32_32x32x16_bf16 v[132:147], v[196:199], v[204:207], v[132:147]
  v_pk_fma_f16 v39, v47, v49, v39
  v_cvt_pknorm_u16_f32 v42, v80, v81
  v_add_u32 v45, v48, v41
  v_pk_fma_f16 v40, v44, v49, v40
  v_cvt_pknorm_u16_f32 v43, v82, v83
  v_add_u32 v46, v48, v42
  s_waitcnt lgkmcnt(2)
  v_mfma_f32_32x32x16_f16 v[100:115], v[28:31], v[36:39], v[100:115]
  ds_read_b128 v[28:31], v3 offset:5120
  v_pk_fma_f16 v41, v45, v49, v41
  v_add_u32 v47, v48, v43
  v_pk_fma_f16 v42, v46, v49, v42
  v_pk_fma_f16 v43, v47, v49, v43
  v_cvt_pknorm_u16_f32 v36, v84, v85
  v_cvt_pknorm_u16_f32 v37, v86, v87
  s_waitcnt lgkmcnt(2)
  v_mfma_f32_32x32x16_f16 v[100:115], v[32:35], v[40:43], v[100:115]
  ds_read_b128 v[32:35], v3 offset:5632
  v_add_u32 v44, v48, v36
  v_cvt_pknorm_u16_f32 v38, v88, v89
  v_add_u32 v45, v48, v37
  v_pk_fma_f16 v36, v44, v49, v36
  v_cvt_pknorm_u16_f32 v39, v90, v91
  v_add_u32 v46, v48, v38
  s_waitcnt lgkmcnt(2)
  v_mfma_f32_32x32x16_bf16 v[68:83], v[24:27], v[16:19], v[52:67]
  ds_read_b128 v[24:27], v5 offset:31744
  v_pk_fma_f16 v37, v45, v49, v37
  v_cvt_pknorm_u16_f32 v40, v92, v93
  v_add_u32 v47, v48, v39
  v_pk_fma_f16 v38, v46, v49, v38
  v_cvt_pknorm_u16_f32 v41, v94, v95
  v_add_u32 v44, v48, v40
  s_waitcnt vmcnt(7)
  v_mfma_f32_32x32x16_bf16 v[164:179], v[196:199], v[208:211], v[164:179]
  buffer_load_dwordx4 v[196:199], v5, s[8:11], s24 offen offset:2048 sc1
  v_pk_fma_f16 v39, v47, v49, v39
  v_cvt_pknorm_u16_f32 v42, v96, v97
  v_add_u32 v45, v48, v41
  v_pk_fma_f16 v40, v44, v49, v40
  v_cvt_pknorm_u16_f32 v43, v98, v99
  v_add_u32 v46, v48, v42
  s_waitcnt lgkmcnt(2)
  v_mfma_f32_32x32x16_f16 v[100:115], v[28:31], v[36:39], v[100:115]
  ds_read_b128 v[28:31], v3 offset:6144
  v_pk_fma_f16 v41, v45, v49, v41
  v_add_u32 v47, v48, v43
  v_pk_fma_f16 v42, v46, v49, v42
  v_pk_fma_f16 v43, v47, v49, v43
  s_barrier
  v_cvt_pknorm_u16_f32 v36, v68, v69
  v_cvt_pknorm_u16_f32 v37, v70, v71
  s_waitcnt lgkmcnt(2)
  v_mfma_f32_32x32x16_f16 v[100:115], v[32:35], v[40:43], v[100:115]
  ds_read_b128 v[32:35], v3 offset:6656
  s_waitcnt vmcnt(7)
  v_mfma_f32_32x32x16_bf16 v[148:163], v[200:203], v[204:207], v[148:163]
  buffer_load_dwordx4 v[204:207], v5, s[8:11], s26 offen offset:2048 sc1
  v_add_u32 v44, v48, v36
  v_cvt_pknorm_u16_f32 v38, v72, v73
  v_add_u32 v45, v48, v37
  v_pk_fma_f16 v36, v44, v49, v36
  v_cvt_pknorm_u16_f32 v39, v74, v75
  v_add_u32 v46, v48, v38
  s_waitcnt lgkmcnt(2)
  v_mfma_f32_32x32x16_bf16 v[84:99], v[24:27], v[16:19], v[52:67]
  ds_read_b128 v[24:27], v5 offset:32768
  v_pk_fma_f16 v37, v45, v49, v37
  v_cvt_pknorm_u16_f32 v40, v76, v77
  v_add_u32 v47, v48, v39
  v_pk_fma_f16 v38, v46, v49, v38
  v_cvt_pknorm_u16_f32 v41, v78, v79
  v_add_u32 v44, v48, v40
  v_mfma_f32_32x32x16_bf16 v[180:195], v[200:203], v[208:211], v[180:195]
  buffer_load_dwordx4 v[208:211], v5, s[8:11], s27 offen offset:2048 sc1
  buffer_load_dwordx4 v[200:203], v5, s[8:11], s25 offen offset:2048 sc1
  v_pk_fma_f16 v39, v47, v49, v39
  v_cvt_pknorm_u16_f32 v42, v80, v81
  v_add_u32 v45, v48, v41
  v_pk_fma_f16 v40, v44, v49, v40
  v_cvt_pknorm_u16_f32 v43, v82, v83
  v_add_u32 v46, v48, v42
  s_waitcnt lgkmcnt(2)
  v_mfma_f32_32x32x16_f16 v[100:115], v[28:31], v[36:39], v[100:115]
  ds_read_b128 v[28:31], v3 offset:7168
  v_pk_fma_f16 v41, v45, v49, v41
  v_add_u32 v47, v48, v43
  v_pk_fma_f16 v42, v46, v49, v42
  v_pk_fma_f16 v43, v47, v49, v43
  v_cvt_pknorm_u16_f32 v36, v84, v85
  v_cvt_pknorm_u16_f32 v37, v86, v87
  s_waitcnt lgkmcnt(2)
  v_mfma_f32_32x32x16_f16 v[100:115], v[32:35], v[40:43], v[100:115]
  ds_read_b128 v[32:35], v3 offset:7680
  v_add_u32 v44, v48, v36
  v_cvt_pknorm_u16_f32 v38, v88, v89
  v_add_u32 v45, v48, v37
  buffer_load_dwordx4 v5, s[8:11], s32 offen sc1 lds
  v_pk_fma_f16 v36, v44, v49, v36
  v_cvt_pknorm_u16_f32 v39, v90, v91
  v_add_u32 v46, v48, v38
  s_waitcnt lgkmcnt(2)
  v_mfma_f32_32x32x16_bf16 v[68:83], v[24:27], v[16:19], v[52:67]
  ds_read_b128 v[24:27], v5 offset:33792
  v_pk_fma_f16 v37, v45, v49, v37
  v_cvt_pknorm_u16_f32 v40, v92, v93
  v_add_u32 v47, v48, v39
  v_pk_fma_f16 v38, v46, v49, v38
  v_cvt_pknorm_u16_f32 v41, v94, v95
  v_add_u32 v44, v48, v40
  s_waitcnt vmcnt(8)
  v_mfma_f32_32x32x16_bf16 v[132:147], v[212:215], v[220:223], v[132:147]
  v_pk_fma_f16 v39, v47, v49, v39
  v_cvt_pknorm_u16_f32 v42, v96, v97
  v_add_u32 v45, v48, v41
  v_pk_fma_f16 v40, v44, v49, v40
  v_cvt_pknorm_u16_f32 v43, v98, v99
  v_add_u32 v46, v48, v42
  s_waitcnt lgkmcnt(2)
  v_mfma_f32_32x32x16_f16 v[100:115], v[28:31], v[36:39], v[100:115]
  v_add_u32 v3, v4, v3
  ds_read_b128 v[28:31], v3 offset:0
  v_pk_fma_f16 v41, v45, v49, v41
  v_add_u32 v47, v48, v43
  v_pk_fma_f16 v42, v46, v49, v42
  v_pk_fma_f16 v43, v47, v49, v43
  v_cvt_pknorm_u16_f32 v36, v68, v69
  v_cvt_pknorm_u16_f32 v37, v70, v71
  s_waitcnt lgkmcnt(2)
  v_mfma_f32_32x32x16_f16 v[100:115], v[32:35], v[40:43], v[100:115]
  ds_read_b128 v[32:35], v3 offset:512
  v_add_u32 v44, v48, v36
  v_cvt_pknorm_u16_f32 v38, v72, v73
  v_add_u32 v45, v48, v37
  v_pk_fma_f16 v36, v44, v49, v36
  v_cvt_pknorm_u16_f32 v39, v74, v75
  v_add_u32 v46, v48, v38
  s_waitcnt lgkmcnt(2)
  v_mfma_f32_32x32x16_bf16 v[84:99], v[24:27], v[16:19], v[52:67]
  ds_read_b128 v[24:27], v5 offset:34816
  v_pk_fma_f16 v37, v45, v49, v37
  v_cvt_pknorm_u16_f32 v40, v76, v77
  v_add_u32 v47, v48, v39
  v_pk_fma_f16 v38, v46, v49, v38
  v_cvt_pknorm_u16_f32 v41, v78, v79
  v_add_u32 v44, v48, v40
  s_waitcnt vmcnt(7)
  v_mfma_f32_32x32x16_bf16 v[164:179], v[212:215], v[224:227], v[164:179]
  buffer_load_dwordx4 v[212:215], v5, s[8:11], s24 offen offset:3072 sc1
  v_pk_fma_f16 v39, v47, v49, v39
  v_cvt_pknorm_u16_f32 v42, v80, v81
  v_add_u32 v45, v48, v41
  v_pk_fma_f16 v40, v44, v49, v40
  v_cvt_pknorm_u16_f32 v43, v82, v83
  v_add_u32 v46, v48, v42
  s_waitcnt lgkmcnt(2)
  v_mfma_f32_32x32x16_f16 v[100:115], v[28:31], v[36:39], v[100:115]
  ds_read_b128 v[28:31], v3 offset:1024
  v_pk_fma_f16 v41, v45, v49, v41
  v_add_u32 v47, v48, v43
  v_pk_fma_f16 v42, v46, v49, v42
  v_pk_fma_f16 v43, v47, v49, v43
  v_cvt_pknorm_u16_f32 v36, v84, v85
  v_cvt_pknorm_u16_f32 v37, v86, v87
  s_waitcnt lgkmcnt(2)
  v_mfma_f32_32x32x16_f16 v[100:115], v[32:35], v[40:43], v[100:115]
  ds_read_b128 v[32:35], v3 offset:1536
  v_add_u32 v44, v48, v36
  v_cvt_pknorm_u16_f32 v38, v88, v89
  v_add_u32 v45, v48, v37
  v_pk_fma_f16 v36, v44, v49, v36
  v_cvt_pknorm_u16_f32 v39, v90, v91
  v_add_u32 v46, v48, v38
  s_waitcnt lgkmcnt(2)
  v_mfma_f32_32x32x16_bf16 v[68:83], v[24:27], v[16:19], v[52:67]
  ds_read_b128 v[24:27], v5 offset:35840
  v_pk_fma_f16 v37, v45, v49, v37
  v_cvt_pknorm_u16_f32 v40, v92, v93
  v_add_u32 v47, v48, v39
  v_pk_fma_f16 v38, v46, v49, v38
  v_cvt_pknorm_u16_f32 v41, v94, v95
  v_add_u32 v44, v48, v40
  s_waitcnt vmcnt(7)
  v_mfma_f32_32x32x16_bf16 v[148:163], v[216:219], v[220:223], v[148:163]
  buffer_load_dwordx4 v[220:223], v5, s[8:11], s26 offen offset:3072 sc1
  v_pk_fma_f16 v39, v47, v49, v39
  v_cvt_pknorm_u16_f32 v42, v96, v97
  v_add_u32 v45, v48, v41
  v_pk_fma_f16 v40, v44, v49, v40
  v_cvt_pknorm_u16_f32 v43, v98, v99
  v_add_u32 v46, v48, v42
  s_waitcnt lgkmcnt(2)
  v_mfma_f32_32x32x16_f16 v[100:115], v[28:31], v[36:39], v[100:115]
  ds_read_b128 v[28:31], v3 offset:2048
  v_pk_fma_f16 v41, v45, v49, v41
  v_add_u32 v47, v48, v43
  v_pk_fma_f16 v42, v46, v49, v42
  v_pk_fma_f16 v43, v47, v49, v43
  v_cvt_pknorm_u16_f32 v36, v68, v69
  v_cvt_pknorm_u16_f32 v37, v70, v71
  s_waitcnt lgkmcnt(2)
  v_mfma_f32_32x32x16_f16 v[100:115], v[32:35], v[40:43], v[100:115]
  ds_read_b128 v[32:35], v3 offset:2560
  v_mfma_f32_32x32x16_bf16 v[180:195], v[216:219], v[224:227], v[180:195]
  buffer_load_dwordx4 v[224:227], v5, s[8:11], s27 offen offset:3072 sc1
  buffer_load_dwordx4 v[216:219], v5, s[8:11], s25 offen offset:3072 sc1
  v_add_u32 v44, v48, v36
  v_cvt_pknorm_u16_f32 v38, v72, v73
  v_add_u32 v45, v48, v37
  v_pk_fma_f16 v36, v44, v49, v36
  v_cvt_pknorm_u16_f32 v39, v74, v75
  v_add_u32 v46, v48, v38
  s_waitcnt lgkmcnt(2)
  v_mfma_f32_32x32x16_bf16 v[84:99], v[24:27], v[16:19], v[52:67]
  ds_read_b128 v[24:27], v5 offset:36864
  v_pk_fma_f16 v37, v45, v49, v37
  v_cvt_pknorm_u16_f32 v40, v76, v77
  v_add_u32 v47, v48, v39
  v_pk_fma_f16 v38, v46, v49, v38
  v_cvt_pknorm_u16_f32 v41, v78, v79
  v_add_u32 v44, v48, v40
  s_waitcnt vmcnt(7)
  v_mfma_f32_32x32x16_bf16 v[132:147], v[196:199], v[204:207], v[132:147]
  v_pk_fma_f16 v39, v47, v49, v39
  v_cvt_pknorm_u16_f32 v42, v80, v81
  v_add_u32 v45, v48, v41
  v_pk_fma_f16 v40, v44, v49, v40
  v_cvt_pknorm_u16_f32 v43, v82, v83
  v_add_u32 v46, v48, v42
  s_waitcnt lgkmcnt(2)
  v_mfma_f32_32x32x16_f16 v[100:115], v[28:31], v[36:39], v[100:115]
  ds_read_b128 v[28:31], v3 offset:3072
  v_pk_fma_f16 v41, v45, v49, v41
  v_add_u32 v47, v48, v43
  v_pk_fma_f16 v42, v46, v49, v42
  v_pk_fma_f16 v43, v47, v49, v43
  v_cvt_pknorm_u16_f32 v36, v84, v85
  v_cvt_pknorm_u16_f32 v37, v86, v87
  s_waitcnt lgkmcnt(2)
  v_mfma_f32_32x32x16_f16 v[100:115], v[32:35], v[40:43], v[100:115]
  ds_read_b128 v[32:35], v3 offset:3584
  v_add_u32 v44, v48, v36
  v_cvt_pknorm_u16_f32 v38, v88, v89
  v_add_u32 v45, v48, v37
  v_pk_fma_f16 v36, v44, v49, v36
  v_cvt_pknorm_u16_f32 v39, v90, v91
  v_add_u32 v46, v48, v38
  s_waitcnt lgkmcnt(2)
  v_mfma_f32_32x32x16_bf16 v[68:83], v[24:27], v[16:19], v[52:67]
  ds_read_b128 v[24:27], v5 offset:37888
  v_pk_fma_f16 v37, v45, v49, v37
  v_cvt_pknorm_u16_f32 v40, v92, v93
  v_add_u32 v47, v48, v39
  v_pk_fma_f16 v38, v46, v49, v38
  v_cvt_pknorm_u16_f32 v41, v94, v95
  v_add_u32 v44, v48, v40
  s_waitcnt vmcnt(6)
  v_mfma_f32_32x32x16_bf16 v[164:179], v[196:199], v[208:211], v[164:179]
  s_add_u32 s24, s24, 4096
  buffer_load_dwordx4 v[196:199], v5, s[8:11], s24 offen offset:0 sc1
  v_pk_fma_f16 v39, v47, v49, v39
  v_cvt_pknorm_u16_f32 v42, v96, v97
  v_add_u32 v45, v48, v41
  v_pk_fma_f16 v40, v44, v49, v40
  v_cvt_pknorm_u16_f32 v43, v98, v99
  v_add_u32 v46, v48, v42
  s_waitcnt lgkmcnt(2)
  v_mfma_f32_32x32x16_f16 v[100:115], v[28:31], v[36:39], v[100:115]
  ds_read_b128 v[28:31], v3 offset:4096
  v_pk_fma_f16 v41, v45, v49, v41
  v_add_u32 v47, v48, v43
  v_pk_fma_f16 v42, v46, v49, v42
  v_pk_fma_f16 v43, v47, v49, v43
  v_cvt_pknorm_u16_f32 v36, v68, v69
  v_cvt_pknorm_u16_f32 v37, v70, v71
  s_waitcnt lgkmcnt(2)
  v_mfma_f32_32x32x16_f16 v[100:115], v[32:35], v[40:43], v[100:115]
  ds_read_b128 v[32:35], v3 offset:4608
  v_add_u32 v44, v48, v36
  v_cvt_pknorm_u16_f32 v38, v72, v73
  v_add_u32 v45, v48, v37
  v_pk_fma_f16 v36, v44, v49, v36
  v_cvt_pknorm_u16_f32 v39, v74, v75
  v_add_u32 v46, v48, v38
  s_waitcnt lgkmcnt(2)
  v_mfma_f32_32x32x16_bf16 v[84:99], v[24:27], v[16:19], v[52:67]
  ds_read_b128 v[24:27], v5 offset:38912
  v_pk_fma_f16 v37, v45, v49, v37
  v_cvt_pknorm_u16_f32 v40, v76, v77
  v_add_u32 v47, v48, v39
  v_pk_fma_f16 v38, v46, v49, v38
  v_cvt_pknorm_u16_f32 v41, v78, v79
  v_add_u32 v44, v48, v40
  s_waitcnt vmcnt(6)
  v_mfma_f32_32x32x16_bf16 v[148:163], v[200:203], v[204:207], v[148:163]
  s_add_u32 s26, s26, 4096
  buffer_load_dwordx4 v[204:207], v5, s[8:11], s26 offen offset:0 sc1
  v_pk_fma_f16 v39, v47, v49, v39
  v_cvt_pknorm_u16_f32 v42, v80, v81
  v_add_u32 v45, v48, v41
  v_pk_fma_f16 v40, v44, v49, v40
  v_cvt_pknorm_u16_f32 v43, v82, v83
  v_add_u32 v46, v48, v42
  s_waitcnt lgkmcnt(2)
  v_mfma_f32_32x32x16_f16 v[100:115], v[28:31], v[36:39], v[100:115]
  ds_read_b128 v[28:31], v3 offset:5120
  v_pk_fma_f16 v41, v45, v49, v41
  v_add_u32 v47, v48, v43
  v_pk_fma_f16 v42, v46, v49, v42
  v_pk_fma_f16 v43, v47, v49, v43
  v_cvt_pknorm_u16_f32 v36, v84, v85
  v_cvt_pknorm_u16_f32 v37, v86, v87
  s_waitcnt lgkmcnt(2)
  v_mfma_f32_32x32x16_f16 v[100:115], v[32:35], v[40:43], v[100:115]
  ds_read_b128 v[32:35], v3 offset:5632
  v_add_u32 v44, v48, v36
  v_cvt_pknorm_u16_f32 v38, v88, v89
  v_add_u32 v45, v48, v37
  v_pk_fma_f16 v36, v44, v49, v36
  v_cvt_pknorm_u16_f32 v39, v90, v91
  v_add_u32 v46, v48, v38
  s_waitcnt lgkmcnt(2)
  v_mfma_f32_32x32x16_bf16 v[68:83], v[24:27], v[16:19], v[52:67]
  ds_read_b128 v[24:27], v5 offset:39936
  v_pk_fma_f16 v37, v45, v49, v37
  v_cvt_pknorm_u16_f32 v40, v92, v93
  v_add_u32 v47, v48, v39
  v_pk_fma_f16 v38, v46, v49, v38
  v_cvt_pknorm_u16_f32 v41, v94, v95
  v_add_u32 v44, v48, v40
  v_mfma_f32_32x32x16_bf16 v[180:195], v[200:203], v[208:211], v[180:195]
  s_add_u32 s27, s27, 4096
  buffer_load_dwordx4 v[208:211], v5, s[8:11], s27 offen offset:0 sc1
  s_add_u32 s25, s25, 4096
  buffer_load_dwordx4 v[200:203], v5, s[8:11], s25 offen offset:0 sc1
  v_pk_fma_f16 v39, v47, v49, v39
  v_cvt_pknorm_u16_f32 v42, v96, v97
  v_add_u32 v45, v48, v41
  v_pk_fma_f16 v40, v44, v49, v40
  v_cvt_pknorm_u16_f32 v43, v98, v99
  v_add_u32 v46, v48, v42
  s_waitcnt lgkmcnt(2)
  v_mfma_f32_32x32x16_f16 v[100:115], v[28:31], v[36:39], v[100:115]
  ds_read_b128 v[28:31], v3 offset:6144
  v_pk_fma_f16 v41, v45, v49, v41
  v_add_u32 v47, v48, v43
  v_pk_fma_f16 v42, v46, v49, v42
  v_pk_fma_f16 v43, v47, v49, v43
  v_cvt_pknorm_u16_f32 v36, v68, v69
  v_cvt_pknorm_u16_f32 v37, v70, v71
  s_waitcnt lgkmcnt(2)
  v_mfma_f32_32x32x16_f16 v[100:115], v[32:35], v[40:43], v[100:115]
  ds_read_b128 v[32:35], v3 offset:6656
  s_waitcnt vmcnt(6)
  v_mfma_f32_32x32x16_bf16 v[132:147], v[212:215], v[220:223], v[132:147]
  v_add_u32 v44, v48, v36
  v_cvt_pknorm_u16_f32 v38, v72, v73
  v_add_u32 v45, v48, v37
  v_pk_fma_f16 v36, v44, v49, v36
  v_cvt_pknorm_u16_f32 v39, v74, v75
  v_add_u32 v46, v48, v38
  s_waitcnt lgkmcnt(2)
  v_mfma_f32_32x32x16_bf16 v[84:99], v[24:27], v[16:19], v[52:67]
  ds_read_b128 v[24:27], v5 offset:40960
  v_pk_fma_f16 v37, v45, v49, v37
  v_cvt_pknorm_u16_f32 v40, v76, v77
  v_add_u32 v47, v48, v39
  v_pk_fma_f16 v38, v46, v49, v38
  v_cvt_pknorm_u16_f32 v41, v78, v79
  v_add_u32 v44, v48, v40
  s_waitcnt vmcnt(5)
  v_mfma_f32_32x32x16_bf16 v[164:179], v[212:215], v[224:227], v[164:179]
  buffer_load_dwordx4 v[212:215], v5, s[8:11], s24 offen offset:1024 sc1
  v_pk_fma_f16 v39, v47, v49, v39
  v_cvt_pknorm_u16_f32 v42, v80, v81
  v_add_u32 v45, v48, v41
  v_pk_fma_f16 v40, v44, v49, v40
  v_cvt_pknorm_u16_f32 v43, v82, v83
  v_add_u32 v46, v48, v42
  s_waitcnt lgkmcnt(2)
  v_mfma_f32_32x32x16_f16 v[100:115], v[28:31], v[36:39], v[100:115]
  ds_read_b128 v[28:31], v3 offset:7168
  v_pk_fma_f16 v41, v45, v49, v41
  v_add_u32 v47, v48, v43
  v_pk_fma_f16 v42, v46, v49, v42
  v_pk_fma_f16 v43, v47, v49, v43
  v_cvt_pknorm_u16_f32 v36, v84, v85
  v_cvt_pknorm_u16_f32 v37, v86, v87
  s_waitcnt lgkmcnt(2)
  v_mfma_f32_32x32x16_f16 v[100:115], v[32:35], v[40:43], v[100:115]
  ds_read_b128 v[32:35], v3 offset:7680
  v_add_u32 v44, v48, v36
  v_cvt_pknorm_u16_f32 v38, v88, v89
  v_add_u32 v45, v48, v37
  v_pk_fma_f16 v36, v44, v49, v36
  v_cvt_pknorm_u16_f32 v39, v90, v91
  v_add_u32 v46, v48, v38
  s_waitcnt lgkmcnt(2)
  v_mfma_f32_32x32x16_bf16 v[68:83], v[24:27], v[16:19], v[52:67]
  ds_read_b128 v[24:27], v5 offset:41984
  v_pk_fma_f16 v37, v45, v49, v37
  v_cvt_pknorm_u16_f32 v40, v92, v93
  v_add_u32 v47, v48, v39
  v_pk_fma_f16 v38, v46, v49, v38
  v_cvt_pknorm_u16_f32 v41, v94, v95
  v_add_u32 v44, v48, v40
  s_waitcnt vmcnt(5)
  v_mfma_f32_32x32x16_bf16 v[148:163], v[216:219], v[220:223], v[148:163]
  buffer_load_dwordx4 v[220:223], v5, s[8:11], s26 offen offset:1024 sc1
  v_pk_fma_f16 v39, v47, v49, v39
  v_cvt_pknorm_u16_f32 v42, v96, v97
  v_add_u32 v45, v48, v41
  v_pk_fma_f16 v40, v44, v49, v40
  v_cvt_pknorm_u16_f32 v43, v98, v99
  v_add_u32 v46, v48, v42
  s_waitcnt lgkmcnt(2)
  v_mfma_f32_32x32x16_f16 v[100:115], v[28:31], v[36:39], v[100:115]
  v_add_u32 v3, v4, v3
  ds_read_b128 v[28:31], v3 offset:0
  v_pk_fma_f16 v41, v45, v49, v41
  v_add_u32 v47, v48, v43
  v_pk_fma_f16 v42, v46, v49, v42
  v_pk_fma_f16 v43, v47, v49, v43
  v_cvt_pknorm_u16_f32 v36, v68, v69
  v_cvt_pknorm_u16_f32 v37, v70, v71
  s_waitcnt lgkmcnt(2)
  v_mfma_f32_32x32x16_f16 v[100:115], v[32:35], v[40:43], v[100:115]
  ds_read_b128 v[32:35], v3 offset:512
  v_add_u32 v44, v48, v36
  v_cvt_pknorm_u16_f32 v38, v72, v73
  v_add_u32 v45, v48, v37
  v_pk_fma_f16 v36, v44, v49, v36
  v_cvt_pknorm_u16_f32 v39, v74, v75
  v_add_u32 v46, v48, v38
  s_waitcnt lgkmcnt(2)
  v_mfma_f32_32x32x16_bf16 v[84:99], v[24:27], v[16:19], v[52:67]
  ds_read_b128 v[24:27], v5 offset:43008
  v_pk_fma_f16 v37, v45, v49, v37
  v_cvt_pknorm_u16_f32 v40, v76, v77
  v_add_u32 v47, v48, v39
  v_pk_fma_f16 v38, v46, v49, v38
  v_cvt_pknorm_u16_f32 v41, v78, v79
  v_add_u32 v44, v48, v40
  v_mfma_f32_32x32x16_bf16 v[180:195], v[216:219], v[224:227], v[180:195]
  buffer_load_dwordx4 v[224:227], v5, s[8:11], s27 offen offset:1024 sc1
  buffer_load_dwordx4 v[216:219], v5, s[8:11], s25 offen offset:1024 sc1
  v_pk_fma_f16 v39, v47, v49, v39
  v_cvt_pknorm_u16_f32 v42, v80, v81
  v_add_u32 v45, v48, v41
  v_pk_fma_f16 v40, v44, v49, v40
  v_cvt_pknorm_u16_f32 v43, v82, v83
  v_add_u32 v46, v48, v42
  s_waitcnt lgkmcnt(2)
  v_mfma_f32_32x32x16_f16 v[100:115], v[28:31], v[36:39], v[100:115]
  ds_read_b128 v[28:31], v3 offset:1024
  v_pk_fma_f16 v41, v45, v49, v41
  v_add_u32 v47, v48, v43
  v_pk_fma_f16 v42, v46, v49, v42
  v_pk_fma_f16 v43, v47, v49, v43
  v_cvt_pknorm_u16_f32 v36, v84, v85
  v_cvt_pknorm_u16_f32 v37, v86, v87
  s_waitcnt lgkmcnt(2)
  v_mfma_f32_32x32x16_f16 v[100:115], v[32:35], v[40:43], v[100:115]
  ds_read_b128 v[32:35], v3 offset:1536
  s_waitcnt vmcnt(6)
  v_mfma_f32_32x32x16_bf16 v[132:147], v[196:199], v[204:207], v[132:147]
  v_add_u32 v44, v48, v36
  v_cvt_pknorm_u16_f32 v38, v88, v89
  v_add_u32 v45, v48, v37
  v_pk_fma_f16 v36, v44, v49, v36
  v_cvt_pknorm_u16_f32 v39, v90, v91
  v_add_u32 v46, v48, v38
  s_waitcnt lgkmcnt(2)
  v_mfma_f32_32x32x16_bf16 v[68:83], v[24:27], v[16:19], v[52:67]
  ds_read_b128 v[24:27], v5 offset:44032
  v_pk_fma_f16 v37, v45, v49, v37
  v_cvt_pknorm_u16_f32 v40, v92, v93
  v_add_u32 v47, v48, v39
  v_pk_fma_f16 v38, v46, v49, v38
  v_cvt_pknorm_u16_f32 v41, v94, v95
  v_add_u32 v44, v48, v40
  s_waitcnt vmcnt(5)
  v_mfma_f32_32x32x16_bf16 v[164:179], v[196:199], v[208:211], v[164:179]
  buffer_load_dwordx4 v[196:199], v5, s[8:11], s24 offen offset:2048 sc1
  v_pk_fma_f16 v39, v47, v49, v39
  v_cvt_pknorm_u16_f32 v42, v96, v97
  v_add_u32 v45, v48, v41
  v_pk_fma_f16 v40, v44, v49, v40
  v_cvt_pknorm_u16_f32 v43, v98, v99
  v_add_u32 v46, v48, v42
  s_waitcnt lgkmcnt(2)
  v_mfma_f32_32x32x16_f16 v[100:115], v[28:31], v[36:39], v[100:115]
  ds_read_b128 v[28:31], v3 offset:2048
  v_pk_fma_f16 v41, v45, v49, v41
  v_add_u32 v47, v48, v43
  v_pk_fma_f16 v42, v46, v49, v42
  v_pk_fma_f16 v43, v47, v49, v43
  v_cvt_pknorm_u16_f32 v36, v68, v69
  v_cvt_pknorm_u16_f32 v37, v70, v71
  s_waitcnt lgkmcnt(2)
  v_mfma_f32_32x32x16_f16 v[100:115], v[32:35], v[40:43], v[100:115]
  ds_read_b128 v[32:35], v3 offset:2560
  v_add_u32 v44, v48, v36
  v_cvt_pknorm_u16_f32 v38, v72, v73
  v_add_u32 v45, v48, v37
  v_pk_fma_f16 v36, v44, v49, v36
  v_cvt_pknorm_u16_f32 v39, v74, v75
  v_add_u32 v46, v48, v38
  s_waitcnt lgkmcnt(2)
  v_mfma_f32_32x32x16_bf16 v[84:99], v[24:27], v[16:19], v[52:67]
  ds_read_b128 v[24:27], v5 offset:45056
  v_pk_fma_f16 v37, v45, v49, v37
  v_cvt_pknorm_u16_f32 v40, v76, v77
  v_add_u32 v47, v48, v39
  v_pk_fma_f16 v38, v46, v49, v38
  v_cvt_pknorm_u16_f32 v41, v78, v79
  v_add_u32 v44, v48, v40
  s_waitcnt vmcnt(5)
  v_mfma_f32_32x32x16_bf16 v[148:163], v[200:203], v[204:207], v[148:163]
  buffer_load_dwordx4 v[204:207], v5, s[8:11], s26 offen offset:2048 sc1
  v_pk_fma_f16 v39, v47, v49, v39
  v_cvt_pknorm_u16_f32 v42, v80, v81
  v_add_u32 v45, v48, v41
  v_pk_fma_f16 v40, v44, v49, v40
  v_cvt_pknorm_u16_f32 v43, v82, v83
  v_add_u32 v46, v48, v42
  s_waitcnt lgkmcnt(2)
  v_mfma_f32_32x32x16_f16 v[100:115], v[28:31], v[36:39], v[100:115]
  ds_read_b128 v[28:31], v3 offset:3072
  v_pk_fma_f16 v41, v45, v49, v41
  v_add_u32 v47, v48, v43
  v_pk_fma_f16 v42, v46, v49, v42
  v_pk_fma_f16 v43, v47, v49, v43
  v_cvt_pknorm_u16_f32 v36, v84, v85
  v_cvt_pknorm_u16_f32 v37, v86, v87
  s_waitcnt lgkmcnt(2)
  v_mfma_f32_32x32x16_f16 v[100:115], v[32:35], v[40:43], v[100:115]
  ds_read_b128 v[32:35], v3 offset:3584
  v_add_u32 v44, v48, v36
  v_cvt_pknorm_u16_f32 v38, v88, v89
  v_add_u32 v45, v48, v37
  v_pk_fma_f16 v36, v44, v49, v36
  v_cvt_pknorm_u16_f32 v39, v90, v91
  v_add_u32 v46, v48, v38
  s_waitcnt lgkmcnt(2)
  v_mfma_f32_32x32x16_bf16 v[68:83], v[24:27], v[16:19], v[52:67]
  ds_read_b128 v[24:27], v5 offset:46080
  v_pk_fma_f16 v37, v45, v49, v37
  v_cvt_pknorm_u16_f32 v40, v92, v93
  v_add_u32 v47, v48, v39
  v_pk_fma_f16 v38, v46, v49, v38
  v_cvt_pknorm_u16_f32 v41, v94, v95
  v_add_u32 v44, v48, v40
  v_mfma_f32_32x32x16_bf16 v[180:195], v[200:203], v[208:211], v[180:195]
  buffer_load_dwordx4 v[208:211], v5, s[8:11], s27 offen offset:2048 sc1
  buffer_load_dwordx4 v[200:203], v5, s[8:11], s25 offen offset:2048 sc1
  v_pk_fma_f16 v39, v47, v49, v39
  v_cvt_pknorm_u16_f32 v42, v96, v97
  v_add_u32 v45, v48, v41
  v_pk_fma_f16 v40, v44, v49, v40
  v_cvt_pknorm_u16_f32 v43, v98, v99
  v_add_u32 v46, v48, v42
  s_waitcnt lgkmcnt(2)
  v_mfma_f32_32x32x16_f16 v[100:115], v[28:31], v[36:39], v[100:115]
  ds_read_b128 v[28:31], v3 offset:4096
  v_pk_fma_f16 v41, v45, v49, v41
  v_add_u32 v47, v48, v43
  v_pk_fma_f16 v42, v46, v49, v42
  v_pk_fma_f16 v43, v47, v49, v43
  v_cvt_pknorm_u16_f32 v36, v68, v69
  v_cvt_pknorm_u16_f32 v37, v70, v71
  s_waitcnt lgkmcnt(2)
  v_mfma_f32_32x32x16_f16 v[100:115], v[32:35], v[40:43], v[100:115]
  ds_read_b128 v[32:35], v3 offset:4608
  v_add_u32 v44, v48, v36
  v_cvt_pknorm_u16_f32 v38, v72, v73
  v_add_u32 v45, v48, v37
  v_pk_fma_f16 v36, v44, v49, v36
  v_cvt_pknorm_u16_f32 v39, v74, v75
  v_add_u32 v46, v48, v38
  s_waitcnt lgkmcnt(2)
  v_mfma_f32_32x32x16_bf16 v[84:99], v[24:27], v[16:19], v[52:67]
  ds_read_b128 v[24:27], v5 offset:47104
  v_pk_fma_f16 v37, v45, v49, v37
  v_cvt_pknorm_u16_f32 v40, v76, v77
  v_add_u32 v47, v48, v39
  v_pk_fma_f16 v38, v46, v49, v38
  v_cvt_pknorm_u16_f32 v41, v78, v79
  v_add_u32 v44, v48, v40
  s_waitcnt vmcnt(6)
  v_mfma_f32_32x32x16_bf16 v[132:147], v[212:215], v[220:223], v[132:147]
  v_pk_fma_f16 v39, v47, v49, v39
  v_cvt_pknorm_u16_f32 v42, v80, v81
  v_add_u32 v45, v48, v41
  v_pk_fma_f16 v40, v44, v49, v40
  v_cvt_pknorm_u16_f32 v43, v82, v83
  v_add_u32 v46, v48, v42
  s_waitcnt lgkmcnt(2)
  v_mfma_f32_32x32x16_f16 v[100:115], v[28:31], v[36:39], v[100:115]
  ds_read_b128 v[28:31], v3 offset:5120
  v_pk_fma_f16 v41, v45, v49, v41
  v_add_u32 v47, v48, v43
  v_pk_fma_f16 v42, v46, v49, v42
  v_pk_fma_f16 v43, v47, v49, v43
  v_cvt_pknorm_u16_f32 v36, v84, v85
  v_cvt_pknorm_u16_f32 v37, v86, v87
  s_waitcnt lgkmcnt(2)
  v_mfma_f32_32x32x16_f16 v[100:115], v[32:35], v[40:43], v[100:115]
  ds_read_b128 v[32:35], v3 offset:5632
  s_waitcnt vmcnt(5)
  v_mfma_f32_32x32x16_bf16 v[164:179], v[212:215], v[224:227], v[164:179]
  buffer_load_dwordx4 v[212:215], v5, s[8:11], s24 offen offset:3072 sc1
  v_add_u32 v44, v48, v36
  v_cvt_pknorm_u16_f32 v38, v88, v89
  v_add_u32 v45, v48, v37
  v_pk_fma_f16 v36, v44, v49, v36
  v_cvt_pknorm_u16_f32 v39, v90, v91
  v_add_u32 v46, v48, v38
  s_waitcnt lgkmcnt(2)
  v_mfma_f32_32x32x16_bf16 v[68:83], v[24:27], v[16:19], v[52:67]
  ds_read_b128 v[24:27], v5 offset:48128
  v_pk_fma_f16 v37, v45, v49, v37
  v_cvt_pknorm_u16_f32 v40, v92, v93
  v_add_u32 v47, v48, v39
  v_pk_fma_f16 v38, v46, v49, v38
  v_cvt_pknorm_u16_f32 v41, v94, v95
  v_add_u32 v44, v48, v40
  s_waitcnt vmcnt(5)
  v_mfma_f32_32x32x16_bf16 v[148:163], v[216:219], v[220:223], v[148:163]
  buffer_load_dwordx4 v[220:223], v5, s[8:11], s26 offen offset:3072 sc1
  v_pk_fma_f16 v39, v47, v49, v39
  v_cvt_pknorm_u16_f32 v42, v96, v97
  v_add_u32 v45, v48, v41
  v_pk_fma_f16 v40, v44, v49, v40
  v_cvt_pknorm_u16_f32 v43, v98, v99
  v_add_u32 v46, v48, v42
  s_waitcnt lgkmcnt(2)
  v_mfma_f32_32x32x16_f16 v[100:115], v[28:31], v[36:39], v[100:115]
  ds_read_b128 v[28:31], v3 offset:6144
  v_pk_fma_f16 v41, v45, v49, v41
  v_add_u32 v47, v48, v43
  v_pk_fma_f16 v42, v46, v49, v42
  v_pk_fma_f16 v43, v47, v49, v43
  s_barrier
  v_cvt_pknorm_u16_f32 v36, v68, v69
  v_cvt_pknorm_u16_f32 v37, v70, v71
  s_waitcnt lgkmcnt(2)
  v_mfma_f32_32x32x16_f16 v[100:115], v[32:35], v[40:43], v[100:115]
  ds_read_b128 v[32:35], v3 offset:6656
  v_add_u32 v44, v48, v36
  v_cvt_pknorm_u16_f32 v38, v72, v73
  v_add_u32 v45, v48, v37
  v_pk_fma_f16 v36, v44, v49, v36
  v_cvt_pknorm_u16_f32 v39, v74, v75
  v_add_u32 v46, v48, v38
  s_waitcnt lgkmcnt(2)
  v_mfma_f32_32x32x16_bf16 v[84:99], v[24:27], v[16:19], v[52:67]
  ds_read_b128 v[24:27], v5 offset:49152
  v_pk_fma_f16 v37, v45, v49, v37
  v_cvt_pknorm_u16_f32 v40, v76, v77
  v_add_u32 v47, v48, v39
  v_pk_fma_f16 v38, v46, v49, v38
  v_cvt_pknorm_u16_f32 v41, v78, v79
  v_add_u32 v44, v48, v40
  v_mfma_f32_32x32x16_bf16 v[180:195], v[216:219], v[224:227], v[180:195]
  buffer_load_dwordx4 v[224:227], v5, s[8:11], s27 offen offset:3072 sc1
  buffer_load_dwordx4 v[216:219], v5, s[8:11], s25 offen offset:3072 sc1
  v_pk_fma_f16 v39, v47, v49, v39
  v_cvt_pknorm_u16_f32 v42, v80, v81
  v_add_u32 v45, v48, v41
  v_pk_fma_f16 v40, v44, v49, v40
  v_cvt_pknorm_u16_f32 v43, v82, v83
  v_add_u32 v46, v48, v42
  s_waitcnt lgkmcnt(2)
  v_mfma_f32_32x32x16_f16 v[100:115], v[28:31], v[36:39], v[100:115]
  ds_read_b128 v[28:31], v3 offset:7168
  v_pk_fma_f16 v41, v45, v49, v41
  v_add_u32 v47, v48, v43
  v_pk_fma_f16 v42, v46, v49, v42
  v_pk_fma_f16 v43, v47, v49, v43
  v_cvt_pknorm_u16_f32 v36, v84, v85
  v_cvt_pknorm_u16_f32 v37, v86, v87
  s_waitcnt lgkmcnt(2)
  v_mfma_f32_32x32x16_f16 v[100:115], v[32:35], v[40:43], v[100:115]
  ds_read_b128 v[32:35], v3 offset:7680
  v_add_u32 v44, v48, v36
  v_cvt_pknorm_u16_f32 v38, v88, v89
  v_add_u32 v45, v48, v37
  s_lshl_b32 s19, s29, 14
  s_lshl_b32 s20, s22, 16
  s_add_u32 s19, s19, s20
  s_lshl_b32 s20, s30, 13
  s_add_u32 m0, s19, s20
  s_nop 0
  buffer_load_dwordx4 v20, s[60:63], s38 offen lds
  s_add_u32 m0, m0, 1024
  s_add_u32 s38, s38, 8192
  v_pk_fma_f16 v36, v44, v49, v36
  v_cvt_pknorm_u16_f32 v39, v90, v91
  v_add_u32 v46, v48, v38
  s_waitcnt lgkmcnt(2)
  v_mfma_f32_32x32x16_bf16 v[68:83], v[24:27], v[16:19], v[52:67]
  ds_read_b128 v[24:27], v5 offset:50176
  v_pk_fma_f16 v37, v45, v49, v37
  v_cvt_pknorm_u16_f32 v40, v92, v93
  v_add_u32 v47, v48, v39
  v_pk_fma_f16 v38, v46, v49, v38
  v_cvt_pknorm_u16_f32 v41, v94, v95
  v_add_u32 v44, v48, v40
  s_waitcnt vmcnt(7)
  v_mfma_f32_32x32x16_bf16 v[132:147], v[196:199], v[204:207], v[132:147]
  v_pk_fma_f16 v39, v47, v49, v39
  v_cvt_pknorm_u16_f32 v42, v96, v97
  v_add_u32 v45, v48, v41
  v_pk_fma_f16 v40, v44, v49, v40
  v_cvt_pknorm_u16_f32 v43, v98, v99
  v_add_u32 v46, v48, v42
  s_waitcnt lgkmcnt(2)
  v_mfma_f32_32x32x16_f16 v[100:115], v[28:31], v[36:39], v[100:115]
  v_add_u32 v3, v4, v3
  ds_read_b128 v[28:31], v3 offset:0
  v_pk_fma_f16 v41, v45, v49, v41
  v_add_u32 v47, v48, v43
  v_pk_fma_f16 v42, v46, v49, v42
  v_pk_fma_f16 v43, v47, v49, v43
  v_cvt_pknorm_u16_f32 v36, v68, v69
  v_cvt_pknorm_u16_f32 v37, v70, v71
  s_waitcnt lgkmcnt(2)
  v_mfma_f32_32x32x16_f16 v[100:115], v[32:35], v[40:43], v[100:115]
  ds_read_b128 v[32:35], v3 offset:512
  v_add_u32 v44, v48, v36
  v_cvt_pknorm_u16_f32 v38, v72, v73
  v_add_u32 v45, v48, v37
  buffer_load_dwordx4 v20, s[60:63], s38 offen lds
  s_add_u32 m0, m0, 1024
  s_add_u32 s38, s38, 8192
  v_pk_fma_f16 v36, v44, v49, v36
  v_cvt_pknorm_u16_f32 v39, v74, v75
  v_add_u32 v46, v48, v38
  s_waitcnt lgkmcnt(2)
  v_mfma_f32_32x32x16_bf16 v[84:99], v[24:27], v[16:19], v[52:67]
  ds_read_b128 v[24:27], v5 offset:51200
  v_pk_fma_f16 v37, v45, v49, v37
  v_cvt_pknorm_u16_f32 v40, v76, v77
  v_add_u32 v47, v48, v39
  v_pk_fma_f16 v38, v46, v49, v38
  v_cvt_pknorm_u16_f32 v41, v78, v79
  v_add_u32 v44, v48, v40
  s_waitcnt vmcnt(7)
  v_mfma_f32_32x32x16_bf16 v[164:179], v[196:199], v[208:211], v[164:179]
  s_add_u32 s24, s24, 4096
  buffer_load_dwordx4 v[196:199], v5, s[8:11], s24 offen offset:0 sc1
  v_pk_fma_f16 v39, v47, v49, v39
  v_cvt_pknorm_u16_f32 v42, v80, v81
  v_add_u32 v45, v48, v41
  v_pk_fma_f16 v40, v44, v49, v40
  v_cvt_pknorm_u16_f32 v43, v82, v83
  v_add_u32 v46, v48, v42
  s_waitcnt lgkmcnt(2)
  v_mfma_f32_32x32x16_f16 v[100:115], v[28:31], v[36:39], v[100:115]
  ds_read_b128 v[28:31], v3 offset:1024
  v_pk_fma_f16 v41, v45, v49, v41
  v_add_u32 v47, v48, v43
  v_pk_fma_f16 v42, v46, v49, v42
  v_pk_fma_f16 v43, v47, v49, v43
  v_cvt_pknorm_u16_f32 v36, v84, v85
  v_cvt_pknorm_u16_f32 v37, v86, v87
  s_waitcnt lgkmcnt(2)
  v_mfma_f32_32x32x16_f16 v[100:115], v[32:35], v[40:43], v[100:115]
  ds_read_b128 v[32:35], v3 offset:1536
  s_waitcnt vmcnt(7)
  v_mfma_f32_32x32x16_bf16 v[148:163], v[200:203], v[204:207], v[148:163]
  s_add_u32 s26, s26, 4096
  buffer_load_dwordx4 v[204:207], v5, s[8:11], s26 offen offset:0 sc1
  v_add_u32 v44, v48, v36
  v_cvt_pknorm_u16_f32 v38, v88, v89
  v_add_u32 v45, v48, v37
  buffer_load_dwordx4 v20, s[60:63], s38 offen lds
  s_add_u32 m0, m0, 1024
  s_add_u32 s38, s38, 8192
  v_pk_fma_f16 v36, v44, v49, v36
  v_cvt_pknorm_u16_f32 v39, v90, v91
  v_add_u32 v46, v48, v38
  s_waitcnt lgkmcnt(2)
  v_mfma_f32_32x32x16_bf16 v[68:83], v[24:27], v[16:19], v[52:67]
  ds_read_b128 v[24:27], v5 offset:52224
  v_pk_fma_f16 v37, v45, v49, v37
  v_cvt_pknorm_u16_f32 v40, v92, v93
  v_add_u32 v47, v48, v39
  v_pk_fma_f16 v38, v46, v49, v38
  v_cvt_pknorm_u16_f32 v41, v94, v95
  v_add_u32 v44, v48, v40
  v_mfma_f32_32x32x16_bf16 v[180:195], v[200:203], v[208:211], v[180:195]
  s_add_u32 s27, s27, 4096
  buffer_load_dwordx4 v[208:211], v5, s[8:11], s27 offen offset:0 sc1
  s_add_u32 s25, s25, 4096
  buffer_load_dwordx4 v[200:203], v5, s[8:11], s25 offen offset:0 sc1
  v_pk_fma_f16 v39, v47, v49, v39
  v_cvt_pknorm_u16_f32 v42, v96, v97
  v_add_u32 v45, v48, v41
  v_pk_fma_f16 v40, v44, v49, v40
  v_cvt_pknorm_u16_f32 v43, v98, v99
  v_add_u32 v46, v48, v42
  s_waitcnt lgkmcnt(2)
  v_mfma_f32_32x32x16_f16 v[100:115], v[28:31], v[36:39], v[100:115]
  ds_read_b128 v[28:31], v3 offset:2048
  v_pk_fma_f16 v41, v45, v49, v41
  v_add_u32 v47, v48, v43
  v_pk_fma_f16 v42, v46, v49, v42
  v_pk_fma_f16 v43, v47, v49, v43
  v_cvt_pknorm_u16_f32 v36, v68, v69
  v_cvt_pknorm_u16_f32 v37, v70, v71
  s_waitcnt lgkmcnt(2)
  v_mfma_f32_32x32x16_f16 v[100:115], v[32:35], v[40:43], v[100:115]
  ds_read_b128 v[32:35], v3 offset:2560
  v_add_u32 v44, v48, v36
  v_cvt_pknorm_u16_f32 v38, v72, v73
  v_add_u32 v45, v48, v37
  buffer_load_dwordx4 v20, s[60:63], s38 offen lds
  s_add_u32 m0, m0, 1024
  s_add_u32 s38, s38, 8192
  v_pk_fma_f16 v36, v44, v49, v36
  v_cvt_pknorm_u16_f32 v39, v74, v75
  v_add_u32 v46, v48, v38
  s_waitcnt lgkmcnt(2)
  v_mfma_f32_32x32x16_bf16 v[84:99], v[24:27], v[16:19], v[52:67]
  ds_read_b128 v[24:27], v5 offset:53248
  v_pk_fma_f16 v37, v45, v49, v37
  v_cvt_pknorm_u16_f32 v40, v76, v77
  v_add_u32 v47, v48, v39
  v_pk_fma_f16 v38, v46, v49, v38
  v_cvt_pknorm_u16_f32 v41, v78, v79
  v_add_u32 v44, v48, v40
  s_waitcnt vmcnt(10)
  v_mfma_f32_32x32x16_bf16 v[132:147], v[212:215], v[220:223], v[132:147]
  v_pk_fma_f16 v39, v47, v49, v39
  v_cvt_pknorm_u16_f32 v42, v80, v81
  v_add_u32 v45, v48, v41
  v_pk_fma_f16 v40, v44, v49, v40
  v_cvt_pknorm_u16_f32 v43, v82, v83
  v_add_u32 v46, v48, v42
  s_waitcnt lgkmcnt(2)
  v_mfma_f32_32x32x16_f16 v[100:115], v[28:31], v[36:39], v[100:115]
  ds_read_b128 v[28:31], v3 offset:3072
  v_pk_fma_f16 v41, v45, v49, v41
  v_add_u32 v47, v48, v43
  v_pk_fma_f16 v42, v46, v49, v42
  v_pk_fma_f16 v43, v47, v49, v43
  v_cvt_pknorm_u16_f32 v36, v84, v85
  v_cvt_pknorm_u16_f32 v37, v86, v87
  s_waitcnt lgkmcnt(2)
  v_mfma_f32_32x32x16_f16 v[100:115], v[32:35], v[40:43], v[100:115]
  ds_read_b128 v[32:35], v3 offset:3584
  v_add_u32 v44, v48, v36
  v_cvt_pknorm_u16_f32 v38, v88, v89
  v_add_u32 v45, v48, v37
  buffer_load_dwordx4 v20, s[60:63], s38 offen lds
  s_add_u32 m0, m0, 1024
  s_add_u32 s38, s38, 8192
  v_pk_fma_f16 v36, v44, v49, v36
  v_cvt_pknorm_u16_f32 v39, v90, v91
  v_add_u32 v46, v48, v38
  s_waitcnt lgkmcnt(2)
  v_mfma_f32_32x32x16_bf16 v[68:83], v[24:27], v[16:19], v[52:67]
  ds_read_b128 v[24:27], v5 offset:54272
  v_pk_fma_f16 v37, v45, v49, v37
  v_cvt_pknorm_u16_f32 v40, v92, v93
  v_add_u32 v47, v48, v39
  v_pk_fma_f16 v38, v46, v49, v38
  v_cvt_pknorm_u16_f32 v41, v94, v95
  v_add_u32 v44, v48, v40
  s_waitcnt vmcnt(10)
  v_mfma_f32_32x32x16_bf16 v[164:179], v[212:215], v[224:227], v[164:179]
  buffer_load_dwordx4 v[212:215], v5, s[8:11], s24 offen offset:1024 sc1
  v_pk_fma_f16 v39, v47, v49, v39
  v_cvt_pknorm_u16_f32 v42, v96, v97
  v_add_u32 v45, v48, v41
  v_pk_fma_f16 v40, v44, v49, v40
  v_cvt_pknorm_u16_f32 v43, v98, v99
  v_add_u32 v46, v48, v42
  s_waitcnt lgkmcnt(2)
  v_mfma_f32_32x32x16_f16 v[100:115], v[28:31], v[36:39], v[100:115]
  ds_read_b128 v[28:31], v3 offset:4096
  v_pk_fma_f16 v41, v45, v49, v41
  v_add_u32 v47, v48, v43
  v_pk_fma_f16 v42, v46, v49, v42
  v_pk_fma_f16 v43, v47, v49, v43
  v_cvt_pknorm_u16_f32 v36, v68, v69
  v_cvt_pknorm_u16_f32 v37, v70, v71
  s_waitcnt lgkmcnt(2)
  v_mfma_f32_32x32x16_f16 v[100:115], v[32:35], v[40:43], v[100:115]
  ds_read_b128 v[32:35], v3 offset:4608
  s_waitcnt vmcnt(10)
  v_mfma_f32_32x32x16_bf16 v[148:163], v[216:219], v[220:223], v[148:163]
  buffer_load_dwordx4 v[220:223], v5, s[8:11], s26 offen offset:1024 sc1
  v_add_u32 v44, v48, v36
  v_cvt_pknorm_u16_f32 v38, v72, v73
  v_add_u32 v45, v48, v37
  buffer_load_dwordx4 v20, s[60:63], s38 offen lds
  s_add_u32 m0, m0, 1024
  s_add_u32 s38, s38, 8192
  v_pk_fma_f16 v36, v44, v49, v36
  v_cvt_pknorm_u16_f32 v39, v74, v75
  v_add_u32 v46, v48, v38
  s_waitcnt lgkmcnt(2)
  v_mfma_f32_32x32x16_bf16 v[84:99], v[24:27], v[16:19], v[52:67]
  ds_read_b128 v[24:27], v5 offset:55296
  v_pk_fma_f16 v37, v45, v49, v37
  v_cvt_pknorm_u16_f32 v40, v76, v77
  v_add_u32 v47, v48, v39
  v_pk_fma_f16 v38, v46, v49, v38
  v_cvt_pknorm_u16_f32 v41, v78, v79
  v_add_u32 v44, v48, v40
  v_mfma_f32_32x32x16_bf16 v[180:195], v[216:219], v[224:227], v[180:195]
  buffer_load_dwordx4 v[224:227], v5, s[8:11], s27 offen offset:1024 sc1
  buffer_load_dwordx4 v[216:219], v5, s[8:11], s25 offen offset:1024 sc1
  v_pk_fma_f16 v39, v47, v49, v39
  v_cvt_pknorm_u16_f32 v42, v80, v81
  v_add_u32 v45, v48, v41
  v_pk_fma_f16 v40, v44, v49, v40
  v_cvt_pknorm_u16_f32 v43, v82, v83
  v_add_u32 v46, v48, v42
  s_waitcnt lgkmcnt(2)
  v_mfma_f32_32x32x16_f16 v[100:115], v[28:31], v[36:39], v[100:115]
  ds_read_b128 v[28:31], v3 offset:5120
  v_pk_fma_f16 v41, v45, v49, v41
  v_add_u32 v47, v48, v43
  v_pk_fma_f16 v42, v46, v49, v42
  v_pk_fma_f16 v43, v47, v49, v43
  v_cvt_pknorm_u16_f32 v36, v84, v85
  v_cvt_pknorm_u16_f32 v37, v86, v87
  s_waitcnt lgkmcnt(2)
  v_mfma_f32_32x32x16_f16 v[100:115], v[32:35], v[40:43], v[100:115]
  ds_read_b128 v[32:35], v3 offset:5632
  v_add_u32 v44, v48, v36
  v_cvt_pknorm_u16_f32 v38, v88, v89
  v_add_u32 v45, v48, v37
  buffer_load_dwordx4 v20, s[60:63], s38 offen lds
  s_add_u32 m0, m0, 1024
  s_add_u32 s38, s38, 8192
  v_pk_fma_f16 v36, v44, v49, v36
  v_cvt_pknorm_u16_f32 v39, v90, v91
  v_add_u32 v46, v48, v38
  s_waitcnt lgkmcnt(2)
  v_mfma_f32_32x32x16_bf16 v[68:83], v[24:27], v[16:19], v[52:67]
  ds_read_b128 v[24:27], v5 offset:56320
  v_pk_fma_f16 v37, v45, v49, v37
  v_cvt_pknorm_u16_f32 v40, v92, v93
  v_add_u32 v47, v48, v39
  v_pk_fma_f16 v38, v46, v49, v38
  v_cvt_pknorm_u16_f32 v41, v94, v95
  v_add_u32 v44, v48, v40
  s_waitcnt vmcnt(11)
  v_mfma_f32_32x32x16_bf16 v[132:147], v[196:199], v[204:207], v[132:147]
  v_pk_fma_f16 v39, v47, v49, v39
  v_cvt_pknorm_u16_f32 v42, v96, v97
  v_add_u32 v45, v48, v41
  v_pk_fma_f16 v40, v44, v49, v40
  v_cvt_pknorm_u16_f32 v43, v98, v99
  v_add_u32 v46, v48, v42
  s_waitcnt lgkmcnt(2)
  v_mfma_f32_32x32x16_f16 v[100:115], v[28:31], v[36:39], v[100:115]
  ds_read_b128 v[28:31], v3 offset:6144
  v_pk_fma_f16 v41, v45, v49, v41
  v_add_u32 v47, v48, v43
  v_pk_fma_f16 v42, v46, v49, v42
  v_pk_fma_f16 v43, v47, v49, v43
  v_cvt_pknorm_u16_f32 v36, v68, v69
  v_cvt_pknorm_u16_f32 v37, v70, v71
  s_waitcnt lgkmcnt(2)
  v_mfma_f32_32x32x16_f16 v[100:115], v[32:35], v[40:43], v[100:115]
  ds_read_b128 v[32:35], v3 offset:6656
  v_add_u32 v44, v48, v36
  v_cvt_pknorm_u16_f32 v38, v72, v73
  v_add_u32 v45, v48, v37
  buffer_load_dwordx4 v20, s[60:63], s38 offen lds
  v_pk_fma_f16 v36, v44, v49, v36
  v_cvt_pknorm_u16_f32 v39, v74, v75
  v_add_u32 v46, v48, v38
  s_waitcnt lgkmcnt(2)
  v_mfma_f32_32x32x16_bf16 v[84:99], v[24:27], v[16:19], v[52:67]
  ds_read_b128 v[24:27], v5 offset:57344
  v_pk_fma_f16 v37, v45, v49, v37
  v_cvt_pknorm_u16_f32 v40, v76, v77
  v_add_u32 v47, v48, v39
  v_pk_fma_f16 v38, v46, v49, v38
  v_cvt_pknorm_u16_f32 v41, v78, v79
  v_add_u32 v44, v48, v40
  s_waitcnt vmcnt(10)
  v_mfma_f32_32x32x16_bf16 v[164:179], v[196:199], v[208:211], v[164:179]
  v_pk_fma_f16 v39, v47, v49, v39
  v_cvt_pknorm_u16_f32 v42, v80, v81
  v_add_u32 v45, v48, v41
  v_pk_fma_f16 v40, v44, v49, v40
  v_cvt_pknorm_u16_f32 v43, v82, v83
  v_add_u32 v46, v48, v42
  s_waitcnt lgkmcnt(2)
  v_mfma_f32_32x32x16_f16 v[100:115], v[28:31], v[36:39], v[100:115]
  ds_read_b128 v[28:31], v3 offset:7168
  v_pk_fma_f16 v41, v45, v49, v41
  v_add_u32 v47, v48, v43
  v_pk_fma_f16 v42, v46, v49, v42
  v_pk_fma_f16 v43, v47, v49, v43
  v_cvt_pknorm_u16_f32 v36, v84, v85
  v_cvt_pknorm_u16_f32 v37, v86, v87
  s_waitcnt lgkmcnt(2)
  v_mfma_f32_32x32x16_f16 v[100:115], v[32:35], v[40:43], v[100:115]
  ds_read_b128 v[32:35], v3 offset:7680
  v_add_u32 v44, v48, v36
  v_cvt_pknorm_u16_f32 v38, v88, v89
  v_add_u32 v45, v48, v37
  v_pk_fma_f16 v36, v44, v49, v36
  v_cvt_pknorm_u16_f32 v39, v90, v91
  v_add_u32 v46, v48, v38
  s_waitcnt lgkmcnt(2)
  v_mfma_f32_32x32x16_bf16 v[68:83], v[24:27], v[16:19], v[52:67]
  ds_read_b128 v[24:27], v5 offset:58368
  v_pk_fma_f16 v37, v45, v49, v37
  v_cvt_pknorm_u16_f32 v40, v92, v93
  v_add_u32 v47, v48, v39
  v_pk_fma_f16 v38, v46, v49, v38
  v_cvt_pknorm_u16_f32 v41, v94, v95
  v_add_u32 v44, v48, v40
  s_waitcnt vmcnt(9)
  v_mfma_f32_32x32x16_bf16 v[148:163], v[200:203], v[204:207], v[148:163]
  v_pk_fma_f16 v39, v47, v49, v39
  v_cvt_pknorm_u16_f32 v42, v96, v97
  v_add_u32 v45, v48, v41
  v_pk_fma_f16 v40, v44, v49, v40
  v_cvt_pknorm_u16_f32 v43, v98, v99
  v_add_u32 v46, v48, v42
  s_waitcnt lgkmcnt(2)
  v_mfma_f32_32x32x16_f16 v[100:115], v[28:31], v[36:39], v[100:115]
  v_add_u32 v3, v4, v3
  ds_read_b128 v[28:31], v3 offset:0
  v_pk_fma_f16 v41, v45, v49, v41
  v_add_u32 v47, v48, v43
  v_pk_fma_f16 v42, v46, v49, v42
  v_pk_fma_f16 v43, v47, v49, v43
  v_cvt_pknorm_u16_f32 v36, v68, v69
  v_cvt_pknorm_u16_f32 v37, v70, v71
  s_waitcnt lgkmcnt(2)
  v_mfma_f32_32x32x16_f16 v[100:115], v[32:35], v[40:43], v[100:115]
  ds_read_b128 v[32:35], v3 offset:512
  v_mfma_f32_32x32x16_bf16 v[180:195], v[200:203], v[208:211], v[180:195]
  v_add_u32 v44, v48, v36
  v_cvt_pknorm_u16_f32 v38, v72, v73
  v_add_u32 v45, v48, v37
  v_pk_fma_f16 v36, v44, v49, v36
  v_cvt_pknorm_u16_f32 v39, v74, v75
  v_add_u32 v46, v48, v38
  s_waitcnt lgkmcnt(2)
  v_mfma_f32_32x32x16_bf16 v[84:99], v[24:27], v[16:19], v[52:67]
  ds_read_b128 v[24:27], v5 offset:59392
  v_pk_fma_f16 v37, v45, v49, v37
  v_cvt_pknorm_u16_f32 v40, v76, v77
  v_add_u32 v47, v48, v39
  v_pk_fma_f16 v38, v46, v49, v38
  v_cvt_pknorm_u16_f32 v41, v78, v79
  v_add_u32 v44, v48, v40
  s_waitcnt vmcnt(5)
  v_mfma_f32_32x32x16_bf16 v[132:147], v[212:215], v[220:223], v[132:147]
  v_pk_fma_f16 v39, v47, v49, v39
  v_cvt_pknorm_u16_f32 v42, v80, v81
  v_add_u32 v45, v48, v41
  v_pk_fma_f16 v40, v44, v49, v40
  v_cvt_pknorm_u16_f32 v43, v82, v83
  v_add_u32 v46, v48, v42
  s_waitcnt lgkmcnt(2)
  v_mfma_f32_32x32x16_f16 v[100:115], v[28:31], v[36:39], v[100:115]
  ds_read_b128 v[28:31], v3 offset:1024
  v_pk_fma_f16 v41, v45, v49, v41
  v_add_u32 v47, v48, v43
  v_pk_fma_f16 v42, v46, v49, v42
  v_pk_fma_f16 v43, v47, v49, v43
  v_cvt_pknorm_u16_f32 v36, v84, v85
  v_cvt_pknorm_u16_f32 v37, v86, v87
  s_waitcnt lgkmcnt(2)
  v_mfma_f32_32x32x16_f16 v[100:115], v[32:35], v[40:43], v[100:115]
  ds_read_b128 v[32:35], v3 offset:1536
  v_add_u32 v44, v48, v36
  v_cvt_pknorm_u16_f32 v38, v88, v89
  v_add_u32 v45, v48, v37
  v_pk_fma_f16 v36, v44, v49, v36
  v_cvt_pknorm_u16_f32 v39, v90, v91
  v_add_u32 v46, v48, v38
  s_waitcnt lgkmcnt(2)
  v_mfma_f32_32x32x16_bf16 v[68:83], v[24:27], v[16:19], v[52:67]
  ds_read_b128 v[24:27], v5 offset:60416
  v_pk_fma_f16 v37, v45, v49, v37
  v_cvt_pknorm_u16_f32 v40, v92, v93
  v_add_u32 v47, v48, v39
  v_pk_fma_f16 v38, v46, v49, v38
  v_cvt_pknorm_u16_f32 v41, v94, v95
  v_add_u32 v44, v48, v40
  s_waitcnt vmcnt(3)
  v_mfma_f32_32x32x16_bf16 v[164:179], v[212:215], v[224:227], v[164:179]
  v_pk_fma_f16 v39, v47, v49, v39
  v_cvt_pknorm_u16_f32 v42, v96, v97
  v_add_u32 v45, v48, v41
  v_pk_fma_f16 v40, v44, v49, v40
  v_cvt_pknorm_u16_f32 v43, v98, v99
  v_add_u32 v46, v48, v42
  s_waitcnt lgkmcnt(2)
  v_mfma_f32_32x32x16_f16 v[100:115], v[28:31], v[36:39], v[100:115]
  ds_read_b128 v[28:31], v3 offset:2048
  v_pk_fma_f16 v41, v45, v49, v41
  v_add_u32 v47, v48, v43
  v_pk_fma_f16 v42, v46, v49, v42
  v_pk_fma_f16 v43, v47, v49, v43
  s_barrier
  v_cvt_pknorm_u16_f32 v36, v68, v69
  v_cvt_pknorm_u16_f32 v37, v70, v71
  s_waitcnt lgkmcnt(2)
  v_mfma_f32_32x32x16_f16 v[100:115], v[32:35], v[40:43], v[100:115]
  ds_read_b128 v[32:35], v3 offset:2560
  v_add_u32 v44, v48, v36
  v_cvt_pknorm_u16_f32 v38, v72, v73
  v_add_u32 v45, v48, v37
  v_pk_fma_f16 v36, v44, v49, v36
  v_cvt_pknorm_u16_f32 v39, v74, v75
  v_add_u32 v46, v48, v38
  s_waitcnt lgkmcnt(2)
  v_mfma_f32_32x32x16_bf16 v[84:99], v[24:27], v[16:19], v[52:67]
  ds_read_b128 v[24:27], v5 offset:61440
  v_pk_fma_f16 v37, v45, v49, v37
  v_cvt_pknorm_u16_f32 v40, v76, v77
  v_add_u32 v47, v48, v39
  v_pk_fma_f16 v38, v46, v49, v38
  v_cvt_pknorm_u16_f32 v41, v78, v79
  v_add_u32 v44, v48, v40
  s_waitcnt vmcnt(2)
  v_mfma_f32_32x32x16_bf16 v[148:163], v[216:219], v[220:223], v[148:163]
  v_pk_fma_f16 v39, v47, v49, v39
  v_cvt_pknorm_u16_f32 v42, v80, v81
  v_add_u32 v45, v48, v41
  v_pk_fma_f16 v40, v44, v49, v40
  v_cvt_pknorm_u16_f32 v43, v82, v83
  v_add_u32 v46, v48, v42
  s_waitcnt lgkmcnt(2)
  v_mfma_f32_32x32x16_f16 v[100:115], v[28:31], v[36:39], v[100:115]
  ds_read_b128 v[28:31], v3 offset:3072
  v_pk_fma_f16 v41, v45, v49, v41
  v_add_u32 v47, v48, v43
  v_pk_fma_f16 v42, v46, v49, v42
  v_pk_fma_f16 v43, v47, v49, v43
  v_cvt_pknorm_u16_f32 v36, v84, v85
  v_cvt_pknorm_u16_f32 v37, v86, v87
  s_waitcnt lgkmcnt(2)
  v_mfma_f32_32x32x16_f16 v[100:115], v[32:35], v[40:43], v[100:115]
  ds_read_b128 v[32:35], v3 offset:3584
  v_add_u32 v44, v48, v36
  v_cvt_pknorm_u16_f32 v38, v88, v89
  v_add_u32 v45, v48, v37
  v_pk_fma_f16 v36, v44, v49, v36
  v_cvt_pknorm_u16_f32 v39, v90, v91
  v_add_u32 v46, v48, v38
  s_waitcnt lgkmcnt(2)
  v_mfma_f32_32x32x16_bf16 v[68:83], v[24:27], v[16:19], v[52:67]
  ds_read_b128 v[24:27], v5 offset:62464
  v_pk_fma_f16 v37, v45, v49, v37
  v_cvt_pknorm_u16_f32 v40, v92, v93
  v_add_u32 v47, v48, v39
  v_pk_fma_f16 v38, v46, v49, v38
  v_cvt_pknorm_u16_f32 v41, v94, v95
  v_add_u32 v44, v48, v40
  v_mfma_f32_32x32x16_bf16 v[180:195], v[216:219], v[224:227], v[180:195]
  v_pk_fma_f16 v39, v47, v49, v39
  v_cvt_pknorm_u16_f32 v42, v96, v97
  v_add_u32 v45, v48, v41
  v_pk_fma_f16 v40, v44, v49, v40
  v_cvt_pknorm_u16_f32 v43, v98, v99
  v_add_u32 v46, v48, v42
  s_waitcnt lgkmcnt(2)
  v_mfma_f32_32x32x16_f16 v[100:115], v[28:31], v[36:39], v[100:115]
  ds_read_b128 v[28:31], v3 offset:4096
  v_pk_fma_f16 v41, v45, v49, v41
  v_add_u32 v47, v48, v43
  v_pk_fma_f16 v42, v46, v49, v42
  v_pk_fma_f16 v43, v47, v49, v43
  v_cvt_pknorm_u16_f32 v36, v68, v69
  v_cvt_pknorm_u16_f32 v37, v70, v71
  s_waitcnt lgkmcnt(2)
  v_mfma_f32_32x32x16_f16 v[100:115], v[32:35], v[40:43], v[100:115]
  ds_read_b128 v[32:35], v3 offset:4608
  v_add_u32 v44, v48, v36
  v_cvt_pknorm_u16_f32 v38, v72, v73
  v_add_u32 v45, v48, v37
  v_pk_fma_f16 v36, v44, v49, v36
  v_cvt_pknorm_u16_f32 v39, v74, v75
  v_add_u32 v46, v48, v38
  s_waitcnt lgkmcnt(2)
  v_mfma_f32_32x32x16_bf16 v[84:99], v[24:27], v[16:19], v[52:67]
  ds_read_b128 v[24:27], v5 offset:63488
  v_pk_fma_f16 v37, v45, v49, v37
  v_cvt_pknorm_u16_f32 v40, v76, v77
  v_add_u32 v47, v48, v39
  v_pk_fma_f16 v38, v46, v49, v38
  v_cvt_pknorm_u16_f32 v41, v78, v79
  v_add_u32 v44, v48, v40
  ds_write_b128 v2, v[164:167] offset:0
  ds_write_b128 v2, v[168:171] offset:1024
  v_pk_fma_f16 v39, v47, v49, v39
  v_cvt_pknorm_u16_f32 v42, v80, v81
  v_add_u32 v45, v48, v41
  v_pk_fma_f16 v40, v44, v49, v40
  v_cvt_pknorm_u16_f32 v43, v82, v83
  v_add_u32 v46, v48, v42
  s_waitcnt lgkmcnt(4)
  v_mfma_f32_32x32x16_f16 v[100:115], v[28:31], v[36:39], v[100:115]
  ds_read_b128 v[28:31], v3 offset:5120
  v_pk_fma_f16 v41, v45, v49, v41
  v_add_u32 v47, v48, v43
  v_pk_fma_f16 v42, v46, v49, v42
  v_pk_fma_f16 v43, v47, v49, v43
  v_cvt_pknorm_u16_f32 v36, v84, v85
  v_cvt_pknorm_u16_f32 v37, v86, v87
  s_waitcnt lgkmcnt(4)
  v_mfma_f32_32x32x16_f16 v[100:115], v[32:35], v[40:43], v[100:115]
  ds_read_b128 v[32:35], v3 offset:5632
  v_add_u32 v44, v48, v36
  v_cvt_pknorm_u16_f32 v38, v88, v89
  v_add_u32 v45, v48, v37
  v_pk_fma_f16 v36, v44, v49, v36
  v_cvt_pknorm_u16_f32 v39, v90, v91
  v_add_u32 v46, v48, v38
  s_waitcnt lgkmcnt(4)
  v_mfma_f32_32x32x16_bf16 v[68:83], v[24:27], v[16:19], v[52:67]
  ds_read_b128 v[24:27], v5 offset:64512
  v_pk_fma_f16 v37, v45, v49, v37
  v_cvt_pknorm_u16_f32 v40, v92, v93
  v_add_u32 v47, v48, v39
  v_pk_fma_f16 v38, v46, v49, v38
  v_cvt_pknorm_u16_f32 v41, v94, v95
  v_add_u32 v44, v48, v40
  ds_write_b128 v2, v[172:175] offset:2048
  ds_write_b128 v2, v[176:179] offset:3072
  v_pk_fma_f16 v39, v47, v49, v39
  v_cvt_pknorm_u16_f32 v42, v96, v97
  v_add_u32 v45, v48, v41
  v_pk_fma_f16 v40, v44, v49, v40
  v_cvt_pknorm_u16_f32 v43, v98, v99
  v_add_u32 v46, v48, v42
  s_waitcnt lgkmcnt(4)
  v_mfma_f32_32x32x16_f16 v[100:115], v[28:31], v[36:39], v[100:115]
  ds_read_b128 v[28:31], v3 offset:6144
  v_pk_fma_f16 v41, v45, v49, v41
  v_add_u32 v47, v48, v43
  v_pk_fma_f16 v42, v46, v49, v42
  v_pk_fma_f16 v43, v47, v49, v43
  v_cvt_pknorm_u16_f32 v36, v68, v69
  v_cvt_pknorm_u16_f32 v37, v70, v71
  s_waitcnt lgkmcnt(4)
  v_mfma_f32_32x32x16_f16 v[100:115], v[32:35], v[40:43], v[100:115]
  ds_read_b128 v[32:35], v3 offset:6656
  v_add_u32 v44, v48, v36
  v_cvt_pknorm_u16_f32 v38, v72, v73
  v_add_u32 v45, v48, v37
  v_pk_fma_f16 v36, v44, v49, v36
  v_cvt_pknorm_u16_f32 v39, v74, v75
  v_add_u32 v46, v48, v38
  s_waitcnt lgkmcnt(4)
  v_mfma_f32_32x32x16_bf16 v[84:99], v[24:27], v[16:19], v[52:67]
  v_pk_fma_f16 v37, v45, v49, v37
  v_cvt_pknorm_u16_f32 v40, v76, v77
  v_add_u32 v47, v48, v39
  v_pk_fma_f16 v38, v46, v49, v38
  v_cvt_pknorm_u16_f32 v41, v78, v79
  v_add_u32 v44, v48, v40
  ds_write_b128 v2, v[180:183] offset:4096
  ds_write_b128 v2, v[184:187] offset:5120
  v_pk_fma_f16 v39, v47, v49, v39
  v_cvt_pknorm_u16_f32 v42, v80, v81
  v_add_u32 v45, v48, v41
  v_pk_fma_f16 v40, v44, v49, v40
  v_cvt_pknorm_u16_f32 v43, v82, v83
  v_add_u32 v46, v48, v42
  s_waitcnt lgkmcnt(3)
  v_mfma_f32_32x32x16_f16 v[100:115], v[28:31], v[36:39], v[100:115]
  ds_read_b128 v[28:31], v3 offset:7168
  v_pk_fma_f16 v41, v45, v49, v41
  v_add_u32 v47, v48, v43
  v_pk_fma_f16 v42, v46, v49, v42
  v_pk_fma_f16 v43, v47, v49, v43
  v_cvt_pknorm_u16_f32 v36, v84, v85
  v_cvt_pknorm_u16_f32 v37, v86, v87
  s_waitcnt lgkmcnt(3)
  v_mfma_f32_32x32x16_f16 v[100:115], v[32:35], v[40:43], v[100:115]
  ds_read_b128 v[32:35], v3 offset:7680
  v_add_u32 v44, v48, v36
  v_cvt_pknorm_u16_f32 v38, v88, v89
  v_add_u32 v45, v48, v37
  v_pk_fma_f16 v36, v44, v49, v36
  v_cvt_pknorm_u16_f32 v39, v90, v91
  v_add_u32 v46, v48, v38
  v_pk_fma_f16 v37, v45, v49, v37
  v_cvt_pknorm_u16_f32 v40, v92, v93
  v_add_u32 v47, v48, v39
  v_pk_fma_f16 v38, v46, v49, v38
  v_cvt_pknorm_u16_f32 v41, v94, v95
  v_add_u32 v44, v48, v40
  ds_write_b128 v2, v[188:191] offset:6144
  ds_write_b128 v2, v[192:195] offset:7168
  v_pk_fma_f16 v39, v47, v49, v39
  v_cvt_pknorm_u16_f32 v42, v96, v97
  v_add_u32 v45, v48, v41
  v_pk_fma_f16 v40, v44, v49, v40
  v_cvt_pknorm_u16_f32 v43, v98, v99
  v_add_u32 v46, v48, v42
  s_waitcnt lgkmcnt(3)
  v_mfma_f32_32x32x16_f16 v[100:115], v[28:31], v[36:39], v[100:115]
  v_pk_fma_f16 v41, v45, v49, v41
  v_add_u32 v47, v48, v43
  v_pk_fma_f16 v42, v46, v49, v42
  v_pk_fma_f16 v43, v47, v49, v43
  s_waitcnt lgkmcnt(2)
  s_nop 0
  v_mfma_f32_32x32x16_f16 v[100:115], v[32:35], v[40:43], v[100:115]
  v_lshrrev_b32 v8, 5, v1
  v_bfe_u32 v9, v1, 2, 2
  v_lshl_add_u32 v8, v8, 2, v9
  v_lshlrev_b32 v8, 7, v8
  v_bfe_u32 v9, v1, 3, 1
  v_lshl_add_u32 v8, v9, 6, v8
  v_bfe_u32 v9, v1, 4, 1
  v_lshl_add_u32 v8, v9, 5, v8
  v_and_b32 v9, 3, v1
  v_lshl_add_u32 v8, v9, 3, v8
  s_lshl_b32 s19, s29, 14
  s_lshl_b32 s20, s22, 16
  s_add_u32 s19, s19, s20
  s_lshl_b32 s20, s29, 6
  v_add_u32 v8, s19, v8
  v_xor_b32 v8, s20, v8
  v_xor_b32 v9, 64, v8
  s_waitcnt vmcnt(0)
  v_mov_b32 v32, v108
  v_subrev_u32 v10, 1124073472, v32
  v_cmp_gt_u32 vcc, 1015021568, v10
  s_cmp_eq_u64 vcc, -1
  s_cbranch_scc0 B_SLOW
B_NORM:
  v_rcp_f32 v32, v32
  s_nop 0
  v_mul_f32 v32, v32, v6
  s_nop 3
  v_mul_f32 v100, v100, v32
  v_mul_f32 v101, v101, v32
  v_mul_f32 v102, v102, v32
  v_mul_f32 v103, v103, v32
  v_mul_f32 v104, v104, v32
  v_mul_f32 v105, v105, v32
  v_mul_f32 v106, v106, v32
  v_mul_f32 v107, v107, v32
  v_cvt_pk_bf16_f32 v36, v100, v101
  v_cvt_pk_bf16_f32 v37, v102, v103
  v_cvt_pk_bf16_f32 v38, v104, v105
  v_cvt_pk_bf16_f32 v39, v106, v107
  buffer_store_dwordx4 v[36:39], v5, s[8:11], s37 offen sc1
  s_add_u32 s33, s36, 4096
  s_waitcnt lgkmcnt(0)
  s_barrier
  ds_read_b128 v[68:71], v21 offset:0
  ds_read_b128 v[72:75], v21 offset:1024
  ds_read_b128 v[76:79], v21 offset:2048
  ds_read_b128 v[80:83], v21 offset:3072
  ds_read_b128 v[84:87], v21 offset:4096
  ds_read_b128 v[88:91], v21 offset:5120
  ds_read_b128 v[92:95], v21 offset:6144
  ds_read_b128 v[96:99], v21 offset:7168
  v_sub_f32 v7, 1.0, v7
  ds_read_b64_tr_b16 v[164:165], v8 offset:0
  ds_read_b64_tr_b16 v[166:167], v8 offset:1024
  ds_read_b64_tr_b16 v[168:169], v8 offset:2048
  ds_read_b64_tr_b16 v[170:171], v8 offset:3072
  ds_read_b64_tr_b16 v[172:173], v8 offset:4096
  ds_read_b64_tr_b16 v[174:175], v8 offset:5120
  ds_read_b64_tr_b16 v[176:177], v8 offset:6144
  ds_read_b64_tr_b16 v[178:179], v8 offset:7168
  s_waitcnt lgkmcnt(8)
  v_add_f32 v132, v132, v68
  v_add_f32 v133, v133, v69
  v_add_f32 v134, v134, v70
  v_add_f32 v135, v135, v71
  v_add_f32 v136, v136, v72
  v_add_f32 v137, v137, v73
  v_add_f32 v138, v138, v74
  v_add_f32 v139, v139, v75
  v_add_f32 v140, v140, v76
  v_add_f32 v141, v141, v77
  v_add_f32 v142, v142, v78
  v_add_f32 v143, v143, v79
  v_add_f32 v144, v144, v80
  v_add_f32 v145, v145, v81
  v_add_f32 v146, v146, v82
  v_add_f32 v147, v147, v83
  v_add_f32 v148, v148, v84
  v_add_f32 v149, v149, v85
  v_add_f32 v150, v150, v86
  v_add_f32 v151, v151, v87
  v_add_f32 v152, v152, v88
  v_add_f32 v153, v153, v89
  v_add_f32 v154, v154, v90
  v_add_f32 v155, v155, v91
  v_add_f32 v156, v156, v92
  v_add_f32 v157, v157, v93
  v_add_f32 v158, v158, v94
  v_add_f32 v159, v159, v95
  v_add_f32 v160, v160, v96
  v_add_f32 v161, v161, v97
  v_add_f32 v162, v162, v98
  v_add_f32 v163, v163, v99
  ds_read_b64_tr_b16 v[180:181], v8 offset:8192
  ds_read_b64_tr_b16 v[182:183], v8 offset:9216
  ds_read_b64_tr_b16 v[184:185], v8 offset:10240
  ds_read_b64_tr_b16 v[186:187], v8 offset:11264
  ds_read_b64_tr_b16 v[188:189], v8 offset:12288
  ds_read_b64_tr_b16 v[190:191], v8 offset:13312
  ds_read_b64_tr_b16 v[192:193], v8 offset:14336
  ds_read_b64_tr_b16 v[194:195], v8 offset:15360
  ds_read_b64_tr_b16 v[116:117], v9 offset:0
  ds_read_b64_tr_b16 v[118:119], v9 offset:1024
  ds_read_b64_tr_b16 v[120:121], v9 offset:2048
  ds_read_b64_tr_b16 v[122:123], v9 offset:3072
  ds_read_b64_tr_b16 v[124:125], v9 offset:4096
  ds_read_b64_tr_b16 v[126:127], v9 offset:5120
  ds_read_b64_tr_b16 v[128:129], v9 offset:6144
  ds_read_b64_tr_b16 v[130:131], v9 offset:7168
  ds_read_b64_tr_b16 v[228:229], v9 offset:8192
  ds_read_b64_tr_b16 v[230:231], v9 offset:9216
  ds_read_b64_tr_b16 v[232:233], v9 offset:10240
  ds_read_b64_tr_b16 v[234:235], v9 offset:11264
  ds_read_b64_tr_b16 v[236:237], v9 offset:12288
  ds_read_b64_tr_b16 v[238:239], v9 offset:13312
  ds_read_b64_tr_b16 v[240:241], v9 offset:14336
  ds_read_b64_tr_b16 v[242:243], v9 offset:15360
  v_mul_f32 v132, v132, v7
  v_mul_f32 v133, v133, v7
  v_mul_f32 v134, v134, v7
  v_mul_f32 v135, v135, v7
  v_mul_f32 v136, v136, v7
  v_mul_f32 v137, v137, v7
  v_mul_f32 v138, v138, v7
  v_mul_f32 v139, v139, v7
  v_mul_f32 v140, v140, v7
  v_mul_f32 v141, v141, v7
  v_mul_f32 v142, v142, v7
  v_mul_f32 v143, v143, v7
  v_mul_f32 v144, v144, v7
  v_mul_f32 v145, v145, v7
  v_mul_f32 v146, v146, v7
  v_mul_f32 v147, v147, v7
  v_mul_f32 v148, v148, v7
  v_mul_f32 v149, v149, v7
  v_mul_f32 v150, v150, v7
  v_mul_f32 v151, v151, v7
  v_mul_f32 v152, v152, v7
  v_mul_f32 v153, v153, v7
  v_mul_f32 v154, v154, v7
  v_mul_f32 v155, v155, v7
  v_mul_f32 v156, v156, v7
  v_mul_f32 v157, v157, v7
  v_mul_f32 v158, v158, v7
  v_mul_f32 v159, v159, v7
  v_mul_f32 v160, v160, v7
  v_mul_f32 v161, v161, v7
  v_mul_f32 v162, v162, v7
  v_mul_f32 v163, v163, v7
  s_mul_i32 s19, s35, 16896
  s_lshl_b32 s20, s30, 10
  s_add_u32 s19, s19, s20
  s_mul_i32 s20, s29, 8448
  s_add_u32 s20, s20, s19
  v_add_u32 v10, s20, v5
  s_xor_b32 s20, s29, 1
  s_mul_i32 s20, s20, 8448
  s_add_u32 s20, s20, s19
  v_add_u32 v11, s20, v5
  v_and_b32 v12, 7, v1
  v_lshrrev_b32 v13, 3, v1
  v_mul_u32_u24 v14, 2112, v12
  v_lshl_add_u32 v14, v13, 4, v14
  s_lshl_b32 s19, s22, 10
  s_lshl_b32 s20, s28, 7
  s_add_u32 s19, s19, s20
  v_add_u32 v14, s19, v14
  v_add_u32 v15, 33792, v14
  v_lshlrev_b32 v13, 10, v13
  v_lshl_add_u32 v13, v12, 4, v13
  s_lshl_b32 s19, s17, 16
  s_lshl_b32 s20, s16, 13
  s_add_u32 s19, s19, s20
  s_lshl_b32 s20, s18, 7
  s_add_u32 s37, s19, s20
  s_waitcnt lgkmcnt(0)
  s_barrier
  buffer_load_dwordx4 v[196:199], v5, s[8:11], s36 offen offset:0 sc1
  buffer_load_dwordx4 v[200:203], v5, s[8:11], s36 offen offset:1024 sc1
  buffer_load_dwordx4 v[204:207], v5, s[8:11], s36 offen offset:2048 sc1
  buffer_load_dwordx4 v[208:211], v5, s[8:11], s36 offen offset:3072 sc1
  buffer_load_dwordx4 v[212:215], v5, s[8:11], s33 offen offset:0 sc1
  buffer_load_dwordx4 v[216:219], v5, s[8:11], s33 offen offset:1024 sc1
  buffer_load_dwordx4 v[220:223], v5, s[8:11], s33 offen offset:2048 sc1
  buffer_load_dwordx4 v[224:227], v5, s[8:11], s33 offen offset:3072 sc1
  s_mov_b32 s34, 4096
  s_waitcnt vmcnt(6)
B_POLL0:
  v_max_u32 v8, v196, v197
  v_max3_u32 v8, v198, v199, v8
  v_max3_u32 v8, v200, v201, v8
  v_max3_u32 v8, v202, v203, v8
  v_cmp_eq_u32 vcc, -1, v8
  s_cbranch_vccz B_GO0
  s_sub_u32 s34, s34, 1
  s_cmp_eq_u32 s34, 0
  s_cbranch_scc1 B_GO0
  buffer_load_dwordx4 v[196:199], v5, s[8:11], s36 offen offset:0 sc1
  buffer_load_dwordx4 v[200:203], v5, s[8:11], s36 offen offset:1024 sc1
  s_waitcnt vmcnt(0)
  s_branch B_POLL0
B_GO0:
  v_mfma_f32_32x32x16_bf16 v[132:147], v[164:167], v[196:199], v[132:147]
  v_mfma_f32_32x32x16_bf16 v[148:163], v[116:119], v[196:199], v[148:163]
  v_mfma_f32_32x32x16_bf16 v[132:147], v[168:171], v[200:203], v[132:147]
  v_mfma_f32_32x32x16_bf16 v[148:163], v[120:123], v[200:203], v[148:163]
  s_mov_b32 s34, 4096
  s_waitcnt vmcnt(4)
B_POLL1:
  v_max_u32 v8, v204, v205
  v_max3_u32 v8, v206, v207, v8
  v_max3_u32 v8, v208, v209, v8
  v_max3_u32 v8, v210, v211, v8
  v_cmp_eq_u32 vcc, -1, v8
  s_cbranch_vccz B_GO1
  s_sub_u32 s34, s34, 1
  s_cmp_eq_u32 s34, 0
  s_cbranch_scc1 B_GO1
  buffer_load_dwordx4 v[204:207], v5, s[8:11], s36 offen offset:2048 sc1
  buffer_load_dwordx4 v[208:211], v5, s[8:11], s36 offen offset:3072 sc1
  s_waitcnt vmcnt(0)
  s_branch B_POLL1
B_GO1:
  v_mfma_f32_32x32x16_bf16 v[132:147], v[172:175], v[204:207], v[132:147]
  v_mfma_f32_32x32x16_bf16 v[148:163], v[124:127], v[204:207], v[148:163]
  v_mfma_f32_32x32x16_bf16 v[132:147], v[176:179], v[208:211], v[132:147]
  v_mfma_f32_32x32x16_bf16 v[148:163], v[128:131], v[208:211], v[148:163]
  s_mov_b32 s34, 4096
  s_waitcnt vmcnt(2)
B_POLL2:
  v_max_u32 v8, v212, v213
  v_max3_u32 v8, v214, v215, v8
  v_max3_u32 v8, v216, v217, v8
  v_max3_u32 v8, v218, v219, v8
  v_cmp_eq_u32 vcc, -1, v8
  s_cbranch_vccz B_GO2
  s_sub_u32 s34, s34, 1
  s_cmp_eq_u32 s34, 0
  s_cbranch_scc1 B_GO2
  buffer_load_dwordx4 v[212:215], v5, s[8:11], s33 offen offset:0 sc1
  buffer_load_dwordx4 v[216:219], v5, s[8:11], s33 offen offset:1024 sc1
  s_waitcnt vmcnt(0)
  s_branch B_POLL2
B_GO2:
  v_mfma_f32_32x32x16_bf16 v[132:147], v[180:183], v[212:215], v[132:147]
  v_mfma_f32_32x32x16_bf16 v[148:163], v[228:231], v[212:215], v[148:163]
  v_mfma_f32_32x32x16_bf16 v[132:147], v[184:187], v[216:219], v[132:147]
  v_mfma_f32_32x32x16_bf16 v[148:163], v[232:235], v[216:219], v[148:163]
  s_mov_b32 s34, 4096
  s_waitcnt vmcnt(0)
B_POLL3:
  v_max_u32 v8, v220, v221
  v_max3_u32 v8, v222, v223, v8
  v_max3_u32 v8, v224, v225, v8
  v_max3_u32 v8, v226, v227, v8
  v_cmp_eq_u32 vcc, -1, v8
  s_cbranch_vccz B_GO3
  s_sub_u32 s34, s34, 1
  s_cmp_eq_u32 s34, 0
  s_cbranch_scc1 B_GO3
  buffer_load_dwordx4 v[220:223], v5, s[8:11], s33 offen offset:2048 sc1
  buffer_load_dwordx4 v[224:227], v5, s[8:11], s33 offen offset:3072 sc1
  s_waitcnt vmcnt(0)
  s_branch B_POLL3
B_GO3:
  v_mfma_f32_32x32x16_bf16 v[132:147], v[188:191], v[220:223], v[132:147]
  v_mfma_f32_32x32x16_bf16 v[148:163], v[236:239], v[220:223], v[148:163]
  v_mfma_f32_32x32x16_bf16 v[132:147], v[192:195], v[224:227], v[132:147]
  v_mfma_f32_32x32x16_bf16 v[148:163], v[240:243], v[224:227], v[148:163]
  s_nop 10
  ds_write_b128 v10, v[132:135] offset:0
  ds_write_b128 v10, v[136:139] offset:2112
  ds_write_b128 v10, v[140:143] offset:4224
  ds_write_b128 v10, v[144:147] offset:6336
  ds_write_b128 v11, v[148:151] offset:0
  ds_write_b128 v11, v[152:155] offset:2112
  ds_write_b128 v11, v[156:159] offset:4224
  ds_write_b128 v11, v[160:163] offset:6336
  s_waitcnt lgkmcnt(0)
  s_barrier
  ds_read_b128 v[68:71], v14 offset:0
  ds_read_b128 v[72:75], v14 offset:512
  ds_read_b128 v[76:79], v14 offset:16896
  ds_read_b128 v[80:83], v14 offset:17408
  ds_read_b128 v[84:87], v15 offset:0
  ds_read_b128 v[88:91], v15 offset:512
  ds_read_b128 v[92:95], v15 offset:16896
  ds_read_b128 v[96:99], v15 offset:17408
  s_waitcnt lgkmcnt(4)
  v_add_f32 v68, v68, v76
  v_add_f32 v69, v69, v77
  v_add_f32 v70, v70, v78
  v_add_f32 v71, v71, v79
  v_add_f32 v72, v72, v80
  v_add_f32 v73, v73, v81
  v_add_f32 v74, v74, v82
  v_add_f32 v75, v75, v83
  s_waitcnt lgkmcnt(0)
  v_add_f32 v84, v84, v92
  v_add_f32 v85, v85, v93
  v_add_f32 v86, v86, v94
  v_add_f32 v87, v87, v95
  v_add_f32 v88, v88, v96
  v_add_f32 v89, v89, v97
  v_add_f32 v90, v90, v98
  v_add_f32 v91, v91, v99
  v_add_f32 v68, v68, v84
  v_add_f32 v69, v69, v85
  v_add_f32 v70, v70, v86
  v_add_f32 v71, v71, v87
  v_add_f32 v72, v72, v88
  v_add_f32 v73, v73, v89
  v_add_f32 v74, v74, v90
  v_add_f32 v75, v75, v91
  v_cvt_pk_bf16_f32 v36, v68, v69
  v_cvt_pk_bf16_f32 v37, v70, v71
  v_cvt_pk_bf16_f32 v38, v72, v73
  v_cvt_pk_bf16_f32 v39, v74, v75
  buffer_store_dwordx4 v[36:39], v13, s[12:15], s37 offen
  s_endpgm
B_SLOW:
  v_mov_b32 v10, 0xff800000
  s_mov_b32 s19, 2097152
  s_mov_b32 s21, 64
B_SL1:
  buffer_load_dwordx4 v[24:27], v5, s[8:11], s19 offen sc1
  s_add_u32 s19, s19, 1024
  s_waitcnt vmcnt(0)
  v_mfma_f32_32x32x16_bf16 v[68:83], v[24:27], v[16:19], 0
  s_nop 11
  v_max3_f32 v10, v68, v69, v10
  v_max3_f32 v10, v70, v71, v10
  v_max3_f32 v10, v72, v73, v10
  v_max3_f32 v10, v74, v75, v10
  v_max3_f32 v10, v76, v77, v10
  v_max3_f32 v10, v78, v79, v10
  v_max3_f32 v10, v80, v81, v10
  v_max3_f32 v10, v82, v83, v10
  s_sub_u32 s21, s21, 1
  s_cmp_lg_u32 s21, 0
  s_cbranch_scc1 B_SL1
  v_mov_b32 v11, v10
  s_nop 1
  v_permlane32_swap_b32 v10, v11
  v_max_f32 v10, v10, v11
  v_mul_f32 v10, 0xc27fff00, v10
  v_mov_b32 v11, 0x427fff00
  v_and_b32 v12, 15, v1
  v_lshlrev_b32 v12, 4, v12
  v_lshrrev_b32 v13, 5, v1
  v_lshl_add_u32 v12, v13, 8, v12
  v_and_b32 v13, 16, v1
  v_cmp_eq_u32 s[40:41], 0, v13
  v_mov_b32 v13, 0x3f803f80
  v_mov_b32 v100, 0
  v_mov_b32 v101, 0
  v_mov_b32 v102, 0
  v_mov_b32 v103, 0
  v_mov_b32 v104, 0
  v_mov_b32 v105, 0
  v_mov_b32 v106, 0
  v_mov_b32 v107, 0
  v_mov_b32 v108, 0
  v_mov_b32 v109, 0
  v_mov_b32 v110, 0
  v_mov_b32 v111, 0
  v_mov_b32 v112, 0
  v_mov_b32 v113, 0
  v_mov_b32 v114, 0
  v_mov_b32 v115, 0
  s_mov_b32 s19, 2097152
  s_mov_b32 s20, 2293760
  s_mov_b32 s21, 64
B_SL2:
  buffer_load_dwordx4 v[24:27], v5, s[8:11], s19 offen sc1
  buffer_load_dwordx4 v[28:31], v12, s[8:11], s20 offen sc1
  buffer_load_dwordx4 v[84:87], v12, s[8:11], s20 offen offset:512 sc1
  s_add_u32 s19, s19, 1024
  s_add_u32 s20, s20, 1024
  s_waitcnt vmcnt(0)
  v_mfma_f32_32x32x16_bf16 v[68:83], v[24:27], v[16:19], 0
  v_cndmask_b32 v28, v13, v28, s[40:41]
  v_cndmask_b32 v84, v13, v84, s[40:41]
  v_cndmask_b32 v29, v13, v29, s[40:41]
  v_cndmask_b32 v85, v13, v85, s[40:41]
  v_cndmask_b32 v30, v13, v30, s[40:41]
  v_cndmask_b32 v86, v13, v86, s[40:41]
  v_cndmask_b32 v31, v13, v31, s[40:41]
  v_cndmask_b32 v87, v13, v87, s[40:41]
  s_nop 3
  v_fma_f32 v68, v68, v11, v10
  v_exp_f32 v68, v68
  v_fma_f32 v69, v69, v11, v10
  v_exp_f32 v69, v69
  v_fma_f32 v70, v70, v11, v10
  v_exp_f32 v70, v70
  v_fma_f32 v71, v71, v11, v10
  v_exp_f32 v71, v71
  v_fma_f32 v72, v72, v11, v10
  v_exp_f32 v72, v72
  v_fma_f32 v73, v73, v11, v10
  v_exp_f32 v73, v73
  v_fma_f32 v74, v74, v11, v10
  v_exp_f32 v74, v74
  v_fma_f32 v75, v75, v11, v10
  v_exp_f32 v75, v75
  v_fma_f32 v76, v76, v11, v10
  v_exp_f32 v76, v76
  v_fma_f32 v77, v77, v11, v10
  v_exp_f32 v77, v77
  v_fma_f32 v78, v78, v11, v10
  v_exp_f32 v78, v78
  v_fma_f32 v79, v79, v11, v10
  v_exp_f32 v79, v79
  v_fma_f32 v80, v80, v11, v10
  v_exp_f32 v80, v80
  v_fma_f32 v81, v81, v11, v10
  v_exp_f32 v81, v81
  v_fma_f32 v82, v82, v11, v10
  v_exp_f32 v82, v82
  v_fma_f32 v83, v83, v11, v10
  v_exp_f32 v83, v83
  v_cvt_pk_bf16_f32 v36, v68, v69
  v_cvt_pk_bf16_f32 v37, v70, v71
  v_cvt_pk_bf16_f32 v38, v72, v73
  v_cvt_pk_bf16_f32 v39, v74, v75
  v_cvt_pk_bf16_f32 v40, v76, v77
  v_cvt_pk_bf16_f32 v41, v78, v79
  v_cvt_pk_bf16_f32 v42, v80, v81
  v_cvt_pk_bf16_f32 v43, v82, v83
  v_mfma_f32_32x32x16_bf16 v[100:115], v[28:31], v[36:39], v[100:115]
  s_nop 0
  v_mfma_f32_32x32x16_bf16 v[100:115], v[84:87], v[40:43], v[100:115]
  s_sub_u32 s21, s21, 1
  s_cmp_lg_u32 s21, 0
  s_cbranch_scc1 B_SL2
  s_nop 8
  v_mov_b32 v32, v108
  s_branch B_NORM
M_END:
  s_endpgm
.section .rodata,"a"
.p2align 6
.amdhsa_kernel gated_mix__grouped_kv_mqa__dense_activation_relu__prompt_kernel
  .amdhsa_next_free_vgpr 256
  .amdhsa_next_free_sgpr 102
  .amdhsa_accum_offset 256
  .amdhsa_group_segment_fixed_size 0
  .amdhsa_kernarg_size 96
  .amdhsa_user_sgpr_count 2
  .amdhsa_user_sgpr_kernarg_segment_ptr 1
  .amdhsa_system_sgpr_workgroup_id_x 1
.end_amdhsa_kernel
```
